```python
import torch

def _softmax(x, axis=-1):
    return torch.softmax(x, dim=axis)
def _gelu(x):
    return torch.nn.functional.gelu(x, approximate="tanh")
def _silu(x):
    return torch.nn.functional.silu(x)
def _sigmoid(x):
    return torch.sigmoid(x)
def _layernorm(x, axis=-1, eps=1e-5):
    m = x.mean(dim=axis, keepdim=True)
    v = x.var(dim=axis, keepdim=True, unbiased=False)
    return (x - m) / torch.sqrt(v + eps)
def _scatter_add(tgt, idx, src, axis=0):
    return tgt.clone().index_add_(axis, idx, src)
def _segment_sum(src, seg, n):
    out = torch.zeros((n,) + src.shape[1:], dtype=src.dtype)
    return out.index_add_(0, seg, src)
def _pad(x, pw):
    flat = tuple(v for pair in reversed(pw) for v in pair)
    return torch.nn.functional.pad(x, flat)

kernel_name = 'sequential_preLN__compressed_kv_cla__dense_activation_gelu__prompt'

def setup_inputs():

    _w = (lambda a: (lambda t: t.to(torch.bfloat16) if t.is_floating_point() else t)(torch.as_tensor(a)))
    def _A_setup():
        B, H, Sq, Sk, D, M = 1, 32, 2048, 2048, 128, 640
        Dc = 4 * D
        return {
            "x": _w((lambda *s: torch.randn(*s, dtype=torch.bfloat16) * 0.05)(B, Sq, M)),
            "c_kv": _w((lambda *s: torch.randn(*s, dtype=torch.bfloat16) * 0.4)(B, Sk, Dc)),
            "w_q": _w((lambda *s: torch.randn(*s, dtype=torch.bfloat16) * 1.6)(M, H, D) * (M ** -0.5)),
            "w_uk": _w((lambda *s: torch.randn(*s, dtype=torch.bfloat16) * 1.6)(Dc, H, D) * (Dc ** -0.5)),
            "w_uv": _w((lambda *s: torch.randn(*s, dtype=torch.bfloat16) * 0.4)(Dc, H, D) * (Dc ** -0.5)),
            "w_o": _w((lambda *s: torch.randn(*s, dtype=torch.bfloat16) * 0.4)(H, D, M) * ((H * D) ** -0.5)),
        }
    _A_in = _A_setup()

    def _B_setup():
        B, S, D, F = 1, 2048, 640, 1728
        return {
            "x": _w((lambda *s: torch.randn(*s, dtype=torch.bfloat16) * 0.05)(B, S, D)),
            "w1": _w((lambda *s: torch.randn(*s, dtype=torch.bfloat16) * 0.8)(D, F) * (D ** -0.5)),
            "b1": _w((lambda *s: torch.randn(*s, dtype=torch.bfloat16) * 12.8)(F) * 0.01),
            "w2": _w((lambda *s: torch.randn(*s, dtype=torch.bfloat16) * 0.2)(F, D) * (F ** -0.5)),
            "b2": _w((lambda *s: torch.randn(*s, dtype=torch.bfloat16) * 3.2)(D) * 0.01),
        }
    _B_in = _B_setup()

    return {
        "A_x": _A_in["x"],
        "A_c_kv": _A_in["c_kv"],
        "A_w_q": _A_in["w_q"],
        "A_w_uk": _A_in["w_uk"],
        "A_w_uv": _A_in["w_uv"],
        "A_w_o": _A_in["w_o"],
        "B_x": _B_in["x"],
        "B_w1": _B_in["w1"],
        "B_b1": _B_in["b1"],
        "B_w2": _B_in["w2"],
        "B_b2": _B_in["b2"],
    }

def reference(A_x, A_c_kv, A_w_q, A_w_uk, A_w_uv, A_w_o, B_x, B_w1, B_b1, B_w2, B_b2):
    def _A_ref(x, c_kv, w_q, w_uk, w_uv, w_o):
        B, Sq, M = x.shape[0], x.shape[1], x.shape[2]
        Sk = c_kv.shape[1]
        H, D = w_q.shape[1], w_q.shape[2]
        q = torch.einsum("bqm,mhd->bhqd", x, w_q)
        k = torch.einsum("bkc,chd->bhkd", c_kv, w_uk)
        v = torch.einsum("bkc,chd->bhkd", c_kv, w_uv)
        scores = torch.einsum("bhqd,bhkd->bhqk", q, k) * (D ** -0.5)
        off = Sk - Sq
        qi = torch.arange(Sq)[:, None]
        kj = torch.arange(Sk)[None, :]
        cmask = kj <= (qi + off)
        scores = torch.where(cmask[None, None], scores, -1e9)
        p = _softmax(scores, axis=-1)
        ctx = torch.einsum("bhqk,bhkd->bhqd", p, v)
        return torch.einsum("bhqd,hdm->bqm", ctx, w_o)

    def _B_ref(x, w1, b1, w2, b2):
        h = torch.einsum("bsd,df->bsf", x, w1) + b1
        h = _gelu(h)
        return torch.einsum("bsf,fd->bsd", h, w2) + b2

    x = A_x
    h = x + _A_ref(_layernorm(x, axis=-1), A_c_kv, A_w_q, A_w_uk, A_w_uv, A_w_o)
    h2 = h + _B_ref(_layernorm(h, axis=-1), B_w1, B_b1, B_w2, B_b2)
    return h2
```

```asm
; @launch kernel=sequential_preLN__compressed_kv_cla__dense_activation_gelu__prompt_kernel grid=(256,1,1) block=(512,1,1) lds=163840
.amdgcn_target "amdgcn-amd-amdhsa--gfx950"
.text
.globl sequential_preLN__compressed_kv_cla__dense_activation_gelu__prompt_kernel
.p2align 8
.type sequential_preLN__compressed_kv_cla__dense_activation_gelu__prompt_kernel,@function
sequential_preLN__compressed_kv_cla__dense_activation_gelu__prompt_kernel:
    s_cmp_ge_u32 s2, 256
    s_cbranch_scc1 L_fz_end
    s_load_dwordx2 s[88:89], s[0:1], 96
    s_load_dwordx2 s[90:91], s[0:1], 104
    s_memrealtime s[100:101]
    s_load_dwordx2 s[4:5], s[0:1], 8
    s_load_dwordx4 s[8:11], s[0:1], 24
    s_load_dwordx2 s[6:7], s[0:1], 0
    s_load_dwordx2 s[12:13], s[0:1], 104
    s_load_dwordx2 s[62:63], s[0:1], 56
    s_and_b32 s20, s2, 7
    s_lshr_b32 s21, s2, 3
    s_and_b32 s22, s21, 7
    s_lshr_b32 s21, s21, 3
    s_lshr_b32 s23, s21, 1
    s_and_b32 s21, s21, 1
    s_lshl_b32 s24, s20, 1
    s_add_u32 s24, s24, s21
    v_lshrrev_b32 v1, 6, v0
    v_and_b32 v2, 63, v0
    v_readfirstlane_b32 s25, v1
    s_waitcnt lgkmcnt(0)
    s_cmp_eq_u32 s23, 0
    s_cselect_b32 s26, s8, s10
    s_cselect_b32 s27, s9, s11
    s_mov_b32 s28, s26
    s_mov_b32 s29, s27
    s_mov_b32 s30, 0x400000
    s_mov_b32 s31, 0x00020000
    s_mov_b32 s32, s4
    s_mov_b32 s33, s5
    s_mov_b32 s34, 0x200000
    s_mov_b32 s35, 0x00020000
    s_add_u32 s36, s12, 0x400000
    s_addc_u32 s37, s13, 0
    s_mov_b32 s38, 0x2000000
    s_mov_b32 s39, 0x00020000
    s_mov_b32 s40, s6
    s_mov_b32 s41, s7
    s_mov_b32 s42, 0x280000
    s_mov_b32 s43, 0x00020000
    s_mov_b32 s44, s12
    s_mov_b32 s45, s13
    s_mov_b32 s46, 0x280000
    s_mov_b32 s47, 0x00020000
    s_lshl_b32 s48, s2, 3
    s_add_u32 s48, s48, s25
    s_mul_i32 s49, s48, 1280
    v_lshlrev_b32 v3, 4, v2
    v_mov_b32 v20, 0
    v_mov_b32 v21, 0
    v_mov_b32 v22, 0
    v_mov_b32 v23, 0
    buffer_load_dwordx4 v[16:19], v3, s[40:43], s49 offen sc1
    v_add_u32 v4, 1024, v3
    v_cmp_gt_u32 vcc, 16, v2
    v_mov_b32 v5, 0x7fffffff
    s_nop 0
    v_cndmask_b32 v4, v5, v4, vcc
    buffer_load_dwordx4 v[20:23], v4, s[40:43], s49 offen sc1
    s_lshl_b32 s50, s25, 1
    v_lshrrev_b32 v7, 5, v2
    v_add_u32 v7, s50, v7
    v_and_b32 v8, 3, v7
    v_lshlrev_b32 v8, 2, v8
    v_and_b32 v9, 31, v2
    v_xor_b32 v8, v8, v9
    v_lshlrev_b32 v8, 4, v8
    v_lshlrev_b32 v7, 13, v7
    v_add_u32 v6, v7, v8
    s_lshl_b32 s50, s25, 3
    v_lshrrev_b32 v7, 3, v2
    v_add_u32 v7, s50, v7
    v_lshrrev_b32 v8, 1, v7
    v_and_b32 v8, 7, v8
    v_and_b32 v9, 7, v2
    v_xor_b32 v8, v8, v9
    v_lshlrev_b32 v8, 4, v8
    v_lshlrev_b32 v7, 10, v7
    v_add_u32 v10, v7, v8
    s_lshl_b32 s51, s24, 9
    s_lshl_b32 s52, s22, 18
    s_lshl_b32 s53, s25, 10
    s_add_u32 m0, s53, 0
    s_add_u32 s54, s51, 0
    buffer_load_dwordx4 v6, s[28:31], s54 offen sc1 lds
    s_add_u32 m0, s53, 8192
    s_add_u32 s54, s51, 131072
    buffer_load_dwordx4 v6, s[28:31], s54 offen sc1 lds
    s_add_u32 m0, s53, 16384
    s_add_u32 s54, s51, 262144
    buffer_load_dwordx4 v6, s[28:31], s54 offen sc1 lds
    s_add_u32 m0, s53, 24576
    s_add_u32 s54, s51, 393216
    buffer_load_dwordx4 v6, s[28:31], s54 offen sc1 lds
    s_add_u32 m0, s53, 32768
    s_add_u32 s54, s52, 0
    buffer_load_dwordx4 v10, s[32:35], s54 offen sc1 lds
    s_add_u32 m0, s53, 40960
    s_add_u32 s54, s52, 65536
    buffer_load_dwordx4 v10, s[32:35], s54 offen sc1 lds
    s_add_u32 m0, s53, 49152
    s_add_u32 s54, s52, 131072
    buffer_load_dwordx4 v10, s[32:35], s54 offen sc1 lds
    s_add_u32 m0, s53, 57344
    s_add_u32 s54, s52, 196608
    buffer_load_dwordx4 v10, s[32:35], s54 offen sc1 lds
    s_add_u32 m0, s53, 65536
    s_add_u32 s54, s51, 524288
    buffer_load_dwordx4 v6, s[28:31], s54 offen sc1 lds
    s_add_u32 m0, s53, 73728
    s_add_u32 s54, s51, 655360
    buffer_load_dwordx4 v6, s[28:31], s54 offen sc1 lds
    s_add_u32 m0, s53, 81920
    s_add_u32 s54, s51, 786432
    buffer_load_dwordx4 v6, s[28:31], s54 offen sc1 lds
    s_add_u32 m0, s53, 90112
    s_add_u32 s54, s51, 917504
    buffer_load_dwordx4 v6, s[28:31], s54 offen sc1 lds
    s_add_u32 m0, s53, 98304
    s_add_u32 s54, s52, 128
    buffer_load_dwordx4 v10, s[32:35], s54 offen sc1 lds
    s_add_u32 m0, s53, 106496
    s_add_u32 s54, s52, 65664
    buffer_load_dwordx4 v10, s[32:35], s54 offen sc1 lds
    s_add_u32 m0, s53, 114688
    s_add_u32 s54, s52, 131200
    buffer_load_dwordx4 v10, s[32:35], s54 offen sc1 lds
    s_add_u32 m0, s53, 122880
    s_add_u32 s54, s52, 196736
    buffer_load_dwordx4 v10, s[32:35], s54 offen sc1 lds
    s_or_b32 s100, s100, 1
    s_add_u32 s96, s90, 0x7000000
    s_addc_u32 s97, s91, 0
    s_mov_b32 s98, 0x10000
    s_mov_b32 s99, 0x00020000
    s_cmp_eq_u32 s25, 0
    s_cbranch_scc0 L_fz_p1
    s_mov_b32 s92, s88
    s_mov_b32 s93, s89
    s_mov_b32 s94, 0x100
    s_mov_b32 s95, 0x00020000
    s_mov_b64 exec, 1
    v_mov_b32 v56, s100
    v_mov_b32 v57, s101
    v_mov_b32 v58, 0
    v_mov_b32 v59, 0
    v_mov_b32 v55, 0
    buffer_atomic_cmpswap_x2 v[56:59], v55, s[92:95], 0 offen sc0 sc1
    s_mov_b64 exec, -1
L_fz_p1:
    v_and_b32 v7, 3, v2
    v_and_b32 v8, 1, v7
    v_lshlrev_b32 v8, 1, v8
    v_lshrrev_b32 v9, 1, v7
    v_or_b32 v8, v8, v9
    s_cmp_eq_u32 s23, 0
    s_cselect_b64 s[56:57], -1, 0
    v_cndmask_b32 v7, v7, v8, s[56:57]
    v_lshrrev_b32 v8, 1, v7
    v_and_b32 v7, 1, v7
    v_lshlrev_b32 v7, 3, v7
    v_lshrrev_b32 v9, 4, v2
    v_and_b32 v9, 1, v9
    v_lshlrev_b32 v9, 1, v9
    v_add_u32 v8, v8, v9
    s_and_b32 s55, s25, 3
    s_lshl_b32 s55, s55, 3
    v_add_u32 v8, s55, v8
    v_lshrrev_b32 v9, 2, v2
    v_and_b32 v9, 3, v9
    v_lshlrev_b32 v11, 2, v9
    v_lshrrev_b32 v12, 5, v2
    v_lshlrev_b32 v12, 3, v12
    v_add_u32 v12, v12, v9
    v_lshlrev_b32 v12, 9, v12
    v_add_u32 v12, v12, v7
    v_add_u32 v13, 0, v8
    v_xor_b32 v13, v13, v11
    v_lshlrev_b32 v13, 4, v13
    v_add_u32 v24, v12, v13
    v_add_u32 v26, 0x10000, v24
    v_add_u32 v13, 4, v8
    v_xor_b32 v13, v13, v11
    v_lshlrev_b32 v13, 4, v13
    v_add_u32 v25, v12, v13
    v_add_u32 v27, 0x10000, v25
    v_and_b32 v7, 31, v2
    v_and_b32 v8, 0x13, v7
    v_and_b32 v9, 4, v7
    v_lshlrev_b32 v9, 1, v9
    v_or_b32 v8, v8, v9
    v_and_b32 v9, 8, v7
    v_lshrrev_b32 v9, 1, v9
    v_or_b32 v8, v8, v9
    v_cndmask_b32 v7, v8, v7, s[56:57]
    v_lshrrev_b32 v8, 1, v7
    v_and_b32 v8, 7, v8
    v_lshrrev_b32 v9, 5, v2
    s_lshr_b32 s55, s25, 2
    s_lshl_b32 s55, s55, 14
    s_add_u32 s55, s55, 32768
    v_lshlrev_b32 v7, 7, v7
    v_add_u32 v7, s55, v7
    v_add_u32 v13, 0, v9
    v_xor_b32 v13, v13, v8
    v_lshlrev_b32 v13, 4, v13
    v_add_u32 v28, v7, v13
    v_add_u32 v32, 0x10000, v28
    v_add_u32 v13, 2, v9
    v_xor_b32 v13, v13, v8
    v_lshlrev_b32 v13, 4, v13
    v_add_u32 v29, v7, v13
    v_add_u32 v33, 0x10000, v29
    v_add_u32 v13, 4, v9
    v_xor_b32 v13, v13, v8
    v_lshlrev_b32 v13, 4, v13
    v_add_u32 v30, v7, v13
    v_add_u32 v34, 0x10000, v30
    v_add_u32 v13, 6, v9
    v_xor_b32 v13, v13, v8
    v_lshlrev_b32 v13, 4, v13
    v_add_u32 v31, v7, v13
    v_add_u32 v35, 0x10000, v31
    v_mov_b32 v128, 0
    v_mov_b32 v129, 0
    v_mov_b32 v130, 0
    v_mov_b32 v131, 0
    v_mov_b32 v132, 0
    v_mov_b32 v133, 0
    v_mov_b32 v134, 0
    v_mov_b32 v135, 0
    v_mov_b32 v136, 0
    v_mov_b32 v137, 0
    v_mov_b32 v138, 0
    v_mov_b32 v139, 0
    v_mov_b32 v140, 0
    v_mov_b32 v141, 0
    v_mov_b32 v142, 0
    v_mov_b32 v143, 0
    v_mov_b32 v144, 0
    v_mov_b32 v145, 0
    v_mov_b32 v146, 0
    v_mov_b32 v147, 0
    v_mov_b32 v148, 0
    v_mov_b32 v149, 0
    v_mov_b32 v150, 0
    v_mov_b32 v151, 0
    v_mov_b32 v152, 0
    v_mov_b32 v153, 0
    v_mov_b32 v154, 0
    v_mov_b32 v155, 0
    v_mov_b32 v156, 0
    v_mov_b32 v157, 0
    v_mov_b32 v158, 0
    v_mov_b32 v159, 0
    v_mov_b32 v160, 0
    v_mov_b32 v161, 0
    v_mov_b32 v162, 0
    v_mov_b32 v163, 0
    v_mov_b32 v164, 0
    v_mov_b32 v165, 0
    v_mov_b32 v166, 0
    v_mov_b32 v167, 0
    v_mov_b32 v168, 0
    v_mov_b32 v169, 0
    v_mov_b32 v170, 0
    v_mov_b32 v171, 0
    v_mov_b32 v172, 0
    v_mov_b32 v173, 0
    v_mov_b32 v174, 0
    v_mov_b32 v175, 0
    v_mov_b32 v176, 0
    v_mov_b32 v177, 0
    v_mov_b32 v178, 0
    v_mov_b32 v179, 0
    v_mov_b32 v180, 0
    v_mov_b32 v181, 0
    v_mov_b32 v182, 0
    v_mov_b32 v183, 0
    v_mov_b32 v184, 0
    v_mov_b32 v185, 0
    v_mov_b32 v186, 0
    v_mov_b32 v187, 0
    v_mov_b32 v188, 0
    v_mov_b32 v189, 0
    v_mov_b32 v190, 0
    v_mov_b32 v191, 0
    v_mov_b32 v192, 0
    v_mov_b32 v193, 0
    v_mov_b32 v194, 0
    v_mov_b32 v195, 0
    v_mov_b32 v196, 0
    v_mov_b32 v197, 0
    v_mov_b32 v198, 0
    v_mov_b32 v199, 0
    v_mov_b32 v200, 0
    v_mov_b32 v201, 0
    v_mov_b32 v202, 0
    v_mov_b32 v203, 0
    v_mov_b32 v204, 0
    v_mov_b32 v205, 0
    v_mov_b32 v206, 0
    v_mov_b32 v207, 0
    v_mov_b32 v208, 0
    v_mov_b32 v209, 0
    v_mov_b32 v210, 0
    v_mov_b32 v211, 0
    v_mov_b32 v212, 0
    v_mov_b32 v213, 0
    v_mov_b32 v214, 0
    v_mov_b32 v215, 0
    v_mov_b32 v216, 0
    v_mov_b32 v217, 0
    v_mov_b32 v218, 0
    v_mov_b32 v219, 0
    v_mov_b32 v220, 0
    v_mov_b32 v221, 0
    v_mov_b32 v222, 0
    v_mov_b32 v223, 0
    v_mov_b32 v224, 0
    v_mov_b32 v225, 0
    v_mov_b32 v226, 0
    v_mov_b32 v227, 0
    v_mov_b32 v228, 0
    v_mov_b32 v229, 0
    v_mov_b32 v230, 0
    v_mov_b32 v231, 0
    v_mov_b32 v232, 0
    v_mov_b32 v233, 0
    v_mov_b32 v234, 0
    v_mov_b32 v235, 0
    v_mov_b32 v236, 0
    v_mov_b32 v237, 0
    v_mov_b32 v238, 0
    v_mov_b32 v239, 0
    v_mov_b32 v240, 0
    v_mov_b32 v241, 0
    v_mov_b32 v242, 0
    v_mov_b32 v243, 0
    v_mov_b32 v244, 0
    v_mov_b32 v245, 0
    v_mov_b32 v246, 0
    v_mov_b32 v247, 0
    v_mov_b32 v248, 0
    v_mov_b32 v249, 0
    v_mov_b32 v250, 0
    v_mov_b32 v251, 0
    v_mov_b32 v252, 0
    v_mov_b32 v253, 0
    v_mov_b32 v254, 0
    v_mov_b32 v255, 0
    s_cmp_eq_u32 s23, 0
    s_cbranch_scc0 L_kv_vpath
    s_waitcnt vmcnt(8)
    s_barrier
    ds_read_b64_tr_b16 v[64:65], v24 offset:0
    ds_read_b64_tr_b16 v[66:67], v24 offset:2048
    ds_read_b128 v[72:75], v28 offset:0
    ds_read_b64_tr_b16 v[68:69], v25 offset:0
    ds_read_b64_tr_b16 v[70:71], v25 offset:2048
    ds_read_b128 v[76:79], v28 offset:4096
    ds_read_b128 v[80:83], v28 offset:8192
    ds_read_b128 v[84:87], v28 offset:12288
    s_waitcnt lgkmcnt(0)
    v_mfma_f32_32x32x16_bf16 v[128:143], v[64:67], v[72:75], v[128:143]
    ds_read_b64_tr_b16 v[88:89], v24 offset:8192
    ds_read_b64_tr_b16 v[90:91], v24 offset:10240
    v_mfma_f32_32x32x16_bf16 v[192:207], v[68:71], v[72:75], v[192:207]
    ds_read_b128 v[96:99], v29 offset:0
    ds_read_b64_tr_b16 v[92:93], v25 offset:8192
    v_mfma_f32_32x32x16_bf16 v[144:159], v[64:67], v[76:79], v[144:159]
    ds_read_b64_tr_b16 v[94:95], v25 offset:10240
    ds_read_b128 v[100:103], v29 offset:4096
    v_mfma_f32_32x32x16_bf16 v[208:223], v[68:71], v[76:79], v[208:223]
    ds_read_b128 v[104:107], v29 offset:8192
    ds_read_b128 v[108:111], v29 offset:12288
    v_mfma_f32_32x32x16_bf16 v[160:175], v[64:67], v[80:83], v[160:175]
    v_mfma_f32_32x32x16_bf16 v[224:239], v[68:71], v[80:83], v[224:239]
    v_mfma_f32_32x32x16_bf16 v[176:191], v[64:67], v[84:87], v[176:191]
    v_mfma_f32_32x32x16_bf16 v[240:255], v[68:71], v[84:87], v[240:255]
    s_waitcnt lgkmcnt(0)
    v_mfma_f32_32x32x16_bf16 v[128:143], v[88:91], v[96:99], v[128:143]
    ds_read_b64_tr_b16 v[64:65], v24 offset:16384
    ds_read_b64_tr_b16 v[66:67], v24 offset:18432
    v_mfma_f32_32x32x16_bf16 v[192:207], v[92:95], v[96:99], v[192:207]
    ds_read_b128 v[72:75], v30 offset:0
    ds_read_b64_tr_b16 v[68:69], v25 offset:16384
    v_mfma_f32_32x32x16_bf16 v[144:159], v[88:91], v[100:103], v[144:159]
    ds_read_b64_tr_b16 v[70:71], v25 offset:18432
    ds_read_b128 v[76:79], v30 offset:4096
    v_mfma_f32_32x32x16_bf16 v[208:223], v[92:95], v[100:103], v[208:223]
    ds_read_b128 v[80:83], v30 offset:8192
    ds_read_b128 v[84:87], v30 offset:12288
    v_mfma_f32_32x32x16_bf16 v[160:175], v[88:91], v[104:107], v[160:175]
    v_mfma_f32_32x32x16_bf16 v[224:239], v[92:95], v[104:107], v[224:239]
    v_mfma_f32_32x32x16_bf16 v[176:191], v[88:91], v[108:111], v[176:191]
    v_mfma_f32_32x32x16_bf16 v[240:255], v[92:95], v[108:111], v[240:255]
    s_waitcnt lgkmcnt(0)
    v_mfma_f32_32x32x16_bf16 v[128:143], v[64:67], v[72:75], v[128:143]
    ds_read_b64_tr_b16 v[88:89], v24 offset:24576
    ds_read_b64_tr_b16 v[90:91], v24 offset:26624
    v_mfma_f32_32x32x16_bf16 v[192:207], v[68:71], v[72:75], v[192:207]
    ds_read_b128 v[96:99], v31 offset:0
    ds_read_b64_tr_b16 v[92:93], v25 offset:24576
    v_mfma_f32_32x32x16_bf16 v[144:159], v[64:67], v[76:79], v[144:159]
    ds_read_b64_tr_b16 v[94:95], v25 offset:26624
    ds_read_b128 v[100:103], v31 offset:4096
    v_mfma_f32_32x32x16_bf16 v[208:223], v[68:71], v[76:79], v[208:223]
    ds_read_b128 v[104:107], v31 offset:8192
    ds_read_b128 v[108:111], v31 offset:12288
    v_mfma_f32_32x32x16_bf16 v[160:175], v[64:67], v[80:83], v[160:175]
    v_mfma_f32_32x32x16_bf16 v[224:239], v[68:71], v[80:83], v[224:239]
    v_mfma_f32_32x32x16_bf16 v[176:191], v[64:67], v[84:87], v[176:191]
    v_mfma_f32_32x32x16_bf16 v[240:255], v[68:71], v[84:87], v[240:255]
    s_waitcnt vmcnt(0) lgkmcnt(0)
    s_barrier
    v_mfma_f32_32x32x16_bf16 v[128:143], v[88:91], v[96:99], v[128:143]
    ds_read_b64_tr_b16 v[64:65], v26 offset:0
    ds_read_b64_tr_b16 v[66:67], v26 offset:2048
    ds_read_b128 v[72:75], v32 offset:0
    ds_read_b64_tr_b16 v[68:69], v27 offset:0
    v_mfma_f32_32x32x16_bf16 v[192:207], v[92:95], v[96:99], v[192:207]
    ds_read_b64_tr_b16 v[70:71], v27 offset:2048
    ds_read_b128 v[76:79], v32 offset:4096
    ds_read_b128 v[80:83], v32 offset:8192
    ds_read_b128 v[84:87], v32 offset:12288
    v_mfma_f32_32x32x16_bf16 v[144:159], v[88:91], v[100:103], v[144:159]
    s_add_u32 m0, s53, 0
    s_add_u32 s54, s51, 1048576
    buffer_load_dwordx4 v6, s[28:31], s54 offen sc1 lds
    s_add_u32 m0, s53, 8192
    v_mfma_f32_32x32x16_bf16 v[208:223], v[92:95], v[100:103], v[208:223]
    s_add_u32 s54, s51, 1179648
    buffer_load_dwordx4 v6, s[28:31], s54 offen sc1 lds
    s_add_u32 m0, s53, 16384
    s_add_u32 s54, s51, 1310720
    v_mfma_f32_32x32x16_bf16 v[160:175], v[88:91], v[104:107], v[160:175]
    buffer_load_dwordx4 v6, s[28:31], s54 offen sc1 lds
    s_add_u32 m0, s53, 24576
    s_add_u32 s54, s51, 1441792
    buffer_load_dwordx4 v6, s[28:31], s54 offen sc1 lds
    v_mfma_f32_32x32x16_bf16 v[224:239], v[92:95], v[104:107], v[224:239]
    s_add_u32 m0, s53, 32768
    s_add_u32 s54, s52, 256
    buffer_load_dwordx4 v10, s[32:35], s54 offen sc1 lds
    s_add_u32 m0, s53, 40960
    v_mfma_f32_32x32x16_bf16 v[176:191], v[88:91], v[108:111], v[176:191]
    s_add_u32 s54, s52, 65792
    buffer_load_dwordx4 v10, s[32:35], s54 offen sc1 lds
    s_add_u32 m0, s53, 49152
    s_add_u32 s54, s52, 131328
    v_mfma_f32_32x32x16_bf16 v[240:255], v[92:95], v[108:111], v[240:255]
    buffer_load_dwordx4 v10, s[32:35], s54 offen sc1 lds
    s_add_u32 m0, s53, 57344
    s_add_u32 s54, s52, 196864
    buffer_load_dwordx4 v10, s[32:35], s54 offen sc1 lds
    s_waitcnt lgkmcnt(0)
    v_mfma_f32_32x32x16_bf16 v[128:143], v[64:67], v[72:75], v[128:143]
    ds_read_b64_tr_b16 v[88:89], v26 offset:8192
    ds_read_b64_tr_b16 v[90:91], v26 offset:10240
    v_mfma_f32_32x32x16_bf16 v[192:207], v[68:71], v[72:75], v[192:207]
    ds_read_b128 v[96:99], v33 offset:0
    ds_read_b64_tr_b16 v[92:93], v27 offset:8192
    v_mfma_f32_32x32x16_bf16 v[144:159], v[64:67], v[76:79], v[144:159]
    ds_read_b64_tr_b16 v[94:95], v27 offset:10240
    ds_read_b128 v[100:103], v33 offset:4096
    v_mfma_f32_32x32x16_bf16 v[208:223], v[68:71], v[76:79], v[208:223]
    ds_read_b128 v[104:107], v33 offset:8192
    ds_read_b128 v[108:111], v33 offset:12288
    v_mfma_f32_32x32x16_bf16 v[160:175], v[64:67], v[80:83], v[160:175]
    v_mfma_f32_32x32x16_bf16 v[224:239], v[68:71], v[80:83], v[224:239]
    v_mfma_f32_32x32x16_bf16 v[176:191], v[64:67], v[84:87], v[176:191]
    v_mfma_f32_32x32x16_bf16 v[240:255], v[68:71], v[84:87], v[240:255]
    v_cmp_gt_u32 vcc, 16, v2
    v_mov_b32 v55, 0
    s_nop 0
    v_cndmask_b32 v55, v55, 1.0, vcc
    v_lshlrev_b32 v36, 16, v16
    v_and_b32 v37, 0xffff0000, v16
    v_lshlrev_b32 v38, 16, v17
    v_and_b32 v39, 0xffff0000, v17
    v_lshlrev_b32 v40, 16, v18
    v_and_b32 v41, 0xffff0000, v18
    v_lshlrev_b32 v42, 16, v19
    v_and_b32 v43, 0xffff0000, v19
    v_lshlrev_b32 v44, 16, v20
    v_and_b32 v45, 0xffff0000, v20
    v_lshlrev_b32 v46, 16, v21
    v_and_b32 v47, 0xffff0000, v21
    v_lshlrev_b32 v48, 16, v22
    v_and_b32 v49, 0xffff0000, v22
    v_lshlrev_b32 v50, 16, v23
    v_and_b32 v51, 0xffff0000, v23
    v_add_f32 v52, v36, v37
    v_add_f32 v52, v52, v38
    v_add_f32 v52, v52, v39
    v_add_f32 v52, v52, v40
    v_add_f32 v52, v52, v41
    v_add_f32 v52, v52, v42
    v_add_f32 v52, v52, v43
    v_add_f32 v52, v52, v44
    v_add_f32 v52, v52, v45
    v_add_f32 v52, v52, v46
    v_add_f32 v52, v52, v47
    v_add_f32 v52, v52, v48
    v_add_f32 v52, v52, v49
    v_add_f32 v52, v52, v50
    v_add_f32 v52, v52, v51
    s_nop 1
    v_add_f32_dpp v52, v52, v52 quad_perm:[1,0,3,2] row_mask:0xf bank_mask:0xf
    s_nop 1
    v_add_f32_dpp v52, v52, v52 quad_perm:[2,3,0,1] row_mask:0xf bank_mask:0xf
    s_nop 1
    v_add_f32_dpp v52, v52, v52 row_half_mirror row_mask:0xf bank_mask:0xf
    s_nop 1
    v_add_f32_dpp v52, v52, v52 row_mirror row_mask:0xf bank_mask:0xf
    v_mov_b32 v53, v52
    s_nop 1
    v_permlane16_swap_b32 v52, v53
    v_add_f32 v52, v52, v53
    v_mov_b32 v53, v52
    s_nop 1
    v_permlane32_swap_b32 v52, v53
    v_add_f32 v52, v52, v53
    v_mul_f32 v52, 0x3acccccd, v52
    v_sub_f32 v36, v36, v52
    v_sub_f32 v37, v37, v52
    v_sub_f32 v38, v38, v52
    v_sub_f32 v39, v39, v52
    v_sub_f32 v40, v40, v52
    v_sub_f32 v41, v41, v52
    v_sub_f32 v42, v42, v52
    v_sub_f32 v43, v43, v52
    v_sub_f32 v44, v44, v52
    v_sub_f32 v45, v45, v52
    v_sub_f32 v46, v46, v52
    v_sub_f32 v47, v47, v52
    v_sub_f32 v48, v48, v52
    v_sub_f32 v49, v49, v52
    v_sub_f32 v50, v50, v52
    v_sub_f32 v51, v51, v52
    v_mul_f32 v44, v44, v55
    v_mul_f32 v45, v45, v55
    v_mul_f32 v46, v46, v55
    v_mul_f32 v47, v47, v55
    v_mul_f32 v48, v48, v55
    v_mul_f32 v49, v49, v55
    v_mul_f32 v50, v50, v55
    v_mul_f32 v51, v51, v55
    v_mul_f32 v52, v36, v36
    v_fmac_f32 v52, v37, v37
    v_fmac_f32 v52, v38, v38
    v_fmac_f32 v52, v39, v39
    v_fmac_f32 v52, v40, v40
    v_fmac_f32 v52, v41, v41
    v_fmac_f32 v52, v42, v42
    v_fmac_f32 v52, v43, v43
    v_fmac_f32 v52, v44, v44
    v_fmac_f32 v52, v45, v45
    v_fmac_f32 v52, v46, v46
    v_fmac_f32 v52, v47, v47
    v_fmac_f32 v52, v48, v48
    v_fmac_f32 v52, v49, v49
    v_fmac_f32 v52, v50, v50
    v_fmac_f32 v52, v51, v51
    s_nop 1
    v_add_f32_dpp v52, v52, v52 quad_perm:[1,0,3,2] row_mask:0xf bank_mask:0xf
    s_nop 1
    v_add_f32_dpp v52, v52, v52 quad_perm:[2,3,0,1] row_mask:0xf bank_mask:0xf
    s_nop 1
    v_add_f32_dpp v52, v52, v52 row_half_mirror row_mask:0xf bank_mask:0xf
    s_nop 1
    v_add_f32_dpp v52, v52, v52 row_mirror row_mask:0xf bank_mask:0xf
    v_mov_b32 v53, v52
    s_nop 1
    v_permlane16_swap_b32 v52, v53
    v_add_f32 v52, v52, v53
    v_mov_b32 v53, v52
    s_nop 1
    v_permlane32_swap_b32 v52, v53
    v_add_f32 v52, v52, v53
    v_mov_b32 v54, 0x3727c5ac
    v_fmac_f32 v54, 0x3acccccd, v52
    v_rsq_f32 v54, v54
    s_nop 0
    v_mul_f32 v36, v36, v54
    v_mul_f32 v37, v37, v54
    v_mul_f32 v38, v38, v54
    v_mul_f32 v39, v39, v54
    v_mul_f32 v40, v40, v54
    v_mul_f32 v41, v41, v54
    v_mul_f32 v42, v42, v54
    v_mul_f32 v43, v43, v54
    v_mul_f32 v44, v44, v54
    v_mul_f32 v45, v45, v54
    v_mul_f32 v46, v46, v54
    v_mul_f32 v47, v47, v54
    v_mul_f32 v48, v48, v54
    v_mul_f32 v49, v49, v54
    v_mul_f32 v50, v50, v54
    v_mul_f32 v51, v51, v54
    v_cvt_pk_bf16_f32 v16, v36, v37
    v_cvt_pk_bf16_f32 v17, v38, v39
    v_cvt_pk_bf16_f32 v18, v40, v41
    v_cvt_pk_bf16_f32 v19, v42, v43
    v_cvt_pk_bf16_f32 v20, v44, v45
    v_cvt_pk_bf16_f32 v21, v46, v47
    v_cvt_pk_bf16_f32 v22, v48, v49
    v_cvt_pk_bf16_f32 v23, v50, v51
    s_lshr_b32 s55, s48, 7
    s_mul_i32 s55, s55, 163840
    s_and_b32 s58, s48, 127
    s_lshl_b32 s58, s58, 4
    s_add_u32 s55, s55, s58
    v_lshlrev_b32 v7, 11, v2
    buffer_store_dwordx4 v[16:19], v7, s[44:47], s55 offen sc1
    v_add_u32 v8, 0x20000, v7
    v_mov_b32 v5, 0x7fffffff
    v_cndmask_b32 v8, v5, v8, vcc
    buffer_store_dwordx4 v[20:23], v8, s[44:47], s55 offen sc1
    s_waitcnt lgkmcnt(0)
    v_mfma_f32_32x32x16_bf16 v[128:143], v[88:91], v[96:99], v[128:143]
    ds_read_b64_tr_b16 v[64:65], v26 offset:16384
    ds_read_b64_tr_b16 v[66:67], v26 offset:18432
    v_mfma_f32_32x32x16_bf16 v[192:207], v[92:95], v[96:99], v[192:207]
    ds_read_b128 v[72:75], v34 offset:0
    ds_read_b64_tr_b16 v[68:69], v27 offset:16384
    v_mfma_f32_32x32x16_bf16 v[144:159], v[88:91], v[100:103], v[144:159]
    ds_read_b64_tr_b16 v[70:71], v27 offset:18432
    ds_read_b128 v[76:79], v34 offset:4096
    v_mfma_f32_32x32x16_bf16 v[208:223], v[92:95], v[100:103], v[208:223]
    ds_read_b128 v[80:83], v34 offset:8192
    ds_read_b128 v[84:87], v34 offset:12288
    v_mfma_f32_32x32x16_bf16 v[160:175], v[88:91], v[104:107], v[160:175]
    v_mfma_f32_32x32x16_bf16 v[224:239], v[92:95], v[104:107], v[224:239]
    v_mfma_f32_32x32x16_bf16 v[176:191], v[88:91], v[108:111], v[176:191]
    v_mfma_f32_32x32x16_bf16 v[240:255], v[92:95], v[108:111], v[240:255]
    s_waitcnt lgkmcnt(0)
    v_mfma_f32_32x32x16_bf16 v[128:143], v[64:67], v[72:75], v[128:143]
    ds_read_b64_tr_b16 v[88:89], v26 offset:24576
    ds_read_b64_tr_b16 v[90:91], v26 offset:26624
    v_mfma_f32_32x32x16_bf16 v[192:207], v[68:71], v[72:75], v[192:207]
    ds_read_b128 v[96:99], v35 offset:0
    ds_read_b64_tr_b16 v[92:93], v27 offset:24576
    v_mfma_f32_32x32x16_bf16 v[144:159], v[64:67], v[76:79], v[144:159]
    ds_read_b64_tr_b16 v[94:95], v27 offset:26624
    ds_read_b128 v[100:103], v35 offset:4096
    v_mfma_f32_32x32x16_bf16 v[208:223], v[68:71], v[76:79], v[208:223]
    ds_read_b128 v[104:107], v35 offset:8192
    ds_read_b128 v[108:111], v35 offset:12288
    v_mfma_f32_32x32x16_bf16 v[160:175], v[64:67], v[80:83], v[160:175]
    v_mfma_f32_32x32x16_bf16 v[224:239], v[68:71], v[80:83], v[224:239]
    v_mfma_f32_32x32x16_bf16 v[176:191], v[64:67], v[84:87], v[176:191]
    v_mfma_f32_32x32x16_bf16 v[240:255], v[68:71], v[84:87], v[240:255]
    s_waitcnt vmcnt(0) lgkmcnt(0)
    s_barrier
    s_cmp_eq_u32 s25, 0
    s_cbranch_scc0 L_fz_n1
    v_readfirstlane_b32 s88, v56
    v_readfirstlane_b32 s89, v57
    s_nop 1
    s_cmp_eq_u64 s[88:89], 0
    s_cselect_b32 s100, s100, s88
    s_cselect_b32 s101, s101, s89
L_fz_n1:
    s_cmp_eq_u32 s25, 0
    s_cbranch_scc0 L_fz_f2
    s_lshl_b32 s88, s2, 3
    s_add_u32 s88, s88, 12288
    s_mov_b64 exec, 1
    v_mov_b32 v62, s100
    v_mov_b32 v63, s101
    v_mov_b32 v61, 0
    buffer_store_dwordx2 v[62:63], v61, s[96:99], s88 offen sc0 sc1
    s_mov_b64 exec, -1
L_fz_f2:
    v_mfma_f32_32x32x16_bf16 v[128:143], v[88:91], v[96:99], v[128:143]
    ds_read_b64_tr_b16 v[64:65], v24 offset:0
    ds_read_b64_tr_b16 v[66:67], v24 offset:2048
    ds_read_b128 v[72:75], v28 offset:0
    ds_read_b64_tr_b16 v[68:69], v25 offset:0
    v_mfma_f32_32x32x16_bf16 v[192:207], v[92:95], v[96:99], v[192:207]
    ds_read_b64_tr_b16 v[70:71], v25 offset:2048
    ds_read_b128 v[76:79], v28 offset:4096
    ds_read_b128 v[80:83], v28 offset:8192
    ds_read_b128 v[84:87], v28 offset:12288
    v_mfma_f32_32x32x16_bf16 v[144:159], v[88:91], v[100:103], v[144:159]
    s_add_u32 m0, s53, 65536
    s_add_u32 s54, s51, 1572864
    buffer_load_dwordx4 v6, s[28:31], s54 offen sc1 lds
    s_add_u32 m0, s53, 73728
    v_mfma_f32_32x32x16_bf16 v[208:223], v[92:95], v[100:103], v[208:223]
    s_add_u32 s54, s51, 1703936
    buffer_load_dwordx4 v6, s[28:31], s54 offen sc1 lds
    s_add_u32 m0, s53, 81920
    s_add_u32 s54, s51, 1835008
    v_mfma_f32_32x32x16_bf16 v[160:175], v[88:91], v[104:107], v[160:175]
    buffer_load_dwordx4 v6, s[28:31], s54 offen sc1 lds
    s_add_u32 m0, s53, 90112
    s_add_u32 s54, s51, 1966080
    buffer_load_dwordx4 v6, s[28:31], s54 offen sc1 lds
    v_mfma_f32_32x32x16_bf16 v[224:239], v[92:95], v[104:107], v[224:239]
    s_add_u32 m0, s53, 98304
    s_add_u32 s54, s52, 384
    buffer_load_dwordx4 v10, s[32:35], s54 offen sc1 lds
    s_add_u32 m0, s53, 106496
    v_mfma_f32_32x32x16_bf16 v[176:191], v[88:91], v[108:111], v[176:191]
    s_add_u32 s54, s52, 65920
    buffer_load_dwordx4 v10, s[32:35], s54 offen sc1 lds
    s_add_u32 m0, s53, 114688
    s_add_u32 s54, s52, 131456
    v_mfma_f32_32x32x16_bf16 v[240:255], v[92:95], v[108:111], v[240:255]
    buffer_load_dwordx4 v10, s[32:35], s54 offen sc1 lds
    s_add_u32 m0, s53, 122880
    s_add_u32 s54, s52, 196992
    buffer_load_dwordx4 v10, s[32:35], s54 offen sc1 lds
    s_waitcnt lgkmcnt(0)
    v_mfma_f32_32x32x16_bf16 v[128:143], v[64:67], v[72:75], v[128:143]
    ds_read_b64_tr_b16 v[88:89], v24 offset:8192
    ds_read_b64_tr_b16 v[90:91], v24 offset:10240
    v_mfma_f32_32x32x16_bf16 v[192:207], v[68:71], v[72:75], v[192:207]
    ds_read_b128 v[96:99], v29 offset:0
    ds_read_b64_tr_b16 v[92:93], v25 offset:8192
    v_mfma_f32_32x32x16_bf16 v[144:159], v[64:67], v[76:79], v[144:159]
    ds_read_b64_tr_b16 v[94:95], v25 offset:10240
    ds_read_b128 v[100:103], v29 offset:4096
    v_mfma_f32_32x32x16_bf16 v[208:223], v[68:71], v[76:79], v[208:223]
    ds_read_b128 v[104:107], v29 offset:8192
    ds_read_b128 v[108:111], v29 offset:12288
    v_mfma_f32_32x32x16_bf16 v[160:175], v[64:67], v[80:83], v[160:175]
    v_mfma_f32_32x32x16_bf16 v[224:239], v[68:71], v[80:83], v[224:239]
    v_mfma_f32_32x32x16_bf16 v[176:191], v[64:67], v[84:87], v[176:191]
    v_mfma_f32_32x32x16_bf16 v[240:255], v[68:71], v[84:87], v[240:255]
    s_waitcnt lgkmcnt(0)
    v_mfma_f32_32x32x16_bf16 v[128:143], v[88:91], v[96:99], v[128:143]
    ds_read_b64_tr_b16 v[64:65], v24 offset:16384
    ds_read_b64_tr_b16 v[66:67], v24 offset:18432
    v_mfma_f32_32x32x16_bf16 v[192:207], v[92:95], v[96:99], v[192:207]
    ds_read_b128 v[72:75], v30 offset:0
    ds_read_b64_tr_b16 v[68:69], v25 offset:16384
    v_mfma_f32_32x32x16_bf16 v[144:159], v[88:91], v[100:103], v[144:159]
    ds_read_b64_tr_b16 v[70:71], v25 offset:18432
    ds_read_b128 v[76:79], v30 offset:4096
    v_mfma_f32_32x32x16_bf16 v[208:223], v[92:95], v[100:103], v[208:223]
    ds_read_b128 v[80:83], v30 offset:8192
    ds_read_b128 v[84:87], v30 offset:12288
    v_mfma_f32_32x32x16_bf16 v[160:175], v[88:91], v[104:107], v[160:175]
    v_mfma_f32_32x32x16_bf16 v[224:239], v[92:95], v[104:107], v[224:239]
    v_mfma_f32_32x32x16_bf16 v[176:191], v[88:91], v[108:111], v[176:191]
    v_mfma_f32_32x32x16_bf16 v[240:255], v[92:95], v[108:111], v[240:255]
    s_waitcnt lgkmcnt(0)
    v_mfma_f32_32x32x16_bf16 v[128:143], v[64:67], v[72:75], v[128:143]
    ds_read_b64_tr_b16 v[88:89], v24 offset:24576
    ds_read_b64_tr_b16 v[90:91], v24 offset:26624
    v_mfma_f32_32x32x16_bf16 v[192:207], v[68:71], v[72:75], v[192:207]
    ds_read_b128 v[96:99], v31 offset:0
    ds_read_b64_tr_b16 v[92:93], v25 offset:24576
    v_mfma_f32_32x32x16_bf16 v[144:159], v[64:67], v[76:79], v[144:159]
    ds_read_b64_tr_b16 v[94:95], v25 offset:26624
    ds_read_b128 v[100:103], v31 offset:4096
    v_mfma_f32_32x32x16_bf16 v[208:223], v[68:71], v[76:79], v[208:223]
    ds_read_b128 v[104:107], v31 offset:8192
    ds_read_b128 v[108:111], v31 offset:12288
    v_mfma_f32_32x32x16_bf16 v[160:175], v[64:67], v[80:83], v[160:175]
    v_mfma_f32_32x32x16_bf16 v[224:239], v[68:71], v[80:83], v[224:239]
    v_mfma_f32_32x32x16_bf16 v[176:191], v[64:67], v[84:87], v[176:191]
    v_mfma_f32_32x32x16_bf16 v[240:255], v[68:71], v[84:87], v[240:255]
    s_waitcnt vmcnt(0) lgkmcnt(0)
    s_barrier
    s_lshl_b32 s84, s25, 8
    s_add_u32 s84, s84, s2
    s_cmp_lt_u32 s84, 640
    s_cbranch_scc0 L_pf_kv0_0
    s_load_dwordx2 s[86:87], s[0:1], 16
    s_sub_u32 s85, s84, 0
    s_lshl_b32 s85, s85, 13
    v_lshlrev_b32 v61, 7, v2
    s_waitcnt lgkmcnt(0)
    s_mov_b32 s76, s86
    s_mov_b32 s77, s87
    s_mov_b32 s78, 0x500000
    s_mov_b32 s79, 0x00020000
    buffer_load_dword v60, v61, s[76:79], s85 offen sc1
L_pf_kv0_0:
    v_mfma_f32_32x32x16_bf16 v[128:143], v[88:91], v[96:99], v[128:143]
    ds_read_b64_tr_b16 v[64:65], v26 offset:0
    ds_read_b64_tr_b16 v[66:67], v26 offset:2048
    ds_read_b128 v[72:75], v32 offset:0
    ds_read_b64_tr_b16 v[68:69], v27 offset:0
    v_mfma_f32_32x32x16_bf16 v[192:207], v[92:95], v[96:99], v[192:207]
    ds_read_b64_tr_b16 v[70:71], v27 offset:2048
    ds_read_b128 v[76:79], v32 offset:4096
    ds_read_b128 v[80:83], v32 offset:8192
    ds_read_b128 v[84:87], v32 offset:12288
    v_mfma_f32_32x32x16_bf16 v[144:159], v[88:91], v[100:103], v[144:159]
    s_add_u32 m0, s53, 0
    s_add_u32 s54, s51, 2097152
    buffer_load_dwordx4 v6, s[28:31], s54 offen sc1 lds
    s_add_u32 m0, s53, 8192
    v_mfma_f32_32x32x16_bf16 v[208:223], v[92:95], v[100:103], v[208:223]
    s_add_u32 s54, s51, 2228224
    buffer_load_dwordx4 v6, s[28:31], s54 offen sc1 lds
    s_add_u32 m0, s53, 16384
    s_add_u32 s54, s51, 2359296
    v_mfma_f32_32x32x16_bf16 v[160:175], v[88:91], v[104:107], v[160:175]
    buffer_load_dwordx4 v6, s[28:31], s54 offen sc1 lds
    s_add_u32 m0, s53, 24576
    s_add_u32 s54, s51, 2490368
    buffer_load_dwordx4 v6, s[28:31], s54 offen sc1 lds
    v_mfma_f32_32x32x16_bf16 v[224:239], v[92:95], v[104:107], v[224:239]
    s_add_u32 m0, s53, 32768
    s_add_u32 s54, s52, 512
    buffer_load_dwordx4 v10, s[32:35], s54 offen sc1 lds
    s_add_u32 m0, s53, 40960
    v_mfma_f32_32x32x16_bf16 v[176:191], v[88:91], v[108:111], v[176:191]
    s_add_u32 s54, s52, 66048
    buffer_load_dwordx4 v10, s[32:35], s54 offen sc1 lds
    s_add_u32 m0, s53, 49152
    s_add_u32 s54, s52, 131584
    v_mfma_f32_32x32x16_bf16 v[240:255], v[92:95], v[108:111], v[240:255]
    buffer_load_dwordx4 v10, s[32:35], s54 offen sc1 lds
    s_add_u32 m0, s53, 57344
    s_add_u32 s54, s52, 197120
    buffer_load_dwordx4 v10, s[32:35], s54 offen sc1 lds
    s_waitcnt lgkmcnt(0)
    v_mfma_f32_32x32x16_bf16 v[128:143], v[64:67], v[72:75], v[128:143]
    ds_read_b64_tr_b16 v[88:89], v26 offset:8192
    ds_read_b64_tr_b16 v[90:91], v26 offset:10240
    v_mfma_f32_32x32x16_bf16 v[192:207], v[68:71], v[72:75], v[192:207]
    ds_read_b128 v[96:99], v33 offset:0
    ds_read_b64_tr_b16 v[92:93], v27 offset:8192
    v_mfma_f32_32x32x16_bf16 v[144:159], v[64:67], v[76:79], v[144:159]
    ds_read_b64_tr_b16 v[94:95], v27 offset:10240
    ds_read_b128 v[100:103], v33 offset:4096
    v_mfma_f32_32x32x16_bf16 v[208:223], v[68:71], v[76:79], v[208:223]
    ds_read_b128 v[104:107], v33 offset:8192
    ds_read_b128 v[108:111], v33 offset:12288
    v_mfma_f32_32x32x16_bf16 v[160:175], v[64:67], v[80:83], v[160:175]
    v_mfma_f32_32x32x16_bf16 v[224:239], v[68:71], v[80:83], v[224:239]
    v_mfma_f32_32x32x16_bf16 v[176:191], v[64:67], v[84:87], v[176:191]
    v_mfma_f32_32x32x16_bf16 v[240:255], v[68:71], v[84:87], v[240:255]
    s_waitcnt lgkmcnt(0)
    v_mfma_f32_32x32x16_bf16 v[128:143], v[88:91], v[96:99], v[128:143]
    ds_read_b64_tr_b16 v[64:65], v26 offset:16384
    ds_read_b64_tr_b16 v[66:67], v26 offset:18432
    v_mfma_f32_32x32x16_bf16 v[192:207], v[92:95], v[96:99], v[192:207]
    ds_read_b128 v[72:75], v34 offset:0
    ds_read_b64_tr_b16 v[68:69], v27 offset:16384
    v_mfma_f32_32x32x16_bf16 v[144:159], v[88:91], v[100:103], v[144:159]
    ds_read_b64_tr_b16 v[70:71], v27 offset:18432
    ds_read_b128 v[76:79], v34 offset:4096
    v_mfma_f32_32x32x16_bf16 v[208:223], v[92:95], v[100:103], v[208:223]
    ds_read_b128 v[80:83], v34 offset:8192
    ds_read_b128 v[84:87], v34 offset:12288
    v_mfma_f32_32x32x16_bf16 v[160:175], v[88:91], v[104:107], v[160:175]
    v_mfma_f32_32x32x16_bf16 v[224:239], v[92:95], v[104:107], v[224:239]
    v_mfma_f32_32x32x16_bf16 v[176:191], v[88:91], v[108:111], v[176:191]
    v_mfma_f32_32x32x16_bf16 v[240:255], v[92:95], v[108:111], v[240:255]
    s_waitcnt lgkmcnt(0)
    v_mfma_f32_32x32x16_bf16 v[128:143], v[64:67], v[72:75], v[128:143]
    ds_read_b64_tr_b16 v[88:89], v26 offset:24576
    ds_read_b64_tr_b16 v[90:91], v26 offset:26624
    v_mfma_f32_32x32x16_bf16 v[192:207], v[68:71], v[72:75], v[192:207]
    ds_read_b128 v[96:99], v35 offset:0
    ds_read_b64_tr_b16 v[92:93], v27 offset:24576
    v_mfma_f32_32x32x16_bf16 v[144:159], v[64:67], v[76:79], v[144:159]
    ds_read_b64_tr_b16 v[94:95], v27 offset:26624
    ds_read_b128 v[100:103], v35 offset:4096
    v_mfma_f32_32x32x16_bf16 v[208:223], v[68:71], v[76:79], v[208:223]
    ds_read_b128 v[104:107], v35 offset:8192
    ds_read_b128 v[108:111], v35 offset:12288
    v_mfma_f32_32x32x16_bf16 v[160:175], v[64:67], v[80:83], v[160:175]
    v_mfma_f32_32x32x16_bf16 v[224:239], v[68:71], v[80:83], v[224:239]
    v_mfma_f32_32x32x16_bf16 v[176:191], v[64:67], v[84:87], v[176:191]
    v_mfma_f32_32x32x16_bf16 v[240:255], v[68:71], v[84:87], v[240:255]
    s_waitcnt vmcnt(0) lgkmcnt(0)
    s_barrier
    v_mfma_f32_32x32x16_bf16 v[128:143], v[88:91], v[96:99], v[128:143]
    ds_read_b64_tr_b16 v[64:65], v24 offset:0
    ds_read_b64_tr_b16 v[66:67], v24 offset:2048
    ds_read_b128 v[72:75], v28 offset:0
    ds_read_b64_tr_b16 v[68:69], v25 offset:0
    v_mfma_f32_32x32x16_bf16 v[192:207], v[92:95], v[96:99], v[192:207]
    ds_read_b64_tr_b16 v[70:71], v25 offset:2048
    ds_read_b128 v[76:79], v28 offset:4096
    ds_read_b128 v[80:83], v28 offset:8192
    ds_read_b128 v[84:87], v28 offset:12288
    v_mfma_f32_32x32x16_bf16 v[144:159], v[88:91], v[100:103], v[144:159]
    s_add_u32 m0, s53, 65536
    s_add_u32 s54, s51, 2621440
    buffer_load_dwordx4 v6, s[28:31], s54 offen sc1 lds
    s_add_u32 m0, s53, 73728
    v_mfma_f32_32x32x16_bf16 v[208:223], v[92:95], v[100:103], v[208:223]
    s_add_u32 s54, s51, 2752512
    buffer_load_dwordx4 v6, s[28:31], s54 offen sc1 lds
    s_add_u32 m0, s53, 81920
    s_add_u32 s54, s51, 2883584
    v_mfma_f32_32x32x16_bf16 v[160:175], v[88:91], v[104:107], v[160:175]
    buffer_load_dwordx4 v6, s[28:31], s54 offen sc1 lds
    s_add_u32 m0, s53, 90112
    s_add_u32 s54, s51, 3014656
    buffer_load_dwordx4 v6, s[28:31], s54 offen sc1 lds
    v_mfma_f32_32x32x16_bf16 v[224:239], v[92:95], v[104:107], v[224:239]
    s_add_u32 m0, s53, 98304
    s_add_u32 s54, s52, 640
    buffer_load_dwordx4 v10, s[32:35], s54 offen sc1 lds
    s_add_u32 m0, s53, 106496
    v_mfma_f32_32x32x16_bf16 v[176:191], v[88:91], v[108:111], v[176:191]
    s_add_u32 s54, s52, 66176
    buffer_load_dwordx4 v10, s[32:35], s54 offen sc1 lds
    s_add_u32 m0, s53, 114688
    s_add_u32 s54, s52, 131712
    v_mfma_f32_32x32x16_bf16 v[240:255], v[92:95], v[108:111], v[240:255]
    buffer_load_dwordx4 v10, s[32:35], s54 offen sc1 lds
    s_add_u32 m0, s53, 122880
    s_add_u32 s54, s52, 197248
    buffer_load_dwordx4 v10, s[32:35], s54 offen sc1 lds
    s_waitcnt lgkmcnt(0)
    v_mfma_f32_32x32x16_bf16 v[128:143], v[64:67], v[72:75], v[128:143]
    ds_read_b64_tr_b16 v[88:89], v24 offset:8192
    ds_read_b64_tr_b16 v[90:91], v24 offset:10240
    v_mfma_f32_32x32x16_bf16 v[192:207], v[68:71], v[72:75], v[192:207]
    ds_read_b128 v[96:99], v29 offset:0
    ds_read_b64_tr_b16 v[92:93], v25 offset:8192
    v_mfma_f32_32x32x16_bf16 v[144:159], v[64:67], v[76:79], v[144:159]
    ds_read_b64_tr_b16 v[94:95], v25 offset:10240
    ds_read_b128 v[100:103], v29 offset:4096
    v_mfma_f32_32x32x16_bf16 v[208:223], v[68:71], v[76:79], v[208:223]
    ds_read_b128 v[104:107], v29 offset:8192
    ds_read_b128 v[108:111], v29 offset:12288
    v_mfma_f32_32x32x16_bf16 v[160:175], v[64:67], v[80:83], v[160:175]
    v_mfma_f32_32x32x16_bf16 v[224:239], v[68:71], v[80:83], v[224:239]
    v_mfma_f32_32x32x16_bf16 v[176:191], v[64:67], v[84:87], v[176:191]
    v_mfma_f32_32x32x16_bf16 v[240:255], v[68:71], v[84:87], v[240:255]
    s_waitcnt lgkmcnt(0)
    v_mfma_f32_32x32x16_bf16 v[128:143], v[88:91], v[96:99], v[128:143]
    ds_read_b64_tr_b16 v[64:65], v24 offset:16384
    ds_read_b64_tr_b16 v[66:67], v24 offset:18432
    v_mfma_f32_32x32x16_bf16 v[192:207], v[92:95], v[96:99], v[192:207]
    ds_read_b128 v[72:75], v30 offset:0
    ds_read_b64_tr_b16 v[68:69], v25 offset:16384
    v_mfma_f32_32x32x16_bf16 v[144:159], v[88:91], v[100:103], v[144:159]
    ds_read_b64_tr_b16 v[70:71], v25 offset:18432
    ds_read_b128 v[76:79], v30 offset:4096
    v_mfma_f32_32x32x16_bf16 v[208:223], v[92:95], v[100:103], v[208:223]
    ds_read_b128 v[80:83], v30 offset:8192
    ds_read_b128 v[84:87], v30 offset:12288
    v_mfma_f32_32x32x16_bf16 v[160:175], v[88:91], v[104:107], v[160:175]
    v_mfma_f32_32x32x16_bf16 v[224:239], v[92:95], v[104:107], v[224:239]
    v_mfma_f32_32x32x16_bf16 v[176:191], v[88:91], v[108:111], v[176:191]
    v_mfma_f32_32x32x16_bf16 v[240:255], v[92:95], v[108:111], v[240:255]
    s_waitcnt lgkmcnt(0)
    v_mfma_f32_32x32x16_bf16 v[128:143], v[64:67], v[72:75], v[128:143]
    ds_read_b64_tr_b16 v[88:89], v24 offset:24576
    ds_read_b64_tr_b16 v[90:91], v24 offset:26624
    v_mfma_f32_32x32x16_bf16 v[192:207], v[68:71], v[72:75], v[192:207]
    ds_read_b128 v[96:99], v31 offset:0
    ds_read_b64_tr_b16 v[92:93], v25 offset:24576
    v_mfma_f32_32x32x16_bf16 v[144:159], v[64:67], v[76:79], v[144:159]
    ds_read_b64_tr_b16 v[94:95], v25 offset:26624
    ds_read_b128 v[100:103], v31 offset:4096
    v_mfma_f32_32x32x16_bf16 v[208:223], v[68:71], v[76:79], v[208:223]
    ds_read_b128 v[104:107], v31 offset:8192
    ds_read_b128 v[108:111], v31 offset:12288
    v_mfma_f32_32x32x16_bf16 v[160:175], v[64:67], v[80:83], v[160:175]
    v_mfma_f32_32x32x16_bf16 v[224:239], v[68:71], v[80:83], v[224:239]
    v_mfma_f32_32x32x16_bf16 v[176:191], v[64:67], v[84:87], v[176:191]
    v_mfma_f32_32x32x16_bf16 v[240:255], v[68:71], v[84:87], v[240:255]
    s_waitcnt vmcnt(0) lgkmcnt(0)
    s_barrier
    v_mfma_f32_32x32x16_bf16 v[128:143], v[88:91], v[96:99], v[128:143]
    ds_read_b64_tr_b16 v[64:65], v26 offset:0
    ds_read_b64_tr_b16 v[66:67], v26 offset:2048
    ds_read_b128 v[72:75], v32 offset:0
    ds_read_b64_tr_b16 v[68:69], v27 offset:0
    v_mfma_f32_32x32x16_bf16 v[192:207], v[92:95], v[96:99], v[192:207]
    ds_read_b64_tr_b16 v[70:71], v27 offset:2048
    ds_read_b128 v[76:79], v32 offset:4096
    ds_read_b128 v[80:83], v32 offset:8192
    ds_read_b128 v[84:87], v32 offset:12288
    v_mfma_f32_32x32x16_bf16 v[144:159], v[88:91], v[100:103], v[144:159]
    s_add_u32 m0, s53, 0
    s_add_u32 s54, s51, 3145728
    buffer_load_dwordx4 v6, s[28:31], s54 offen sc1 lds
    s_add_u32 m0, s53, 8192
    v_mfma_f32_32x32x16_bf16 v[208:223], v[92:95], v[100:103], v[208:223]
    s_add_u32 s54, s51, 3276800
    buffer_load_dwordx4 v6, s[28:31], s54 offen sc1 lds
    s_add_u32 m0, s53, 16384
    s_add_u32 s54, s51, 3407872
    v_mfma_f32_32x32x16_bf16 v[160:175], v[88:91], v[104:107], v[160:175]
    buffer_load_dwordx4 v6, s[28:31], s54 offen sc1 lds
    s_add_u32 m0, s53, 24576
    s_add_u32 s54, s51, 3538944
    buffer_load_dwordx4 v6, s[28:31], s54 offen sc1 lds
    v_mfma_f32_32x32x16_bf16 v[224:239], v[92:95], v[104:107], v[224:239]
    s_add_u32 m0, s53, 32768
    s_add_u32 s54, s52, 768
    buffer_load_dwordx4 v10, s[32:35], s54 offen sc1 lds
    s_add_u32 m0, s53, 40960
    v_mfma_f32_32x32x16_bf16 v[176:191], v[88:91], v[108:111], v[176:191]
    s_add_u32 s54, s52, 66304
    buffer_load_dwordx4 v10, s[32:35], s54 offen sc1 lds
    s_add_u32 m0, s53, 49152
    s_add_u32 s54, s52, 131840
    v_mfma_f32_32x32x16_bf16 v[240:255], v[92:95], v[108:111], v[240:255]
    buffer_load_dwordx4 v10, s[32:35], s54 offen sc1 lds
    s_add_u32 m0, s53, 57344
    s_add_u32 s54, s52, 197376
    buffer_load_dwordx4 v10, s[32:35], s54 offen sc1 lds
    s_waitcnt lgkmcnt(0)
    v_mfma_f32_32x32x16_bf16 v[128:143], v[64:67], v[72:75], v[128:143]
    ds_read_b64_tr_b16 v[88:89], v26 offset:8192
    ds_read_b64_tr_b16 v[90:91], v26 offset:10240
    v_mfma_f32_32x32x16_bf16 v[192:207], v[68:71], v[72:75], v[192:207]
    ds_read_b128 v[96:99], v33 offset:0
    ds_read_b64_tr_b16 v[92:93], v27 offset:8192
    v_mfma_f32_32x32x16_bf16 v[144:159], v[64:67], v[76:79], v[144:159]
    ds_read_b64_tr_b16 v[94:95], v27 offset:10240
    ds_read_b128 v[100:103], v33 offset:4096
    v_mfma_f32_32x32x16_bf16 v[208:223], v[68:71], v[76:79], v[208:223]
    ds_read_b128 v[104:107], v33 offset:8192
    ds_read_b128 v[108:111], v33 offset:12288
    v_mfma_f32_32x32x16_bf16 v[160:175], v[64:67], v[80:83], v[160:175]
    v_mfma_f32_32x32x16_bf16 v[224:239], v[68:71], v[80:83], v[224:239]
    v_mfma_f32_32x32x16_bf16 v[176:191], v[64:67], v[84:87], v[176:191]
    v_mfma_f32_32x32x16_bf16 v[240:255], v[68:71], v[84:87], v[240:255]
    s_waitcnt lgkmcnt(0)
    v_mfma_f32_32x32x16_bf16 v[128:143], v[88:91], v[96:99], v[128:143]
    ds_read_b64_tr_b16 v[64:65], v26 offset:16384
    ds_read_b64_tr_b16 v[66:67], v26 offset:18432
    v_mfma_f32_32x32x16_bf16 v[192:207], v[92:95], v[96:99], v[192:207]
    ds_read_b128 v[72:75], v34 offset:0
    ds_read_b64_tr_b16 v[68:69], v27 offset:16384
    v_mfma_f32_32x32x16_bf16 v[144:159], v[88:91], v[100:103], v[144:159]
    ds_read_b64_tr_b16 v[70:71], v27 offset:18432
    ds_read_b128 v[76:79], v34 offset:4096
    v_mfma_f32_32x32x16_bf16 v[208:223], v[92:95], v[100:103], v[208:223]
    ds_read_b128 v[80:83], v34 offset:8192
    ds_read_b128 v[84:87], v34 offset:12288
    v_mfma_f32_32x32x16_bf16 v[160:175], v[88:91], v[104:107], v[160:175]
    v_mfma_f32_32x32x16_bf16 v[224:239], v[92:95], v[104:107], v[224:239]
    v_mfma_f32_32x32x16_bf16 v[176:191], v[88:91], v[108:111], v[176:191]
    v_mfma_f32_32x32x16_bf16 v[240:255], v[92:95], v[108:111], v[240:255]
    s_waitcnt lgkmcnt(0)
    v_mfma_f32_32x32x16_bf16 v[128:143], v[64:67], v[72:75], v[128:143]
    ds_read_b64_tr_b16 v[88:89], v26 offset:24576
    ds_read_b64_tr_b16 v[90:91], v26 offset:26624
    v_mfma_f32_32x32x16_bf16 v[192:207], v[68:71], v[72:75], v[192:207]
    ds_read_b128 v[96:99], v35 offset:0
    ds_read_b64_tr_b16 v[92:93], v27 offset:24576
    v_mfma_f32_32x32x16_bf16 v[144:159], v[64:67], v[76:79], v[144:159]
    ds_read_b64_tr_b16 v[94:95], v27 offset:26624
    ds_read_b128 v[100:103], v35 offset:4096
    v_mfma_f32_32x32x16_bf16 v[208:223], v[68:71], v[76:79], v[208:223]
    ds_read_b128 v[104:107], v35 offset:8192
    ds_read_b128 v[108:111], v35 offset:12288
    v_mfma_f32_32x32x16_bf16 v[160:175], v[64:67], v[80:83], v[160:175]
    v_mfma_f32_32x32x16_bf16 v[224:239], v[68:71], v[80:83], v[224:239]
    v_mfma_f32_32x32x16_bf16 v[176:191], v[64:67], v[84:87], v[176:191]
    v_mfma_f32_32x32x16_bf16 v[240:255], v[68:71], v[84:87], v[240:255]
    s_waitcnt vmcnt(0) lgkmcnt(0)
    s_barrier
    v_mfma_f32_32x32x16_bf16 v[128:143], v[88:91], v[96:99], v[128:143]
    ds_read_b64_tr_b16 v[64:65], v24 offset:0
    ds_read_b64_tr_b16 v[66:67], v24 offset:2048
    ds_read_b128 v[72:75], v28 offset:0
    ds_read_b64_tr_b16 v[68:69], v25 offset:0
    v_mfma_f32_32x32x16_bf16 v[192:207], v[92:95], v[96:99], v[192:207]
    ds_read_b64_tr_b16 v[70:71], v25 offset:2048
    ds_read_b128 v[76:79], v28 offset:4096
    ds_read_b128 v[80:83], v28 offset:8192
    ds_read_b128 v[84:87], v28 offset:12288
    v_mfma_f32_32x32x16_bf16 v[144:159], v[88:91], v[100:103], v[144:159]
    s_add_u32 m0, s53, 65536
    s_add_u32 s54, s51, 3670016
    buffer_load_dwordx4 v6, s[28:31], s54 offen sc1 lds
    s_add_u32 m0, s53, 73728
    v_mfma_f32_32x32x16_bf16 v[208:223], v[92:95], v[100:103], v[208:223]
    s_add_u32 s54, s51, 3801088
    buffer_load_dwordx4 v6, s[28:31], s54 offen sc1 lds
    s_add_u32 m0, s53, 81920
    s_add_u32 s54, s51, 3932160
    v_mfma_f32_32x32x16_bf16 v[160:175], v[88:91], v[104:107], v[160:175]
    buffer_load_dwordx4 v6, s[28:31], s54 offen sc1 lds
    s_add_u32 m0, s53, 90112
    s_add_u32 s54, s51, 4063232
    buffer_load_dwordx4 v6, s[28:31], s54 offen sc1 lds
    v_mfma_f32_32x32x16_bf16 v[224:239], v[92:95], v[104:107], v[224:239]
    s_add_u32 m0, s53, 98304
    s_add_u32 s54, s52, 896
    buffer_load_dwordx4 v10, s[32:35], s54 offen sc1 lds
    s_add_u32 m0, s53, 106496
    v_mfma_f32_32x32x16_bf16 v[176:191], v[88:91], v[108:111], v[176:191]
    s_add_u32 s54, s52, 66432
    buffer_load_dwordx4 v10, s[32:35], s54 offen sc1 lds
    s_add_u32 m0, s53, 114688
    s_add_u32 s54, s52, 131968
    v_mfma_f32_32x32x16_bf16 v[240:255], v[92:95], v[108:111], v[240:255]
    buffer_load_dwordx4 v10, s[32:35], s54 offen sc1 lds
    s_add_u32 m0, s53, 122880
    s_add_u32 s54, s52, 197504
    buffer_load_dwordx4 v10, s[32:35], s54 offen sc1 lds
    s_waitcnt lgkmcnt(0)
    v_mfma_f32_32x32x16_bf16 v[128:143], v[64:67], v[72:75], v[128:143]
    ds_read_b64_tr_b16 v[88:89], v24 offset:8192
    ds_read_b64_tr_b16 v[90:91], v24 offset:10240
    v_mfma_f32_32x32x16_bf16 v[192:207], v[68:71], v[72:75], v[192:207]
    ds_read_b128 v[96:99], v29 offset:0
    ds_read_b64_tr_b16 v[92:93], v25 offset:8192
    v_mfma_f32_32x32x16_bf16 v[144:159], v[64:67], v[76:79], v[144:159]
    ds_read_b64_tr_b16 v[94:95], v25 offset:10240
    ds_read_b128 v[100:103], v29 offset:4096
    v_mfma_f32_32x32x16_bf16 v[208:223], v[68:71], v[76:79], v[208:223]
    ds_read_b128 v[104:107], v29 offset:8192
    ds_read_b128 v[108:111], v29 offset:12288
    v_mfma_f32_32x32x16_bf16 v[160:175], v[64:67], v[80:83], v[160:175]
    v_mfma_f32_32x32x16_bf16 v[224:239], v[68:71], v[80:83], v[224:239]
    v_mfma_f32_32x32x16_bf16 v[176:191], v[64:67], v[84:87], v[176:191]
    v_mfma_f32_32x32x16_bf16 v[240:255], v[68:71], v[84:87], v[240:255]
    s_waitcnt lgkmcnt(0)
    v_mfma_f32_32x32x16_bf16 v[128:143], v[88:91], v[96:99], v[128:143]
    ds_read_b64_tr_b16 v[64:65], v24 offset:16384
    ds_read_b64_tr_b16 v[66:67], v24 offset:18432
    v_mfma_f32_32x32x16_bf16 v[192:207], v[92:95], v[96:99], v[192:207]
    ds_read_b128 v[72:75], v30 offset:0
    ds_read_b64_tr_b16 v[68:69], v25 offset:16384
    v_mfma_f32_32x32x16_bf16 v[144:159], v[88:91], v[100:103], v[144:159]
    ds_read_b64_tr_b16 v[70:71], v25 offset:18432
    ds_read_b128 v[76:79], v30 offset:4096
    v_mfma_f32_32x32x16_bf16 v[208:223], v[92:95], v[100:103], v[208:223]
    ds_read_b128 v[80:83], v30 offset:8192
    ds_read_b128 v[84:87], v30 offset:12288
    v_mfma_f32_32x32x16_bf16 v[160:175], v[88:91], v[104:107], v[160:175]
    v_mfma_f32_32x32x16_bf16 v[224:239], v[92:95], v[104:107], v[224:239]
    v_mfma_f32_32x32x16_bf16 v[176:191], v[88:91], v[108:111], v[176:191]
    v_mfma_f32_32x32x16_bf16 v[240:255], v[92:95], v[108:111], v[240:255]
    s_waitcnt lgkmcnt(0)
    v_mfma_f32_32x32x16_bf16 v[128:143], v[64:67], v[72:75], v[128:143]
    ds_read_b64_tr_b16 v[88:89], v24 offset:24576
    ds_read_b64_tr_b16 v[90:91], v24 offset:26624
    v_mfma_f32_32x32x16_bf16 v[192:207], v[68:71], v[72:75], v[192:207]
    ds_read_b128 v[96:99], v31 offset:0
    ds_read_b64_tr_b16 v[92:93], v25 offset:24576
    v_mfma_f32_32x32x16_bf16 v[144:159], v[64:67], v[76:79], v[144:159]
    ds_read_b64_tr_b16 v[94:95], v25 offset:26624
    ds_read_b128 v[100:103], v31 offset:4096
    v_mfma_f32_32x32x16_bf16 v[208:223], v[68:71], v[76:79], v[208:223]
    ds_read_b128 v[104:107], v31 offset:8192
    ds_read_b128 v[108:111], v31 offset:12288
    v_mfma_f32_32x32x16_bf16 v[160:175], v[64:67], v[80:83], v[160:175]
    v_mfma_f32_32x32x16_bf16 v[224:239], v[68:71], v[80:83], v[224:239]
    v_mfma_f32_32x32x16_bf16 v[176:191], v[64:67], v[84:87], v[176:191]
    v_mfma_f32_32x32x16_bf16 v[240:255], v[68:71], v[84:87], v[240:255]
    s_waitcnt vmcnt(0) lgkmcnt(0)
    s_barrier
    v_mfma_f32_32x32x16_bf16 v[128:143], v[88:91], v[96:99], v[128:143]
    ds_read_b64_tr_b16 v[64:65], v26 offset:0
    ds_read_b64_tr_b16 v[66:67], v26 offset:2048
    ds_read_b128 v[72:75], v32 offset:0
    ds_read_b64_tr_b16 v[68:69], v27 offset:0
    v_mfma_f32_32x32x16_bf16 v[192:207], v[92:95], v[96:99], v[192:207]
    ds_read_b64_tr_b16 v[70:71], v27 offset:2048
    ds_read_b128 v[76:79], v32 offset:4096
    ds_read_b128 v[80:83], v32 offset:8192
    ds_read_b128 v[84:87], v32 offset:12288
    v_mfma_f32_32x32x16_bf16 v[144:159], v[88:91], v[100:103], v[144:159]
    v_mfma_f32_32x32x16_bf16 v[208:223], v[92:95], v[100:103], v[208:223]
    v_mfma_f32_32x32x16_bf16 v[160:175], v[88:91], v[104:107], v[160:175]
    v_mfma_f32_32x32x16_bf16 v[224:239], v[92:95], v[104:107], v[224:239]
    v_mfma_f32_32x32x16_bf16 v[176:191], v[88:91], v[108:111], v[176:191]
    v_mfma_f32_32x32x16_bf16 v[240:255], v[92:95], v[108:111], v[240:255]
    s_waitcnt lgkmcnt(0)
    v_mfma_f32_32x32x16_bf16 v[128:143], v[64:67], v[72:75], v[128:143]
    ds_read_b64_tr_b16 v[88:89], v26 offset:8192
    ds_read_b64_tr_b16 v[90:91], v26 offset:10240
    v_mfma_f32_32x32x16_bf16 v[192:207], v[68:71], v[72:75], v[192:207]
    ds_read_b128 v[96:99], v33 offset:0
    ds_read_b64_tr_b16 v[92:93], v27 offset:8192
    v_mfma_f32_32x32x16_bf16 v[144:159], v[64:67], v[76:79], v[144:159]
    ds_read_b64_tr_b16 v[94:95], v27 offset:10240
    ds_read_b128 v[100:103], v33 offset:4096
    v_mfma_f32_32x32x16_bf16 v[208:223], v[68:71], v[76:79], v[208:223]
    ds_read_b128 v[104:107], v33 offset:8192
    ds_read_b128 v[108:111], v33 offset:12288
    v_mfma_f32_32x32x16_bf16 v[160:175], v[64:67], v[80:83], v[160:175]
    v_mfma_f32_32x32x16_bf16 v[224:239], v[68:71], v[80:83], v[224:239]
    v_mfma_f32_32x32x16_bf16 v[176:191], v[64:67], v[84:87], v[176:191]
    v_mfma_f32_32x32x16_bf16 v[240:255], v[68:71], v[84:87], v[240:255]
    s_waitcnt lgkmcnt(0)
    v_mfma_f32_32x32x16_bf16 v[128:143], v[88:91], v[96:99], v[128:143]
    ds_read_b64_tr_b16 v[64:65], v26 offset:16384
    ds_read_b64_tr_b16 v[66:67], v26 offset:18432
    v_mfma_f32_32x32x16_bf16 v[192:207], v[92:95], v[96:99], v[192:207]
    ds_read_b128 v[72:75], v34 offset:0
    ds_read_b64_tr_b16 v[68:69], v27 offset:16384
    v_mfma_f32_32x32x16_bf16 v[144:159], v[88:91], v[100:103], v[144:159]
    ds_read_b64_tr_b16 v[70:71], v27 offset:18432
    ds_read_b128 v[76:79], v34 offset:4096
    v_mfma_f32_32x32x16_bf16 v[208:223], v[92:95], v[100:103], v[208:223]
    ds_read_b128 v[80:83], v34 offset:8192
    ds_read_b128 v[84:87], v34 offset:12288
    v_mfma_f32_32x32x16_bf16 v[160:175], v[88:91], v[104:107], v[160:175]
    v_mfma_f32_32x32x16_bf16 v[224:239], v[92:95], v[104:107], v[224:239]
    v_mfma_f32_32x32x16_bf16 v[176:191], v[88:91], v[108:111], v[176:191]
    v_mfma_f32_32x32x16_bf16 v[240:255], v[92:95], v[108:111], v[240:255]
    s_waitcnt lgkmcnt(0)
    v_mfma_f32_32x32x16_bf16 v[128:143], v[64:67], v[72:75], v[128:143]
    ds_read_b64_tr_b16 v[88:89], v26 offset:24576
    ds_read_b64_tr_b16 v[90:91], v26 offset:26624
    v_mfma_f32_32x32x16_bf16 v[192:207], v[68:71], v[72:75], v[192:207]
    ds_read_b128 v[96:99], v35 offset:0
    ds_read_b64_tr_b16 v[92:93], v27 offset:24576
    v_mfma_f32_32x32x16_bf16 v[144:159], v[64:67], v[76:79], v[144:159]
    ds_read_b64_tr_b16 v[94:95], v27 offset:26624
    ds_read_b128 v[100:103], v35 offset:4096
    v_mfma_f32_32x32x16_bf16 v[208:223], v[68:71], v[76:79], v[208:223]
    ds_read_b128 v[104:107], v35 offset:8192
    ds_read_b128 v[108:111], v35 offset:12288
    v_mfma_f32_32x32x16_bf16 v[160:175], v[64:67], v[80:83], v[160:175]
    v_mfma_f32_32x32x16_bf16 v[224:239], v[68:71], v[80:83], v[224:239]
    v_mfma_f32_32x32x16_bf16 v[176:191], v[64:67], v[84:87], v[176:191]
    v_mfma_f32_32x32x16_bf16 v[240:255], v[68:71], v[84:87], v[240:255]
    s_waitcnt lgkmcnt(0)
    v_mfma_f32_32x32x16_bf16 v[128:143], v[88:91], v[96:99], v[128:143]
    v_mfma_f32_32x32x16_bf16 v[192:207], v[92:95], v[96:99], v[192:207]
    v_mfma_f32_32x32x16_bf16 v[144:159], v[88:91], v[100:103], v[144:159]
    v_mfma_f32_32x32x16_bf16 v[208:223], v[92:95], v[100:103], v[208:223]
    v_mfma_f32_32x32x16_bf16 v[160:175], v[88:91], v[104:107], v[160:175]
    v_mfma_f32_32x32x16_bf16 v[224:239], v[92:95], v[104:107], v[224:239]
    v_mfma_f32_32x32x16_bf16 v[176:191], v[88:91], v[108:111], v[176:191]
    v_mfma_f32_32x32x16_bf16 v[240:255], v[92:95], v[108:111], v[240:255]
    s_lshr_b32 s55, s25, 1
    s_and_b32 s55, s55, 1
    s_lshl_b32 s58, s24, 1
    s_add_u32 s58, s58, s55
    s_lshl_b32 s58, s58, 5
    s_lshl_b32 s59, s22, 2
    s_add_u32 s58, s58, s59
    s_lshr_b32 s59, s25, 2
    s_lshl_b32 s59, s59, 1
    s_add_u32 s58, s58, s59
    s_lshl_b32 s58, s58, 15
    s_and_b32 s59, s25, 1
    v_and_b32 v7, 31, v2
    v_lshrrev_b32 v8, 5, v2
    v_lshlrev_b32 v7, 4, v7
    s_lshl_b32 s59, s59, 13
    v_lshlrev_b32 v8, 10, v8
    v_add_u32 v7, v7, v8
    s_add_u32 s58, s58, s59
    v_add_u32 v7, s58, v7
    v_mov_b32 v47, v7
    s_mov_b32 s74, s23
    v_cvt_pk_bf16_f32 v255, v254, v255
    v_cvt_pk_bf16_f32 v254, v252, v253
    v_cvt_pk_bf16_f32 v253, v250, v251
    v_cvt_pk_bf16_f32 v252, v248, v249
    v_cvt_pk_bf16_f32 v251, v246, v247
    v_cvt_pk_bf16_f32 v250, v244, v245
    v_cvt_pk_bf16_f32 v249, v242, v243
    v_cvt_pk_bf16_f32 v248, v240, v241
    v_cvt_pk_bf16_f32 v247, v238, v239
    v_cvt_pk_bf16_f32 v246, v236, v237
    v_cvt_pk_bf16_f32 v245, v234, v235
    v_cvt_pk_bf16_f32 v244, v232, v233
    v_cvt_pk_bf16_f32 v243, v230, v231
    v_cvt_pk_bf16_f32 v242, v228, v229
    v_cvt_pk_bf16_f32 v241, v226, v227
    v_cvt_pk_bf16_f32 v240, v224, v225
    v_cvt_pk_bf16_f32 v239, v222, v223
    v_cvt_pk_bf16_f32 v238, v220, v221
    v_cvt_pk_bf16_f32 v237, v218, v219
    v_cvt_pk_bf16_f32 v236, v216, v217
    v_cvt_pk_bf16_f32 v235, v214, v215
    v_cvt_pk_bf16_f32 v234, v212, v213
    v_cvt_pk_bf16_f32 v233, v210, v211
    v_cvt_pk_bf16_f32 v232, v208, v209
    v_cvt_pk_bf16_f32 v231, v206, v207
    v_cvt_pk_bf16_f32 v230, v204, v205
    v_cvt_pk_bf16_f32 v229, v202, v203
    v_cvt_pk_bf16_f32 v228, v200, v201
    v_cvt_pk_bf16_f32 v227, v198, v199
    v_cvt_pk_bf16_f32 v226, v196, v197
    v_cvt_pk_bf16_f32 v225, v194, v195
    v_cvt_pk_bf16_f32 v224, v192, v193
    v_cvt_pk_bf16_f32 v223, v190, v191
    v_cvt_pk_bf16_f32 v222, v188, v189
    v_cvt_pk_bf16_f32 v221, v186, v187
    v_cvt_pk_bf16_f32 v220, v184, v185
    v_cvt_pk_bf16_f32 v219, v182, v183
    v_cvt_pk_bf16_f32 v218, v180, v181
    v_cvt_pk_bf16_f32 v217, v178, v179
    v_cvt_pk_bf16_f32 v216, v176, v177
    v_cvt_pk_bf16_f32 v215, v174, v175
    v_cvt_pk_bf16_f32 v214, v172, v173
    v_cvt_pk_bf16_f32 v213, v170, v171
    v_cvt_pk_bf16_f32 v212, v168, v169
    v_cvt_pk_bf16_f32 v211, v166, v167
    v_cvt_pk_bf16_f32 v210, v164, v165
    v_cvt_pk_bf16_f32 v209, v162, v163
    v_cvt_pk_bf16_f32 v208, v160, v161
    v_cvt_pk_bf16_f32 v207, v158, v159
    v_cvt_pk_bf16_f32 v206, v156, v157
    v_cvt_pk_bf16_f32 v205, v154, v155
    v_cvt_pk_bf16_f32 v204, v152, v153
    v_cvt_pk_bf16_f32 v203, v150, v151
    v_cvt_pk_bf16_f32 v202, v148, v149
    v_cvt_pk_bf16_f32 v201, v146, v147
    v_cvt_pk_bf16_f32 v200, v144, v145
    v_cvt_pk_bf16_f32 v199, v142, v143
    v_cvt_pk_bf16_f32 v198, v140, v141
    v_cvt_pk_bf16_f32 v197, v138, v139
    v_cvt_pk_bf16_f32 v196, v136, v137
    v_cvt_pk_bf16_f32 v195, v134, v135
    v_cvt_pk_bf16_f32 v194, v132, v133
    v_cvt_pk_bf16_f32 v193, v130, v131
    v_cvt_pk_bf16_f32 v192, v128, v129
    s_branch L_kv_ln
L_kv_vpath:
    s_waitcnt vmcnt(8)
    s_barrier
    ds_read_b64_tr_b16 v[64:65], v24 offset:0
    ds_read_b64_tr_b16 v[66:67], v24 offset:2048
    ds_read_b128 v[72:75], v28 offset:0
    ds_read_b64_tr_b16 v[68:69], v25 offset:0
    ds_read_b64_tr_b16 v[70:71], v25 offset:2048
    ds_read_b128 v[76:79], v28 offset:4096
    ds_read_b128 v[80:83], v28 offset:8192
    ds_read_b128 v[84:87], v28 offset:12288
    s_waitcnt lgkmcnt(0)
    v_mfma_f32_32x32x16_bf16 v[128:143], v[72:75], v[64:67], v[128:143]
    ds_read_b64_tr_b16 v[88:89], v24 offset:8192
    ds_read_b64_tr_b16 v[90:91], v24 offset:10240
    v_mfma_f32_32x32x16_bf16 v[192:207], v[72:75], v[68:71], v[192:207]
    ds_read_b128 v[96:99], v29 offset:0
    ds_read_b64_tr_b16 v[92:93], v25 offset:8192
    v_mfma_f32_32x32x16_bf16 v[144:159], v[76:79], v[64:67], v[144:159]
    ds_read_b64_tr_b16 v[94:95], v25 offset:10240
    ds_read_b128 v[100:103], v29 offset:4096
    v_mfma_f32_32x32x16_bf16 v[208:223], v[76:79], v[68:71], v[208:223]
    ds_read_b128 v[104:107], v29 offset:8192
    ds_read_b128 v[108:111], v29 offset:12288
    v_mfma_f32_32x32x16_bf16 v[160:175], v[80:83], v[64:67], v[160:175]
    v_mfma_f32_32x32x16_bf16 v[224:239], v[80:83], v[68:71], v[224:239]
    v_mfma_f32_32x32x16_bf16 v[176:191], v[84:87], v[64:67], v[176:191]
    v_mfma_f32_32x32x16_bf16 v[240:255], v[84:87], v[68:71], v[240:255]
    s_waitcnt lgkmcnt(0)
    v_mfma_f32_32x32x16_bf16 v[128:143], v[96:99], v[88:91], v[128:143]
    ds_read_b64_tr_b16 v[64:65], v24 offset:16384
    ds_read_b64_tr_b16 v[66:67], v24 offset:18432
    v_mfma_f32_32x32x16_bf16 v[192:207], v[96:99], v[92:95], v[192:207]
    ds_read_b128 v[72:75], v30 offset:0
    ds_read_b64_tr_b16 v[68:69], v25 offset:16384
    v_mfma_f32_32x32x16_bf16 v[144:159], v[100:103], v[88:91], v[144:159]
    ds_read_b64_tr_b16 v[70:71], v25 offset:18432
    ds_read_b128 v[76:79], v30 offset:4096
    v_mfma_f32_32x32x16_bf16 v[208:223], v[100:103], v[92:95], v[208:223]
    ds_read_b128 v[80:83], v30 offset:8192
    ds_read_b128 v[84:87], v30 offset:12288
    v_mfma_f32_32x32x16_bf16 v[160:175], v[104:107], v[88:91], v[160:175]
    v_mfma_f32_32x32x16_bf16 v[224:239], v[104:107], v[92:95], v[224:239]
    v_mfma_f32_32x32x16_bf16 v[176:191], v[108:111], v[88:91], v[176:191]
    v_mfma_f32_32x32x16_bf16 v[240:255], v[108:111], v[92:95], v[240:255]
    s_waitcnt lgkmcnt(0)
    v_mfma_f32_32x32x16_bf16 v[128:143], v[72:75], v[64:67], v[128:143]
    ds_read_b64_tr_b16 v[88:89], v24 offset:24576
    ds_read_b64_tr_b16 v[90:91], v24 offset:26624
    v_mfma_f32_32x32x16_bf16 v[192:207], v[72:75], v[68:71], v[192:207]
    ds_read_b128 v[96:99], v31 offset:0
    ds_read_b64_tr_b16 v[92:93], v25 offset:24576
    v_mfma_f32_32x32x16_bf16 v[144:159], v[76:79], v[64:67], v[144:159]
    ds_read_b64_tr_b16 v[94:95], v25 offset:26624
    ds_read_b128 v[100:103], v31 offset:4096
    v_mfma_f32_32x32x16_bf16 v[208:223], v[76:79], v[68:71], v[208:223]
    ds_read_b128 v[104:107], v31 offset:8192
    ds_read_b128 v[108:111], v31 offset:12288
    v_mfma_f32_32x32x16_bf16 v[160:175], v[80:83], v[64:67], v[160:175]
    v_mfma_f32_32x32x16_bf16 v[224:239], v[80:83], v[68:71], v[224:239]
    v_mfma_f32_32x32x16_bf16 v[176:191], v[84:87], v[64:67], v[176:191]
    v_mfma_f32_32x32x16_bf16 v[240:255], v[84:87], v[68:71], v[240:255]
    s_waitcnt vmcnt(0) lgkmcnt(0)
    s_barrier
    v_mfma_f32_32x32x16_bf16 v[128:143], v[96:99], v[88:91], v[128:143]
    ds_read_b64_tr_b16 v[64:65], v26 offset:0
    ds_read_b64_tr_b16 v[66:67], v26 offset:2048
    ds_read_b128 v[72:75], v32 offset:0
    ds_read_b64_tr_b16 v[68:69], v27 offset:0
    v_mfma_f32_32x32x16_bf16 v[192:207], v[96:99], v[92:95], v[192:207]
    ds_read_b64_tr_b16 v[70:71], v27 offset:2048
    ds_read_b128 v[76:79], v32 offset:4096
    ds_read_b128 v[80:83], v32 offset:8192
    ds_read_b128 v[84:87], v32 offset:12288
    v_mfma_f32_32x32x16_bf16 v[144:159], v[100:103], v[88:91], v[144:159]
    s_add_u32 m0, s53, 0
    s_add_u32 s54, s51, 1048576
    buffer_load_dwordx4 v6, s[28:31], s54 offen sc1 lds
    s_add_u32 m0, s53, 8192
    v_mfma_f32_32x32x16_bf16 v[208:223], v[100:103], v[92:95], v[208:223]
    s_add_u32 s54, s51, 1179648
    buffer_load_dwordx4 v6, s[28:31], s54 offen sc1 lds
    s_add_u32 m0, s53, 16384
    s_add_u32 s54, s51, 1310720
    v_mfma_f32_32x32x16_bf16 v[160:175], v[104:107], v[88:91], v[160:175]
    buffer_load_dwordx4 v6, s[28:31], s54 offen sc1 lds
    s_add_u32 m0, s53, 24576
    s_add_u32 s54, s51, 1441792
    buffer_load_dwordx4 v6, s[28:31], s54 offen sc1 lds
    v_mfma_f32_32x32x16_bf16 v[224:239], v[104:107], v[92:95], v[224:239]
    s_add_u32 m0, s53, 32768
    s_add_u32 s54, s52, 256
    buffer_load_dwordx4 v10, s[32:35], s54 offen sc1 lds
    s_add_u32 m0, s53, 40960
    v_mfma_f32_32x32x16_bf16 v[176:191], v[108:111], v[88:91], v[176:191]
    s_add_u32 s54, s52, 65792
    buffer_load_dwordx4 v10, s[32:35], s54 offen sc1 lds
    s_add_u32 m0, s53, 49152
    s_add_u32 s54, s52, 131328
    v_mfma_f32_32x32x16_bf16 v[240:255], v[108:111], v[92:95], v[240:255]
    buffer_load_dwordx4 v10, s[32:35], s54 offen sc1 lds
    s_add_u32 m0, s53, 57344
    s_add_u32 s54, s52, 196864
    buffer_load_dwordx4 v10, s[32:35], s54 offen sc1 lds
    s_waitcnt lgkmcnt(0)
    v_mfma_f32_32x32x16_bf16 v[128:143], v[72:75], v[64:67], v[128:143]
    ds_read_b64_tr_b16 v[88:89], v26 offset:8192
    ds_read_b64_tr_b16 v[90:91], v26 offset:10240
    v_mfma_f32_32x32x16_bf16 v[192:207], v[72:75], v[68:71], v[192:207]
    ds_read_b128 v[96:99], v33 offset:0
    ds_read_b64_tr_b16 v[92:93], v27 offset:8192
    v_mfma_f32_32x32x16_bf16 v[144:159], v[76:79], v[64:67], v[144:159]
    ds_read_b64_tr_b16 v[94:95], v27 offset:10240
    ds_read_b128 v[100:103], v33 offset:4096
    v_mfma_f32_32x32x16_bf16 v[208:223], v[76:79], v[68:71], v[208:223]
    ds_read_b128 v[104:107], v33 offset:8192
    ds_read_b128 v[108:111], v33 offset:12288
    v_mfma_f32_32x32x16_bf16 v[160:175], v[80:83], v[64:67], v[160:175]
    v_mfma_f32_32x32x16_bf16 v[224:239], v[80:83], v[68:71], v[224:239]
    v_mfma_f32_32x32x16_bf16 v[176:191], v[84:87], v[64:67], v[176:191]
    v_mfma_f32_32x32x16_bf16 v[240:255], v[84:87], v[68:71], v[240:255]
    v_cmp_gt_u32 vcc, 16, v2
    v_mov_b32 v55, 0
    s_nop 0
    v_cndmask_b32 v55, v55, 1.0, vcc
    v_lshlrev_b32 v36, 16, v16
    v_and_b32 v37, 0xffff0000, v16
    v_lshlrev_b32 v38, 16, v17
    v_and_b32 v39, 0xffff0000, v17
    v_lshlrev_b32 v40, 16, v18
    v_and_b32 v41, 0xffff0000, v18
    v_lshlrev_b32 v42, 16, v19
    v_and_b32 v43, 0xffff0000, v19
    v_lshlrev_b32 v44, 16, v20
    v_and_b32 v45, 0xffff0000, v20
    v_lshlrev_b32 v46, 16, v21
    v_and_b32 v47, 0xffff0000, v21
    v_lshlrev_b32 v48, 16, v22
    v_and_b32 v49, 0xffff0000, v22
    v_lshlrev_b32 v50, 16, v23
    v_and_b32 v51, 0xffff0000, v23
    v_add_f32 v52, v36, v37
    v_add_f32 v52, v52, v38
    v_add_f32 v52, v52, v39
    v_add_f32 v52, v52, v40
    v_add_f32 v52, v52, v41
    v_add_f32 v52, v52, v42
    v_add_f32 v52, v52, v43
    v_add_f32 v52, v52, v44
    v_add_f32 v52, v52, v45
    v_add_f32 v52, v52, v46
    v_add_f32 v52, v52, v47
    v_add_f32 v52, v52, v48
    v_add_f32 v52, v52, v49
    v_add_f32 v52, v52, v50
    v_add_f32 v52, v52, v51
    s_nop 1
    v_add_f32_dpp v52, v52, v52 quad_perm:[1,0,3,2] row_mask:0xf bank_mask:0xf
    s_nop 1
    v_add_f32_dpp v52, v52, v52 quad_perm:[2,3,0,1] row_mask:0xf bank_mask:0xf
    s_nop 1
    v_add_f32_dpp v52, v52, v52 row_half_mirror row_mask:0xf bank_mask:0xf
    s_nop 1
    v_add_f32_dpp v52, v52, v52 row_mirror row_mask:0xf bank_mask:0xf
    v_mov_b32 v53, v52
    s_nop 1
    v_permlane16_swap_b32 v52, v53
    v_add_f32 v52, v52, v53
    v_mov_b32 v53, v52
    s_nop 1
    v_permlane32_swap_b32 v52, v53
    v_add_f32 v52, v52, v53
    v_mul_f32 v52, 0x3acccccd, v52
    v_sub_f32 v36, v36, v52
    v_sub_f32 v37, v37, v52
    v_sub_f32 v38, v38, v52
    v_sub_f32 v39, v39, v52
    v_sub_f32 v40, v40, v52
    v_sub_f32 v41, v41, v52
    v_sub_f32 v42, v42, v52
    v_sub_f32 v43, v43, v52
    v_sub_f32 v44, v44, v52
    v_sub_f32 v45, v45, v52
    v_sub_f32 v46, v46, v52
    v_sub_f32 v47, v47, v52
    v_sub_f32 v48, v48, v52
    v_sub_f32 v49, v49, v52
    v_sub_f32 v50, v50, v52
    v_sub_f32 v51, v51, v52
    v_mul_f32 v44, v44, v55
    v_mul_f32 v45, v45, v55
    v_mul_f32 v46, v46, v55
    v_mul_f32 v47, v47, v55
    v_mul_f32 v48, v48, v55
    v_mul_f32 v49, v49, v55
    v_mul_f32 v50, v50, v55
    v_mul_f32 v51, v51, v55
    v_mul_f32 v52, v36, v36
    v_fmac_f32 v52, v37, v37
    v_fmac_f32 v52, v38, v38
    v_fmac_f32 v52, v39, v39
    v_fmac_f32 v52, v40, v40
    v_fmac_f32 v52, v41, v41
    v_fmac_f32 v52, v42, v42
    v_fmac_f32 v52, v43, v43
    v_fmac_f32 v52, v44, v44
    v_fmac_f32 v52, v45, v45
    v_fmac_f32 v52, v46, v46
    v_fmac_f32 v52, v47, v47
    v_fmac_f32 v52, v48, v48
    v_fmac_f32 v52, v49, v49
    v_fmac_f32 v52, v50, v50
    v_fmac_f32 v52, v51, v51
    s_nop 1
    v_add_f32_dpp v52, v52, v52 quad_perm:[1,0,3,2] row_mask:0xf bank_mask:0xf
    s_nop 1
    v_add_f32_dpp v52, v52, v52 quad_perm:[2,3,0,1] row_mask:0xf bank_mask:0xf
    s_nop 1
    v_add_f32_dpp v52, v52, v52 row_half_mirror row_mask:0xf bank_mask:0xf
    s_nop 1
    v_add_f32_dpp v52, v52, v52 row_mirror row_mask:0xf bank_mask:0xf
    v_mov_b32 v53, v52
    s_nop 1
    v_permlane16_swap_b32 v52, v53
    v_add_f32 v52, v52, v53
    v_mov_b32 v53, v52
    s_nop 1
    v_permlane32_swap_b32 v52, v53
    v_add_f32 v52, v52, v53
    v_mov_b32 v54, 0x3727c5ac
    v_fmac_f32 v54, 0x3acccccd, v52
    v_rsq_f32 v54, v54
    s_nop 0
    v_mul_f32 v36, v36, v54
    v_mul_f32 v37, v37, v54
    v_mul_f32 v38, v38, v54
    v_mul_f32 v39, v39, v54
    v_mul_f32 v40, v40, v54
    v_mul_f32 v41, v41, v54
    v_mul_f32 v42, v42, v54
    v_mul_f32 v43, v43, v54
    v_mul_f32 v44, v44, v54
    v_mul_f32 v45, v45, v54
    v_mul_f32 v46, v46, v54
    v_mul_f32 v47, v47, v54
    v_mul_f32 v48, v48, v54
    v_mul_f32 v49, v49, v54
    v_mul_f32 v50, v50, v54
    v_mul_f32 v51, v51, v54
    v_cvt_pk_bf16_f32 v16, v36, v37
    v_cvt_pk_bf16_f32 v17, v38, v39
    v_cvt_pk_bf16_f32 v18, v40, v41
    v_cvt_pk_bf16_f32 v19, v42, v43
    v_cvt_pk_bf16_f32 v20, v44, v45
    v_cvt_pk_bf16_f32 v21, v46, v47
    v_cvt_pk_bf16_f32 v22, v48, v49
    v_cvt_pk_bf16_f32 v23, v50, v51
    s_lshr_b32 s55, s48, 7
    s_mul_i32 s55, s55, 163840
    s_and_b32 s58, s48, 127
    s_lshl_b32 s58, s58, 4
    s_add_u32 s55, s55, s58
    v_lshlrev_b32 v7, 11, v2
    buffer_store_dwordx4 v[16:19], v7, s[44:47], s55 offen sc1
    v_add_u32 v8, 0x20000, v7
    v_mov_b32 v5, 0x7fffffff
    v_cndmask_b32 v8, v5, v8, vcc
    buffer_store_dwordx4 v[20:23], v8, s[44:47], s55 offen sc1
    s_waitcnt lgkmcnt(0)
    v_mfma_f32_32x32x16_bf16 v[128:143], v[96:99], v[88:91], v[128:143]
    ds_read_b64_tr_b16 v[64:65], v26 offset:16384
    ds_read_b64_tr_b16 v[66:67], v26 offset:18432
    v_mfma_f32_32x32x16_bf16 v[192:207], v[96:99], v[92:95], v[192:207]
    ds_read_b128 v[72:75], v34 offset:0
    ds_read_b64_tr_b16 v[68:69], v27 offset:16384
    v_mfma_f32_32x32x16_bf16 v[144:159], v[100:103], v[88:91], v[144:159]
    ds_read_b64_tr_b16 v[70:71], v27 offset:18432
    ds_read_b128 v[76:79], v34 offset:4096
    v_mfma_f32_32x32x16_bf16 v[208:223], v[100:103], v[92:95], v[208:223]
    ds_read_b128 v[80:83], v34 offset:8192
    ds_read_b128 v[84:87], v34 offset:12288
    v_mfma_f32_32x32x16_bf16 v[160:175], v[104:107], v[88:91], v[160:175]
    v_mfma_f32_32x32x16_bf16 v[224:239], v[104:107], v[92:95], v[224:239]
    v_mfma_f32_32x32x16_bf16 v[176:191], v[108:111], v[88:91], v[176:191]
    v_mfma_f32_32x32x16_bf16 v[240:255], v[108:111], v[92:95], v[240:255]
    s_waitcnt lgkmcnt(0)
    v_mfma_f32_32x32x16_bf16 v[128:143], v[72:75], v[64:67], v[128:143]
    ds_read_b64_tr_b16 v[88:89], v26 offset:24576
    ds_read_b64_tr_b16 v[90:91], v26 offset:26624
    v_mfma_f32_32x32x16_bf16 v[192:207], v[72:75], v[68:71], v[192:207]
    ds_read_b128 v[96:99], v35 offset:0
    ds_read_b64_tr_b16 v[92:93], v27 offset:24576
    v_mfma_f32_32x32x16_bf16 v[144:159], v[76:79], v[64:67], v[144:159]
    ds_read_b64_tr_b16 v[94:95], v27 offset:26624
    ds_read_b128 v[100:103], v35 offset:4096
    v_mfma_f32_32x32x16_bf16 v[208:223], v[76:79], v[68:71], v[208:223]
    ds_read_b128 v[104:107], v35 offset:8192
    ds_read_b128 v[108:111], v35 offset:12288
    v_mfma_f32_32x32x16_bf16 v[160:175], v[80:83], v[64:67], v[160:175]
    v_mfma_f32_32x32x16_bf16 v[224:239], v[80:83], v[68:71], v[224:239]
    v_mfma_f32_32x32x16_bf16 v[176:191], v[84:87], v[64:67], v[176:191]
    v_mfma_f32_32x32x16_bf16 v[240:255], v[84:87], v[68:71], v[240:255]
    s_waitcnt vmcnt(0) lgkmcnt(0)
    s_barrier
    s_cmp_eq_u32 s25, 0
    s_cbranch_scc0 L_fz_n3
    v_readfirstlane_b32 s88, v56
    v_readfirstlane_b32 s89, v57
    s_nop 1
    s_cmp_eq_u64 s[88:89], 0
    s_cselect_b32 s100, s100, s88
    s_cselect_b32 s101, s101, s89
L_fz_n3:
    s_cmp_eq_u32 s25, 0
    s_cbranch_scc0 L_fz_f4
    s_lshl_b32 s88, s2, 3
    s_add_u32 s88, s88, 12288
    s_mov_b64 exec, 1
    v_mov_b32 v62, s100
    v_mov_b32 v63, s101
    v_mov_b32 v61, 0
    buffer_store_dwordx2 v[62:63], v61, s[96:99], s88 offen sc0 sc1
    s_mov_b64 exec, -1
L_fz_f4:
    v_mfma_f32_32x32x16_bf16 v[128:143], v[96:99], v[88:91], v[128:143]
    ds_read_b64_tr_b16 v[64:65], v24 offset:0
    ds_read_b64_tr_b16 v[66:67], v24 offset:2048
    ds_read_b128 v[72:75], v28 offset:0
    ds_read_b64_tr_b16 v[68:69], v25 offset:0
    v_mfma_f32_32x32x16_bf16 v[192:207], v[96:99], v[92:95], v[192:207]
    ds_read_b64_tr_b16 v[70:71], v25 offset:2048
    ds_read_b128 v[76:79], v28 offset:4096
    ds_read_b128 v[80:83], v28 offset:8192
    ds_read_b128 v[84:87], v28 offset:12288
    v_mfma_f32_32x32x16_bf16 v[144:159], v[100:103], v[88:91], v[144:159]
    s_add_u32 m0, s53, 65536
    s_add_u32 s54, s51, 1572864
    buffer_load_dwordx4 v6, s[28:31], s54 offen sc1 lds
    s_add_u32 m0, s53, 73728
    v_mfma_f32_32x32x16_bf16 v[208:223], v[100:103], v[92:95], v[208:223]
    s_add_u32 s54, s51, 1703936
    buffer_load_dwordx4 v6, s[28:31], s54 offen sc1 lds
    s_add_u32 m0, s53, 81920
    s_add_u32 s54, s51, 1835008
    v_mfma_f32_32x32x16_bf16 v[160:175], v[104:107], v[88:91], v[160:175]
    buffer_load_dwordx4 v6, s[28:31], s54 offen sc1 lds
    s_add_u32 m0, s53, 90112
    s_add_u32 s54, s51, 1966080
    buffer_load_dwordx4 v6, s[28:31], s54 offen sc1 lds
    v_mfma_f32_32x32x16_bf16 v[224:239], v[104:107], v[92:95], v[224:239]
    s_add_u32 m0, s53, 98304
    s_add_u32 s54, s52, 384
    buffer_load_dwordx4 v10, s[32:35], s54 offen sc1 lds
    s_add_u32 m0, s53, 106496
    v_mfma_f32_32x32x16_bf16 v[176:191], v[108:111], v[88:91], v[176:191]
    s_add_u32 s54, s52, 65920
    buffer_load_dwordx4 v10, s[32:35], s54 offen sc1 lds
    s_add_u32 m0, s53, 114688
    s_add_u32 s54, s52, 131456
    v_mfma_f32_32x32x16_bf16 v[240:255], v[108:111], v[92:95], v[240:255]
    buffer_load_dwordx4 v10, s[32:35], s54 offen sc1 lds
    s_add_u32 m0, s53, 122880
    s_add_u32 s54, s52, 196992
    buffer_load_dwordx4 v10, s[32:35], s54 offen sc1 lds
    s_waitcnt lgkmcnt(0)
    v_mfma_f32_32x32x16_bf16 v[128:143], v[72:75], v[64:67], v[128:143]
    ds_read_b64_tr_b16 v[88:89], v24 offset:8192
    ds_read_b64_tr_b16 v[90:91], v24 offset:10240
    v_mfma_f32_32x32x16_bf16 v[192:207], v[72:75], v[68:71], v[192:207]
    ds_read_b128 v[96:99], v29 offset:0
    ds_read_b64_tr_b16 v[92:93], v25 offset:8192
    v_mfma_f32_32x32x16_bf16 v[144:159], v[76:79], v[64:67], v[144:159]
    ds_read_b64_tr_b16 v[94:95], v25 offset:10240
    ds_read_b128 v[100:103], v29 offset:4096
    v_mfma_f32_32x32x16_bf16 v[208:223], v[76:79], v[68:71], v[208:223]
    ds_read_b128 v[104:107], v29 offset:8192
    ds_read_b128 v[108:111], v29 offset:12288
    v_mfma_f32_32x32x16_bf16 v[160:175], v[80:83], v[64:67], v[160:175]
    v_mfma_f32_32x32x16_bf16 v[224:239], v[80:83], v[68:71], v[224:239]
    v_mfma_f32_32x32x16_bf16 v[176:191], v[84:87], v[64:67], v[176:191]
    v_mfma_f32_32x32x16_bf16 v[240:255], v[84:87], v[68:71], v[240:255]
    s_waitcnt lgkmcnt(0)
    v_mfma_f32_32x32x16_bf16 v[128:143], v[96:99], v[88:91], v[128:143]
    ds_read_b64_tr_b16 v[64:65], v24 offset:16384
    ds_read_b64_tr_b16 v[66:67], v24 offset:18432
    v_mfma_f32_32x32x16_bf16 v[192:207], v[96:99], v[92:95], v[192:207]
    ds_read_b128 v[72:75], v30 offset:0
    ds_read_b64_tr_b16 v[68:69], v25 offset:16384
    v_mfma_f32_32x32x16_bf16 v[144:159], v[100:103], v[88:91], v[144:159]
    ds_read_b64_tr_b16 v[70:71], v25 offset:18432
    ds_read_b128 v[76:79], v30 offset:4096
    v_mfma_f32_32x32x16_bf16 v[208:223], v[100:103], v[92:95], v[208:223]
    ds_read_b128 v[80:83], v30 offset:8192
    ds_read_b128 v[84:87], v30 offset:12288
    v_mfma_f32_32x32x16_bf16 v[160:175], v[104:107], v[88:91], v[160:175]
    v_mfma_f32_32x32x16_bf16 v[224:239], v[104:107], v[92:95], v[224:239]
    v_mfma_f32_32x32x16_bf16 v[176:191], v[108:111], v[88:91], v[176:191]
    v_mfma_f32_32x32x16_bf16 v[240:255], v[108:111], v[92:95], v[240:255]
    s_waitcnt lgkmcnt(0)
    v_mfma_f32_32x32x16_bf16 v[128:143], v[72:75], v[64:67], v[128:143]
    ds_read_b64_tr_b16 v[88:89], v24 offset:24576
    ds_read_b64_tr_b16 v[90:91], v24 offset:26624
    v_mfma_f32_32x32x16_bf16 v[192:207], v[72:75], v[68:71], v[192:207]
    ds_read_b128 v[96:99], v31 offset:0
    ds_read_b64_tr_b16 v[92:93], v25 offset:24576
    v_mfma_f32_32x32x16_bf16 v[144:159], v[76:79], v[64:67], v[144:159]
    ds_read_b64_tr_b16 v[94:95], v25 offset:26624
    ds_read_b128 v[100:103], v31 offset:4096
    v_mfma_f32_32x32x16_bf16 v[208:223], v[76:79], v[68:71], v[208:223]
    ds_read_b128 v[104:107], v31 offset:8192
    ds_read_b128 v[108:111], v31 offset:12288
    v_mfma_f32_32x32x16_bf16 v[160:175], v[80:83], v[64:67], v[160:175]
    v_mfma_f32_32x32x16_bf16 v[224:239], v[80:83], v[68:71], v[224:239]
    v_mfma_f32_32x32x16_bf16 v[176:191], v[84:87], v[64:67], v[176:191]
    v_mfma_f32_32x32x16_bf16 v[240:255], v[84:87], v[68:71], v[240:255]
    s_waitcnt vmcnt(0) lgkmcnt(0)
    s_barrier
    s_lshl_b32 s84, s25, 8
    s_add_u32 s84, s84, s2
    s_cmp_lt_u32 s84, 640
    s_cbranch_scc0 L_pf_kv1_0
    s_load_dwordx2 s[86:87], s[0:1], 16
    s_sub_u32 s85, s84, 0
    s_lshl_b32 s85, s85, 13
    v_lshlrev_b32 v61, 7, v2
    s_waitcnt lgkmcnt(0)
    s_mov_b32 s76, s86
    s_mov_b32 s77, s87
    s_mov_b32 s78, 0x500000
    s_mov_b32 s79, 0x00020000
    buffer_load_dword v60, v61, s[76:79], s85 offen sc1
L_pf_kv1_0:
    v_mfma_f32_32x32x16_bf16 v[128:143], v[96:99], v[88:91], v[128:143]
    ds_read_b64_tr_b16 v[64:65], v26 offset:0
    ds_read_b64_tr_b16 v[66:67], v26 offset:2048
    ds_read_b128 v[72:75], v32 offset:0
    ds_read_b64_tr_b16 v[68:69], v27 offset:0
    v_mfma_f32_32x32x16_bf16 v[192:207], v[96:99], v[92:95], v[192:207]
    ds_read_b64_tr_b16 v[70:71], v27 offset:2048
    ds_read_b128 v[76:79], v32 offset:4096
    ds_read_b128 v[80:83], v32 offset:8192
    ds_read_b128 v[84:87], v32 offset:12288
    v_mfma_f32_32x32x16_bf16 v[144:159], v[100:103], v[88:91], v[144:159]
    s_add_u32 m0, s53, 0
    s_add_u32 s54, s51, 2097152
    buffer_load_dwordx4 v6, s[28:31], s54 offen sc1 lds
    s_add_u32 m0, s53, 8192
    v_mfma_f32_32x32x16_bf16 v[208:223], v[100:103], v[92:95], v[208:223]
    s_add_u32 s54, s51, 2228224
    buffer_load_dwordx4 v6, s[28:31], s54 offen sc1 lds
    s_add_u32 m0, s53, 16384
    s_add_u32 s54, s51, 2359296
    v_mfma_f32_32x32x16_bf16 v[160:175], v[104:107], v[88:91], v[160:175]
    buffer_load_dwordx4 v6, s[28:31], s54 offen sc1 lds
    s_add_u32 m0, s53, 24576
    s_add_u32 s54, s51, 2490368
    buffer_load_dwordx4 v6, s[28:31], s54 offen sc1 lds
    v_mfma_f32_32x32x16_bf16 v[224:239], v[104:107], v[92:95], v[224:239]
    s_add_u32 m0, s53, 32768
    s_add_u32 s54, s52, 512
    buffer_load_dwordx4 v10, s[32:35], s54 offen sc1 lds
    s_add_u32 m0, s53, 40960
    v_mfma_f32_32x32x16_bf16 v[176:191], v[108:111], v[88:91], v[176:191]
    s_add_u32 s54, s52, 66048
    buffer_load_dwordx4 v10, s[32:35], s54 offen sc1 lds
    s_add_u32 m0, s53, 49152
    s_add_u32 s54, s52, 131584
    v_mfma_f32_32x32x16_bf16 v[240:255], v[108:111], v[92:95], v[240:255]
    buffer_load_dwordx4 v10, s[32:35], s54 offen sc1 lds
    s_add_u32 m0, s53, 57344
    s_add_u32 s54, s52, 197120
    buffer_load_dwordx4 v10, s[32:35], s54 offen sc1 lds
    s_waitcnt lgkmcnt(0)
    v_mfma_f32_32x32x16_bf16 v[128:143], v[72:75], v[64:67], v[128:143]
    ds_read_b64_tr_b16 v[88:89], v26 offset:8192
    ds_read_b64_tr_b16 v[90:91], v26 offset:10240
    v_mfma_f32_32x32x16_bf16 v[192:207], v[72:75], v[68:71], v[192:207]
    ds_read_b128 v[96:99], v33 offset:0
    ds_read_b64_tr_b16 v[92:93], v27 offset:8192
    v_mfma_f32_32x32x16_bf16 v[144:159], v[76:79], v[64:67], v[144:159]
    ds_read_b64_tr_b16 v[94:95], v27 offset:10240
    ds_read_b128 v[100:103], v33 offset:4096
    v_mfma_f32_32x32x16_bf16 v[208:223], v[76:79], v[68:71], v[208:223]
    ds_read_b128 v[104:107], v33 offset:8192
    ds_read_b128 v[108:111], v33 offset:12288
    v_mfma_f32_32x32x16_bf16 v[160:175], v[80:83], v[64:67], v[160:175]
    v_mfma_f32_32x32x16_bf16 v[224:239], v[80:83], v[68:71], v[224:239]
    v_mfma_f32_32x32x16_bf16 v[176:191], v[84:87], v[64:67], v[176:191]
    v_mfma_f32_32x32x16_bf16 v[240:255], v[84:87], v[68:71], v[240:255]
    s_waitcnt lgkmcnt(0)
    v_mfma_f32_32x32x16_bf16 v[128:143], v[96:99], v[88:91], v[128:143]
    ds_read_b64_tr_b16 v[64:65], v26 offset:16384
    ds_read_b64_tr_b16 v[66:67], v26 offset:18432
    v_mfma_f32_32x32x16_bf16 v[192:207], v[96:99], v[92:95], v[192:207]
    ds_read_b128 v[72:75], v34 offset:0
    ds_read_b64_tr_b16 v[68:69], v27 offset:16384
    v_mfma_f32_32x32x16_bf16 v[144:159], v[100:103], v[88:91], v[144:159]
    ds_read_b64_tr_b16 v[70:71], v27 offset:18432
    ds_read_b128 v[76:79], v34 offset:4096
    v_mfma_f32_32x32x16_bf16 v[208:223], v[100:103], v[92:95], v[208:223]
    ds_read_b128 v[80:83], v34 offset:8192
    ds_read_b128 v[84:87], v34 offset:12288
    v_mfma_f32_32x32x16_bf16 v[160:175], v[104:107], v[88:91], v[160:175]
    v_mfma_f32_32x32x16_bf16 v[224:239], v[104:107], v[92:95], v[224:239]
    v_mfma_f32_32x32x16_bf16 v[176:191], v[108:111], v[88:91], v[176:191]
    v_mfma_f32_32x32x16_bf16 v[240:255], v[108:111], v[92:95], v[240:255]
    s_waitcnt lgkmcnt(0)
    v_mfma_f32_32x32x16_bf16 v[128:143], v[72:75], v[64:67], v[128:143]
    ds_read_b64_tr_b16 v[88:89], v26 offset:24576
    ds_read_b64_tr_b16 v[90:91], v26 offset:26624
    v_mfma_f32_32x32x16_bf16 v[192:207], v[72:75], v[68:71], v[192:207]
    ds_read_b128 v[96:99], v35 offset:0
    ds_read_b64_tr_b16 v[92:93], v27 offset:24576
    v_mfma_f32_32x32x16_bf16 v[144:159], v[76:79], v[64:67], v[144:159]
    ds_read_b64_tr_b16 v[94:95], v27 offset:26624
    ds_read_b128 v[100:103], v35 offset:4096
    v_mfma_f32_32x32x16_bf16 v[208:223], v[76:79], v[68:71], v[208:223]
    ds_read_b128 v[104:107], v35 offset:8192
    ds_read_b128 v[108:111], v35 offset:12288
    v_mfma_f32_32x32x16_bf16 v[160:175], v[80:83], v[64:67], v[160:175]
    v_mfma_f32_32x32x16_bf16 v[224:239], v[80:83], v[68:71], v[224:239]
    v_mfma_f32_32x32x16_bf16 v[176:191], v[84:87], v[64:67], v[176:191]
    v_mfma_f32_32x32x16_bf16 v[240:255], v[84:87], v[68:71], v[240:255]
    s_waitcnt vmcnt(0) lgkmcnt(0)
    s_barrier
    v_mfma_f32_32x32x16_bf16 v[128:143], v[96:99], v[88:91], v[128:143]
    ds_read_b64_tr_b16 v[64:65], v24 offset:0
    ds_read_b64_tr_b16 v[66:67], v24 offset:2048
    ds_read_b128 v[72:75], v28 offset:0
    ds_read_b64_tr_b16 v[68:69], v25 offset:0
    v_mfma_f32_32x32x16_bf16 v[192:207], v[96:99], v[92:95], v[192:207]
    ds_read_b64_tr_b16 v[70:71], v25 offset:2048
    ds_read_b128 v[76:79], v28 offset:4096
    ds_read_b128 v[80:83], v28 offset:8192
    ds_read_b128 v[84:87], v28 offset:12288
    v_mfma_f32_32x32x16_bf16 v[144:159], v[100:103], v[88:91], v[144:159]
    s_add_u32 m0, s53, 65536
    s_add_u32 s54, s51, 2621440
    buffer_load_dwordx4 v6, s[28:31], s54 offen sc1 lds
    s_add_u32 m0, s53, 73728
    v_mfma_f32_32x32x16_bf16 v[208:223], v[100:103], v[92:95], v[208:223]
    s_add_u32 s54, s51, 2752512
    buffer_load_dwordx4 v6, s[28:31], s54 offen sc1 lds
    s_add_u32 m0, s53, 81920
    s_add_u32 s54, s51, 2883584
    v_mfma_f32_32x32x16_bf16 v[160:175], v[104:107], v[88:91], v[160:175]
    buffer_load_dwordx4 v6, s[28:31], s54 offen sc1 lds
    s_add_u32 m0, s53, 90112
    s_add_u32 s54, s51, 3014656
    buffer_load_dwordx4 v6, s[28:31], s54 offen sc1 lds
    v_mfma_f32_32x32x16_bf16 v[224:239], v[104:107], v[92:95], v[224:239]
    s_add_u32 m0, s53, 98304
    s_add_u32 s54, s52, 640
    buffer_load_dwordx4 v10, s[32:35], s54 offen sc1 lds
    s_add_u32 m0, s53, 106496
    v_mfma_f32_32x32x16_bf16 v[176:191], v[108:111], v[88:91], v[176:191]
    s_add_u32 s54, s52, 66176
    buffer_load_dwordx4 v10, s[32:35], s54 offen sc1 lds
    s_add_u32 m0, s53, 114688
    s_add_u32 s54, s52, 131712
    v_mfma_f32_32x32x16_bf16 v[240:255], v[108:111], v[92:95], v[240:255]
    buffer_load_dwordx4 v10, s[32:35], s54 offen sc1 lds
    s_add_u32 m0, s53, 122880
    s_add_u32 s54, s52, 197248
    buffer_load_dwordx4 v10, s[32:35], s54 offen sc1 lds
    s_waitcnt lgkmcnt(0)
    v_mfma_f32_32x32x16_bf16 v[128:143], v[72:75], v[64:67], v[128:143]
    ds_read_b64_tr_b16 v[88:89], v24 offset:8192
    ds_read_b64_tr_b16 v[90:91], v24 offset:10240
    v_mfma_f32_32x32x16_bf16 v[192:207], v[72:75], v[68:71], v[192:207]
    ds_read_b128 v[96:99], v29 offset:0
    ds_read_b64_tr_b16 v[92:93], v25 offset:8192
    v_mfma_f32_32x32x16_bf16 v[144:159], v[76:79], v[64:67], v[144:159]
    ds_read_b64_tr_b16 v[94:95], v25 offset:10240
    ds_read_b128 v[100:103], v29 offset:4096
    v_mfma_f32_32x32x16_bf16 v[208:223], v[76:79], v[68:71], v[208:223]
    ds_read_b128 v[104:107], v29 offset:8192
    ds_read_b128 v[108:111], v29 offset:12288
    v_mfma_f32_32x32x16_bf16 v[160:175], v[80:83], v[64:67], v[160:175]
    v_mfma_f32_32x32x16_bf16 v[224:239], v[80:83], v[68:71], v[224:239]
    v_mfma_f32_32x32x16_bf16 v[176:191], v[84:87], v[64:67], v[176:191]
    v_mfma_f32_32x32x16_bf16 v[240:255], v[84:87], v[68:71], v[240:255]
    s_waitcnt lgkmcnt(0)
    v_mfma_f32_32x32x16_bf16 v[128:143], v[96:99], v[88:91], v[128:143]
    ds_read_b64_tr_b16 v[64:65], v24 offset:16384
    ds_read_b64_tr_b16 v[66:67], v24 offset:18432
    v_mfma_f32_32x32x16_bf16 v[192:207], v[96:99], v[92:95], v[192:207]
    ds_read_b128 v[72:75], v30 offset:0
    ds_read_b64_tr_b16 v[68:69], v25 offset:16384
    v_mfma_f32_32x32x16_bf16 v[144:159], v[100:103], v[88:91], v[144:159]
    ds_read_b64_tr_b16 v[70:71], v25 offset:18432
    ds_read_b128 v[76:79], v30 offset:4096
    v_mfma_f32_32x32x16_bf16 v[208:223], v[100:103], v[92:95], v[208:223]
    ds_read_b128 v[80:83], v30 offset:8192
    ds_read_b128 v[84:87], v30 offset:12288
    v_mfma_f32_32x32x16_bf16 v[160:175], v[104:107], v[88:91], v[160:175]
    v_mfma_f32_32x32x16_bf16 v[224:239], v[104:107], v[92:95], v[224:239]
    v_mfma_f32_32x32x16_bf16 v[176:191], v[108:111], v[88:91], v[176:191]
    v_mfma_f32_32x32x16_bf16 v[240:255], v[108:111], v[92:95], v[240:255]
    s_waitcnt lgkmcnt(0)
    v_mfma_f32_32x32x16_bf16 v[128:143], v[72:75], v[64:67], v[128:143]
    ds_read_b64_tr_b16 v[88:89], v24 offset:24576
    ds_read_b64_tr_b16 v[90:91], v24 offset:26624
    v_mfma_f32_32x32x16_bf16 v[192:207], v[72:75], v[68:71], v[192:207]
    ds_read_b128 v[96:99], v31 offset:0
    ds_read_b64_tr_b16 v[92:93], v25 offset:24576
    v_mfma_f32_32x32x16_bf16 v[144:159], v[76:79], v[64:67], v[144:159]
    ds_read_b64_tr_b16 v[94:95], v25 offset:26624
    ds_read_b128 v[100:103], v31 offset:4096
    v_mfma_f32_32x32x16_bf16 v[208:223], v[76:79], v[68:71], v[208:223]
    ds_read_b128 v[104:107], v31 offset:8192
    ds_read_b128 v[108:111], v31 offset:12288
    v_mfma_f32_32x32x16_bf16 v[160:175], v[80:83], v[64:67], v[160:175]
    v_mfma_f32_32x32x16_bf16 v[224:239], v[80:83], v[68:71], v[224:239]
    v_mfma_f32_32x32x16_bf16 v[176:191], v[84:87], v[64:67], v[176:191]
    v_mfma_f32_32x32x16_bf16 v[240:255], v[84:87], v[68:71], v[240:255]
    s_waitcnt vmcnt(0) lgkmcnt(0)
    s_barrier
    v_mfma_f32_32x32x16_bf16 v[128:143], v[96:99], v[88:91], v[128:143]
    ds_read_b64_tr_b16 v[64:65], v26 offset:0
    ds_read_b64_tr_b16 v[66:67], v26 offset:2048
    ds_read_b128 v[72:75], v32 offset:0
    ds_read_b64_tr_b16 v[68:69], v27 offset:0
    v_mfma_f32_32x32x16_bf16 v[192:207], v[96:99], v[92:95], v[192:207]
    ds_read_b64_tr_b16 v[70:71], v27 offset:2048
    ds_read_b128 v[76:79], v32 offset:4096
    ds_read_b128 v[80:83], v32 offset:8192
    ds_read_b128 v[84:87], v32 offset:12288
    v_mfma_f32_32x32x16_bf16 v[144:159], v[100:103], v[88:91], v[144:159]
    s_add_u32 m0, s53, 0
    s_add_u32 s54, s51, 3145728
    buffer_load_dwordx4 v6, s[28:31], s54 offen sc1 lds
    s_add_u32 m0, s53, 8192
    v_mfma_f32_32x32x16_bf16 v[208:223], v[100:103], v[92:95], v[208:223]
    s_add_u32 s54, s51, 3276800
    buffer_load_dwordx4 v6, s[28:31], s54 offen sc1 lds
    s_add_u32 m0, s53, 16384
    s_add_u32 s54, s51, 3407872
    v_mfma_f32_32x32x16_bf16 v[160:175], v[104:107], v[88:91], v[160:175]
    buffer_load_dwordx4 v6, s[28:31], s54 offen sc1 lds
    s_add_u32 m0, s53, 24576
    s_add_u32 s54, s51, 3538944
    buffer_load_dwordx4 v6, s[28:31], s54 offen sc1 lds
    v_mfma_f32_32x32x16_bf16 v[224:239], v[104:107], v[92:95], v[224:239]
    s_add_u32 m0, s53, 32768
    s_add_u32 s54, s52, 768
    buffer_load_dwordx4 v10, s[32:35], s54 offen sc1 lds
    s_add_u32 m0, s53, 40960
    v_mfma_f32_32x32x16_bf16 v[176:191], v[108:111], v[88:91], v[176:191]
    s_add_u32 s54, s52, 66304
    buffer_load_dwordx4 v10, s[32:35], s54 offen sc1 lds
    s_add_u32 m0, s53, 49152
    s_add_u32 s54, s52, 131840
    v_mfma_f32_32x32x16_bf16 v[240:255], v[108:111], v[92:95], v[240:255]
    buffer_load_dwordx4 v10, s[32:35], s54 offen sc1 lds
    s_add_u32 m0, s53, 57344
    s_add_u32 s54, s52, 197376
    buffer_load_dwordx4 v10, s[32:35], s54 offen sc1 lds
    s_waitcnt lgkmcnt(0)
    v_mfma_f32_32x32x16_bf16 v[128:143], v[72:75], v[64:67], v[128:143]
    ds_read_b64_tr_b16 v[88:89], v26 offset:8192
    ds_read_b64_tr_b16 v[90:91], v26 offset:10240
    v_mfma_f32_32x32x16_bf16 v[192:207], v[72:75], v[68:71], v[192:207]
    ds_read_b128 v[96:99], v33 offset:0
    ds_read_b64_tr_b16 v[92:93], v27 offset:8192
    v_mfma_f32_32x32x16_bf16 v[144:159], v[76:79], v[64:67], v[144:159]
    ds_read_b64_tr_b16 v[94:95], v27 offset:10240
    ds_read_b128 v[100:103], v33 offset:4096
    v_mfma_f32_32x32x16_bf16 v[208:223], v[76:79], v[68:71], v[208:223]
    ds_read_b128 v[104:107], v33 offset:8192
    ds_read_b128 v[108:111], v33 offset:12288
    v_mfma_f32_32x32x16_bf16 v[160:175], v[80:83], v[64:67], v[160:175]
    v_mfma_f32_32x32x16_bf16 v[224:239], v[80:83], v[68:71], v[224:239]
    v_mfma_f32_32x32x16_bf16 v[176:191], v[84:87], v[64:67], v[176:191]
    v_mfma_f32_32x32x16_bf16 v[240:255], v[84:87], v[68:71], v[240:255]
    s_waitcnt lgkmcnt(0)
    v_mfma_f32_32x32x16_bf16 v[128:143], v[96:99], v[88:91], v[128:143]
    ds_read_b64_tr_b16 v[64:65], v26 offset:16384
    ds_read_b64_tr_b16 v[66:67], v26 offset:18432
    v_mfma_f32_32x32x16_bf16 v[192:207], v[96:99], v[92:95], v[192:207]
    ds_read_b128 v[72:75], v34 offset:0
    ds_read_b64_tr_b16 v[68:69], v27 offset:16384
    v_mfma_f32_32x32x16_bf16 v[144:159], v[100:103], v[88:91], v[144:159]
    ds_read_b64_tr_b16 v[70:71], v27 offset:18432
    ds_read_b128 v[76:79], v34 offset:4096
    v_mfma_f32_32x32x16_bf16 v[208:223], v[100:103], v[92:95], v[208:223]
    ds_read_b128 v[80:83], v34 offset:8192
    ds_read_b128 v[84:87], v34 offset:12288
    v_mfma_f32_32x32x16_bf16 v[160:175], v[104:107], v[88:91], v[160:175]
    v_mfma_f32_32x32x16_bf16 v[224:239], v[104:107], v[92:95], v[224:239]
    v_mfma_f32_32x32x16_bf16 v[176:191], v[108:111], v[88:91], v[176:191]
    v_mfma_f32_32x32x16_bf16 v[240:255], v[108:111], v[92:95], v[240:255]
    s_waitcnt lgkmcnt(0)
    v_mfma_f32_32x32x16_bf16 v[128:143], v[72:75], v[64:67], v[128:143]
    ds_read_b64_tr_b16 v[88:89], v26 offset:24576
    ds_read_b64_tr_b16 v[90:91], v26 offset:26624
    v_mfma_f32_32x32x16_bf16 v[192:207], v[72:75], v[68:71], v[192:207]
    ds_read_b128 v[96:99], v35 offset:0
    ds_read_b64_tr_b16 v[92:93], v27 offset:24576
    v_mfma_f32_32x32x16_bf16 v[144:159], v[76:79], v[64:67], v[144:159]
    ds_read_b64_tr_b16 v[94:95], v27 offset:26624
    ds_read_b128 v[100:103], v35 offset:4096
    v_mfma_f32_32x32x16_bf16 v[208:223], v[76:79], v[68:71], v[208:223]
    ds_read_b128 v[104:107], v35 offset:8192
    ds_read_b128 v[108:111], v35 offset:12288
    v_mfma_f32_32x32x16_bf16 v[160:175], v[80:83], v[64:67], v[160:175]
    v_mfma_f32_32x32x16_bf16 v[224:239], v[80:83], v[68:71], v[224:239]
    v_mfma_f32_32x32x16_bf16 v[176:191], v[84:87], v[64:67], v[176:191]
    v_mfma_f32_32x32x16_bf16 v[240:255], v[84:87], v[68:71], v[240:255]
    s_waitcnt vmcnt(0) lgkmcnt(0)
    s_barrier
    v_mfma_f32_32x32x16_bf16 v[128:143], v[96:99], v[88:91], v[128:143]
    ds_read_b64_tr_b16 v[64:65], v24 offset:0
    ds_read_b64_tr_b16 v[66:67], v24 offset:2048
    ds_read_b128 v[72:75], v28 offset:0
    ds_read_b64_tr_b16 v[68:69], v25 offset:0
    v_mfma_f32_32x32x16_bf16 v[192:207], v[96:99], v[92:95], v[192:207]
    ds_read_b64_tr_b16 v[70:71], v25 offset:2048
    ds_read_b128 v[76:79], v28 offset:4096
    ds_read_b128 v[80:83], v28 offset:8192
    ds_read_b128 v[84:87], v28 offset:12288
    v_mfma_f32_32x32x16_bf16 v[144:159], v[100:103], v[88:91], v[144:159]
    s_add_u32 m0, s53, 65536
    s_add_u32 s54, s51, 3670016
    buffer_load_dwordx4 v6, s[28:31], s54 offen sc1 lds
    s_add_u32 m0, s53, 73728
    v_mfma_f32_32x32x16_bf16 v[208:223], v[100:103], v[92:95], v[208:223]
    s_add_u32 s54, s51, 3801088
    buffer_load_dwordx4 v6, s[28:31], s54 offen sc1 lds
    s_add_u32 m0, s53, 81920
    s_add_u32 s54, s51, 3932160
    v_mfma_f32_32x32x16_bf16 v[160:175], v[104:107], v[88:91], v[160:175]
    buffer_load_dwordx4 v6, s[28:31], s54 offen sc1 lds
    s_add_u32 m0, s53, 90112
    s_add_u32 s54, s51, 4063232
    buffer_load_dwordx4 v6, s[28:31], s54 offen sc1 lds
    v_mfma_f32_32x32x16_bf16 v[224:239], v[104:107], v[92:95], v[224:239]
    s_add_u32 m0, s53, 98304
    s_add_u32 s54, s52, 896
    buffer_load_dwordx4 v10, s[32:35], s54 offen sc1 lds
    s_add_u32 m0, s53, 106496
    v_mfma_f32_32x32x16_bf16 v[176:191], v[108:111], v[88:91], v[176:191]
    s_add_u32 s54, s52, 66432
    buffer_load_dwordx4 v10, s[32:35], s54 offen sc1 lds
    s_add_u32 m0, s53, 114688
    s_add_u32 s54, s52, 131968
    v_mfma_f32_32x32x16_bf16 v[240:255], v[108:111], v[92:95], v[240:255]
    buffer_load_dwordx4 v10, s[32:35], s54 offen sc1 lds
    s_add_u32 m0, s53, 122880
    s_add_u32 s54, s52, 197504
    buffer_load_dwordx4 v10, s[32:35], s54 offen sc1 lds
    s_waitcnt lgkmcnt(0)
    v_mfma_f32_32x32x16_bf16 v[128:143], v[72:75], v[64:67], v[128:143]
    ds_read_b64_tr_b16 v[88:89], v24 offset:8192
    ds_read_b64_tr_b16 v[90:91], v24 offset:10240
    v_mfma_f32_32x32x16_bf16 v[192:207], v[72:75], v[68:71], v[192:207]
    ds_read_b128 v[96:99], v29 offset:0
    ds_read_b64_tr_b16 v[92:93], v25 offset:8192
    v_mfma_f32_32x32x16_bf16 v[144:159], v[76:79], v[64:67], v[144:159]
    ds_read_b64_tr_b16 v[94:95], v25 offset:10240
    ds_read_b128 v[100:103], v29 offset:4096
    v_mfma_f32_32x32x16_bf16 v[208:223], v[76:79], v[68:71], v[208:223]
    ds_read_b128 v[104:107], v29 offset:8192
    ds_read_b128 v[108:111], v29 offset:12288
    v_mfma_f32_32x32x16_bf16 v[160:175], v[80:83], v[64:67], v[160:175]
    v_mfma_f32_32x32x16_bf16 v[224:239], v[80:83], v[68:71], v[224:239]
    v_mfma_f32_32x32x16_bf16 v[176:191], v[84:87], v[64:67], v[176:191]
    v_mfma_f32_32x32x16_bf16 v[240:255], v[84:87], v[68:71], v[240:255]
    s_waitcnt lgkmcnt(0)
    v_mfma_f32_32x32x16_bf16 v[128:143], v[96:99], v[88:91], v[128:143]
    ds_read_b64_tr_b16 v[64:65], v24 offset:16384
    ds_read_b64_tr_b16 v[66:67], v24 offset:18432
    v_mfma_f32_32x32x16_bf16 v[192:207], v[96:99], v[92:95], v[192:207]
    ds_read_b128 v[72:75], v30 offset:0
    ds_read_b64_tr_b16 v[68:69], v25 offset:16384
    v_mfma_f32_32x32x16_bf16 v[144:159], v[100:103], v[88:91], v[144:159]
    ds_read_b64_tr_b16 v[70:71], v25 offset:18432
    ds_read_b128 v[76:79], v30 offset:4096
    v_mfma_f32_32x32x16_bf16 v[208:223], v[100:103], v[92:95], v[208:223]
    ds_read_b128 v[80:83], v30 offset:8192
    ds_read_b128 v[84:87], v30 offset:12288
    v_mfma_f32_32x32x16_bf16 v[160:175], v[104:107], v[88:91], v[160:175]
    v_mfma_f32_32x32x16_bf16 v[224:239], v[104:107], v[92:95], v[224:239]
    v_mfma_f32_32x32x16_bf16 v[176:191], v[108:111], v[88:91], v[176:191]
    v_mfma_f32_32x32x16_bf16 v[240:255], v[108:111], v[92:95], v[240:255]
    s_waitcnt lgkmcnt(0)
    v_mfma_f32_32x32x16_bf16 v[128:143], v[72:75], v[64:67], v[128:143]
    ds_read_b64_tr_b16 v[88:89], v24 offset:24576
    ds_read_b64_tr_b16 v[90:91], v24 offset:26624
    v_mfma_f32_32x32x16_bf16 v[192:207], v[72:75], v[68:71], v[192:207]
    ds_read_b128 v[96:99], v31 offset:0
    ds_read_b64_tr_b16 v[92:93], v25 offset:24576
    v_mfma_f32_32x32x16_bf16 v[144:159], v[76:79], v[64:67], v[144:159]
    ds_read_b64_tr_b16 v[94:95], v25 offset:26624
    ds_read_b128 v[100:103], v31 offset:4096
    v_mfma_f32_32x32x16_bf16 v[208:223], v[76:79], v[68:71], v[208:223]
    ds_read_b128 v[104:107], v31 offset:8192
    ds_read_b128 v[108:111], v31 offset:12288
    v_mfma_f32_32x32x16_bf16 v[160:175], v[80:83], v[64:67], v[160:175]
    v_mfma_f32_32x32x16_bf16 v[224:239], v[80:83], v[68:71], v[224:239]
    v_mfma_f32_32x32x16_bf16 v[176:191], v[84:87], v[64:67], v[176:191]
    v_mfma_f32_32x32x16_bf16 v[240:255], v[84:87], v[68:71], v[240:255]
    s_waitcnt vmcnt(0) lgkmcnt(0)
    s_barrier
    v_mfma_f32_32x32x16_bf16 v[128:143], v[96:99], v[88:91], v[128:143]
    ds_read_b64_tr_b16 v[64:65], v26 offset:0
    ds_read_b64_tr_b16 v[66:67], v26 offset:2048
    ds_read_b128 v[72:75], v32 offset:0
    ds_read_b64_tr_b16 v[68:69], v27 offset:0
    v_mfma_f32_32x32x16_bf16 v[192:207], v[96:99], v[92:95], v[192:207]
    ds_read_b64_tr_b16 v[70:71], v27 offset:2048
    ds_read_b128 v[76:79], v32 offset:4096
    ds_read_b128 v[80:83], v32 offset:8192
    ds_read_b128 v[84:87], v32 offset:12288
    v_mfma_f32_32x32x16_bf16 v[144:159], v[100:103], v[88:91], v[144:159]
    v_mfma_f32_32x32x16_bf16 v[208:223], v[100:103], v[92:95], v[208:223]
    v_mfma_f32_32x32x16_bf16 v[160:175], v[104:107], v[88:91], v[160:175]
    v_mfma_f32_32x32x16_bf16 v[224:239], v[104:107], v[92:95], v[224:239]
    v_mfma_f32_32x32x16_bf16 v[176:191], v[108:111], v[88:91], v[176:191]
    v_mfma_f32_32x32x16_bf16 v[240:255], v[108:111], v[92:95], v[240:255]
    s_waitcnt lgkmcnt(0)
    v_mfma_f32_32x32x16_bf16 v[128:143], v[72:75], v[64:67], v[128:143]
    ds_read_b64_tr_b16 v[88:89], v26 offset:8192
    ds_read_b64_tr_b16 v[90:91], v26 offset:10240
    v_mfma_f32_32x32x16_bf16 v[192:207], v[72:75], v[68:71], v[192:207]
    ds_read_b128 v[96:99], v33 offset:0
    ds_read_b64_tr_b16 v[92:93], v27 offset:8192
    v_mfma_f32_32x32x16_bf16 v[144:159], v[76:79], v[64:67], v[144:159]
    ds_read_b64_tr_b16 v[94:95], v27 offset:10240
    ds_read_b128 v[100:103], v33 offset:4096
    v_mfma_f32_32x32x16_bf16 v[208:223], v[76:79], v[68:71], v[208:223]
    ds_read_b128 v[104:107], v33 offset:8192
    ds_read_b128 v[108:111], v33 offset:12288
    v_mfma_f32_32x32x16_bf16 v[160:175], v[80:83], v[64:67], v[160:175]
    v_mfma_f32_32x32x16_bf16 v[224:239], v[80:83], v[68:71], v[224:239]
    v_mfma_f32_32x32x16_bf16 v[176:191], v[84:87], v[64:67], v[176:191]
    v_mfma_f32_32x32x16_bf16 v[240:255], v[84:87], v[68:71], v[240:255]
    s_waitcnt lgkmcnt(0)
    v_mfma_f32_32x32x16_bf16 v[128:143], v[96:99], v[88:91], v[128:143]
    ds_read_b64_tr_b16 v[64:65], v26 offset:16384
    ds_read_b64_tr_b16 v[66:67], v26 offset:18432
    v_mfma_f32_32x32x16_bf16 v[192:207], v[96:99], v[92:95], v[192:207]
    ds_read_b128 v[72:75], v34 offset:0
    ds_read_b64_tr_b16 v[68:69], v27 offset:16384
    v_mfma_f32_32x32x16_bf16 v[144:159], v[100:103], v[88:91], v[144:159]
    ds_read_b64_tr_b16 v[70:71], v27 offset:18432
    ds_read_b128 v[76:79], v34 offset:4096
    v_mfma_f32_32x32x16_bf16 v[208:223], v[100:103], v[92:95], v[208:223]
    ds_read_b128 v[80:83], v34 offset:8192
    ds_read_b128 v[84:87], v34 offset:12288
    v_mfma_f32_32x32x16_bf16 v[160:175], v[104:107], v[88:91], v[160:175]
    v_mfma_f32_32x32x16_bf16 v[224:239], v[104:107], v[92:95], v[224:239]
    v_mfma_f32_32x32x16_bf16 v[176:191], v[108:111], v[88:91], v[176:191]
    v_mfma_f32_32x32x16_bf16 v[240:255], v[108:111], v[92:95], v[240:255]
    s_waitcnt lgkmcnt(0)
    v_mfma_f32_32x32x16_bf16 v[128:143], v[72:75], v[64:67], v[128:143]
    ds_read_b64_tr_b16 v[88:89], v26 offset:24576
    ds_read_b64_tr_b16 v[90:91], v26 offset:26624
    v_mfma_f32_32x32x16_bf16 v[192:207], v[72:75], v[68:71], v[192:207]
    ds_read_b128 v[96:99], v35 offset:0
    ds_read_b64_tr_b16 v[92:93], v27 offset:24576
    v_mfma_f32_32x32x16_bf16 v[144:159], v[76:79], v[64:67], v[144:159]
    ds_read_b64_tr_b16 v[94:95], v27 offset:26624
    ds_read_b128 v[100:103], v35 offset:4096
    v_mfma_f32_32x32x16_bf16 v[208:223], v[76:79], v[68:71], v[208:223]
    ds_read_b128 v[104:107], v35 offset:8192
    ds_read_b128 v[108:111], v35 offset:12288
    v_mfma_f32_32x32x16_bf16 v[160:175], v[80:83], v[64:67], v[160:175]
    v_mfma_f32_32x32x16_bf16 v[224:239], v[80:83], v[68:71], v[224:239]
    v_mfma_f32_32x32x16_bf16 v[176:191], v[84:87], v[64:67], v[176:191]
    v_mfma_f32_32x32x16_bf16 v[240:255], v[84:87], v[68:71], v[240:255]
    s_waitcnt lgkmcnt(0)
    v_mfma_f32_32x32x16_bf16 v[128:143], v[96:99], v[88:91], v[128:143]
    v_mfma_f32_32x32x16_bf16 v[192:207], v[96:99], v[92:95], v[192:207]
    v_mfma_f32_32x32x16_bf16 v[144:159], v[100:103], v[88:91], v[144:159]
    v_mfma_f32_32x32x16_bf16 v[208:223], v[100:103], v[92:95], v[208:223]
    v_mfma_f32_32x32x16_bf16 v[160:175], v[104:107], v[88:91], v[160:175]
    v_mfma_f32_32x32x16_bf16 v[224:239], v[104:107], v[92:95], v[224:239]
    v_mfma_f32_32x32x16_bf16 v[176:191], v[108:111], v[88:91], v[176:191]
    v_mfma_f32_32x32x16_bf16 v[240:255], v[108:111], v[92:95], v[240:255]
    s_lshr_b32 s55, s25, 1
    s_and_b32 s55, s55, 1
    s_lshl_b32 s58, s24, 1
    s_add_u32 s58, s58, s55
    s_lshl_b32 s58, s58, 5
    s_lshl_b32 s59, s22, 2
    s_add_u32 s58, s58, s59
    s_lshr_b32 s59, s25, 2
    s_lshl_b32 s59, s59, 1
    s_add_u32 s58, s58, s59
    s_lshl_b32 s58, s58, 15
    s_and_b32 s59, s25, 1
    v_and_b32 v7, 31, v2
    v_lshrrev_b32 v8, 5, v2
    v_lshlrev_b32 v7, 4, v7
    s_lshl_b32 s59, s59, 10
    s_add_u32 s59, s59, 16384
    v_lshlrev_b32 v8, 11, v8
    v_add_u32 v7, v7, v8
    s_add_u32 s58, s58, s59
    v_add_u32 v7, s58, v7
    v_mov_b32 v47, v7
    s_mov_b32 s74, s23
    v_cvt_pk_bf16_f32 v255, v254, v255
    v_cvt_pk_bf16_f32 v254, v252, v253
    v_cvt_pk_bf16_f32 v253, v250, v251
    v_cvt_pk_bf16_f32 v252, v248, v249
    v_cvt_pk_bf16_f32 v251, v246, v247
    v_cvt_pk_bf16_f32 v250, v244, v245
    v_cvt_pk_bf16_f32 v249, v242, v243
    v_cvt_pk_bf16_f32 v248, v240, v241
    v_cvt_pk_bf16_f32 v247, v238, v239
    v_cvt_pk_bf16_f32 v246, v236, v237
    v_cvt_pk_bf16_f32 v245, v234, v235
    v_cvt_pk_bf16_f32 v244, v232, v233
    v_cvt_pk_bf16_f32 v243, v230, v231
    v_cvt_pk_bf16_f32 v242, v228, v229
    v_cvt_pk_bf16_f32 v241, v226, v227
    v_cvt_pk_bf16_f32 v240, v224, v225
    v_cvt_pk_bf16_f32 v239, v222, v223
    v_cvt_pk_bf16_f32 v238, v220, v221
    v_cvt_pk_bf16_f32 v237, v218, v219
    v_cvt_pk_bf16_f32 v236, v216, v217
    v_cvt_pk_bf16_f32 v235, v214, v215
    v_cvt_pk_bf16_f32 v234, v212, v213
    v_cvt_pk_bf16_f32 v233, v210, v211
    v_cvt_pk_bf16_f32 v232, v208, v209
    v_cvt_pk_bf16_f32 v231, v206, v207
    v_cvt_pk_bf16_f32 v230, v204, v205
    v_cvt_pk_bf16_f32 v229, v202, v203
    v_cvt_pk_bf16_f32 v228, v200, v201
    v_cvt_pk_bf16_f32 v227, v198, v199
    v_cvt_pk_bf16_f32 v226, v196, v197
    v_cvt_pk_bf16_f32 v225, v194, v195
    v_cvt_pk_bf16_f32 v224, v192, v193
    v_cvt_pk_bf16_f32 v223, v190, v191
    v_cvt_pk_bf16_f32 v222, v188, v189
    v_cvt_pk_bf16_f32 v221, v186, v187
    v_cvt_pk_bf16_f32 v220, v184, v185
    v_cvt_pk_bf16_f32 v219, v182, v183
    v_cvt_pk_bf16_f32 v218, v180, v181
    v_cvt_pk_bf16_f32 v217, v178, v179
    v_cvt_pk_bf16_f32 v216, v176, v177
    v_cvt_pk_bf16_f32 v215, v174, v175
    v_cvt_pk_bf16_f32 v214, v172, v173
    v_cvt_pk_bf16_f32 v213, v170, v171
    v_cvt_pk_bf16_f32 v212, v168, v169
    v_cvt_pk_bf16_f32 v211, v166, v167
    v_cvt_pk_bf16_f32 v210, v164, v165
    v_cvt_pk_bf16_f32 v209, v162, v163
    v_cvt_pk_bf16_f32 v208, v160, v161
    v_cvt_pk_bf16_f32 v207, v158, v159
    v_cvt_pk_bf16_f32 v206, v156, v157
    v_cvt_pk_bf16_f32 v205, v154, v155
    v_cvt_pk_bf16_f32 v204, v152, v153
    v_cvt_pk_bf16_f32 v203, v150, v151
    v_cvt_pk_bf16_f32 v202, v148, v149
    v_cvt_pk_bf16_f32 v201, v146, v147
    v_cvt_pk_bf16_f32 v200, v144, v145
    v_cvt_pk_bf16_f32 v199, v142, v143
    v_cvt_pk_bf16_f32 v198, v140, v141
    v_cvt_pk_bf16_f32 v197, v138, v139
    v_cvt_pk_bf16_f32 v196, v136, v137
    v_cvt_pk_bf16_f32 v195, v134, v135
    v_cvt_pk_bf16_f32 v194, v132, v133
    v_cvt_pk_bf16_f32 v193, v130, v131
    v_cvt_pk_bf16_f32 v192, v128, v129
L_kv_ln:
    s_barrier
L_kv_end:
    s_load_dwordx2 s[4:5], s[0:1], 16
    s_load_dwordx2 s[12:13], s[0:1], 104
    s_and_b32 s20, s2, 7
    s_lshl_b32 s20, s20, 2
    s_lshr_b32 s21, s2, 3
    s_and_b32 s21, s21, 3
    s_add_u32 s20, s20, s21
    s_lshr_b32 s21, s2, 5
    s_sub_u32 s22, 15, s21
    v_lshrrev_b32 v2, 6, v0
    v_and_b32 v1, 63, v0
    v_readfirstlane_b32 s25, v2
    s_waitcnt lgkmcnt(0)
    s_mov_b32 s28, s4
    s_mov_b32 s29, s5
    s_mov_b32 s30, 0x500000
    s_mov_b32 s31, 0x00020000
    s_mov_b32 s32, s12
    s_mov_b32 s33, s13
    s_mov_b32 s34, 0x280000
    s_mov_b32 s35, 0x00020000
    s_add_u32 s36, s12, 0x400000
    s_addc_u32 s37, s13, 0
    s_mov_b32 s38, 0x2000000
    s_mov_b32 s39, 0x00020000
    s_add_u32 s40, s12, 0x2800000
    s_addc_u32 s41, s13, 0
    s_mov_b32 s42, 0x1000000
    s_mov_b32 s43, 0x00020000
    s_lshl_b32 s50, s25, 2
    v_lshrrev_b32 v7, 4, v1
    v_lshlrev_b32 v8, 2, v7
    v_and_b32 v9, 15, v1
    v_xor_b32 v8, v8, v9
    v_lshlrev_b32 v8, 4, v8
    v_add_u32 v7, s50, v7
    v_lshlrev_b32 v7, 13, v7
    v_add_u32 v6, v7, v8
    s_lshl_b32 s53, s25, 10
    v_lshlrev_b32 v4, 4, v1
    v_add_u32 v4, s53, v4
    s_lshl_b32 s51, s20, 8
    s_mul_i32 s52, s21, 163840
    s_mul_i32 s55, s22, 163840
    s_add_u32 m0, s53, 0
    s_add_u32 s54, s51, 0
    buffer_load_dwordx4 v6, s[28:31], s54 offen sc1 lds
    s_add_u32 m0, s53, 8192
    s_add_u32 s54, s51, 262144
    buffer_load_dwordx4 v6, s[28:31], s54 offen sc1 lds
    s_add_u32 m0, s53, 49152
    s_add_u32 s54, s51, 524288
    buffer_load_dwordx4 v6, s[28:31], s54 offen sc1 lds
    s_add_u32 m0, s53, 57344
    s_add_u32 s54, s51, 786432
    buffer_load_dwordx4 v6, s[28:31], s54 offen sc1 lds
    s_cmp_eq_u32 s25, 0
    s_cbranch_scc0 L_fz_w5d
    v_and_b32 v9, 63, v0
    v_min_u32 v9, 31, v9
    v_and_b32 v8, 15, v9
    s_lshl_b32 s88, s21, 4
    s_lshl_b32 s89, s22, 4
    v_mov_b32 v10, s88
    v_mov_b32 v11, s89
    v_cmp_gt_u32 vcc, 16, v9
    s_nop 1
    v_cndmask_b32 v10, v11, v10, vcc
    v_add_u32 v8, v8, v10
    v_add_u32 v8, 1536, v8
    v_lshlrev_b32 v8, 3, v8
    s_mov_b32 s88, 0
L_fz_w5:
    buffer_load_dwordx2 v[10:11], v8, s[96:99], 0 offen sc0 sc1
    s_waitcnt vmcnt(0)
    v_cmp_eq_u64 vcc, s[100:101], v[10:11]
    s_add_u32 s88, s88, 1
    s_nop 0
    s_cmp_eq_u64 vcc, exec
    s_cbranch_scc1 L_fz_w5d
    s_sleep 1
    s_cmp_lt_u32 s88, 400000
    s_cbranch_scc1 L_fz_w5
L_fz_w5d:
    s_barrier
    s_add_u32 m0, s53, 16384
    s_add_u32 s54, s52, 0
    buffer_load_dwordx4 v4, s[32:35], s54 offen sc1 lds
    s_add_u32 m0, s53, 24576
    s_add_u32 s54, s52, 8192
    buffer_load_dwordx4 v4, s[32:35], s54 offen sc1 lds
    s_add_u32 m0, s53, 32768
    s_add_u32 s54, s55, 0
    buffer_load_dwordx4 v4, s[32:35], s54 offen sc1 lds
    s_add_u32 m0, s53, 40960
    s_add_u32 s54, s55, 8192
    buffer_load_dwordx4 v4, s[32:35], s54 offen sc1 lds
    s_add_u32 m0, s53, 65536
    s_add_u32 s54, s52, 16384
    buffer_load_dwordx4 v4, s[32:35], s54 offen sc1 lds
    s_add_u32 m0, s53, 73728
    s_add_u32 s54, s52, 24576
    buffer_load_dwordx4 v4, s[32:35], s54 offen sc1 lds
    s_add_u32 m0, s53, 81920
    s_add_u32 s54, s55, 16384
    buffer_load_dwordx4 v4, s[32:35], s54 offen sc1 lds
    s_add_u32 m0, s53, 90112
    s_add_u32 s54, s55, 24576
    buffer_load_dwordx4 v4, s[32:35], s54 offen sc1 lds
    v_and_b32 v7, 3, v1
    v_and_b32 v8, 1, v7
    v_lshlrev_b32 v8, 1, v8
    v_lshrrev_b32 v9, 1, v7
    v_or_b32 v7, v8, v9
    v_lshrrev_b32 v8, 1, v7
    v_and_b32 v7, 1, v7
    v_lshlrev_b32 v7, 3, v7
    v_lshrrev_b32 v9, 4, v1
    v_and_b32 v9, 1, v9
    v_lshlrev_b32 v9, 1, v9
    v_add_u32 v8, v8, v9
    s_and_b32 s56, s25, 1
    s_lshl_b32 s56, s56, 3
    v_add_u32 v8, s56, v8
    v_lshrrev_b32 v9, 2, v1
    v_and_b32 v9, 3, v9
    v_lshlrev_b32 v11, 2, v9
    v_lshrrev_b32 v12, 5, v1
    v_lshlrev_b32 v12, 3, v12
    v_add_u32 v12, v12, v9
    v_lshlrev_b32 v12, 8, v12
    v_add_u32 v12, v12, v7
    v_add_u32 v13, 0, v8
    v_xor_b32 v13, v13, v11
    v_lshlrev_b32 v13, 4, v13
    v_add_u32 v80, v12, v13
    v_add_u32 v82, 49152, v80
    v_add_u32 v84, 98304, v80
    v_add_u32 v13, 4, v8
    v_xor_b32 v13, v13, v11
    v_lshlrev_b32 v13, 4, v13
    v_add_u32 v81, v12, v13
    v_add_u32 v83, 49152, v81
    v_add_u32 v85, 98304, v81
    s_lshr_b32 s56, s25, 2
    s_lshl_b32 s56, s56, 14
    s_lshr_b32 s57, s25, 1
    s_and_b32 s57, s57, 1
    s_lshl_b32 s57, s57, 10
    s_add_u32 s56, s56, s57
    s_add_u32 s56, s56, 16384
    v_and_b32 v7, 31, v1
    v_lshlrev_b32 v7, 4, v7
    v_lshrrev_b32 v8, 5, v1
    v_lshlrev_b32 v8, 11, v8
    v_add_u32 v7, v7, v8
    v_add_u32 v86, s56, v7
    v_add_u32 v87, 49152, v86
    v_add_u32 v88, 98304, v86
    v_mov_b32 v128, 0
    v_mov_b32 v129, 0
    v_mov_b32 v130, 0
    v_mov_b32 v131, 0
    v_mov_b32 v132, 0
    v_mov_b32 v133, 0
    v_mov_b32 v134, 0
    v_mov_b32 v135, 0
    v_mov_b32 v136, 0
    v_mov_b32 v137, 0
    v_mov_b32 v138, 0
    v_mov_b32 v139, 0
    v_mov_b32 v140, 0
    v_mov_b32 v141, 0
    v_mov_b32 v142, 0
    v_mov_b32 v143, 0
    v_mov_b32 v144, 0
    v_mov_b32 v145, 0
    v_mov_b32 v146, 0
    v_mov_b32 v147, 0
    v_mov_b32 v148, 0
    v_mov_b32 v149, 0
    v_mov_b32 v150, 0
    v_mov_b32 v151, 0
    v_mov_b32 v152, 0
    v_mov_b32 v153, 0
    v_mov_b32 v154, 0
    v_mov_b32 v155, 0
    v_mov_b32 v156, 0
    v_mov_b32 v157, 0
    v_mov_b32 v158, 0
    v_mov_b32 v159, 0
    v_mov_b32 v160, 0
    v_mov_b32 v161, 0
    v_mov_b32 v162, 0
    v_mov_b32 v163, 0
    v_mov_b32 v164, 0
    v_mov_b32 v165, 0
    v_mov_b32 v166, 0
    v_mov_b32 v167, 0
    v_mov_b32 v168, 0
    v_mov_b32 v169, 0
    v_mov_b32 v170, 0
    v_mov_b32 v171, 0
    v_mov_b32 v172, 0
    v_mov_b32 v173, 0
    v_mov_b32 v174, 0
    v_mov_b32 v175, 0
    v_mov_b32 v176, 0
    v_mov_b32 v177, 0
    v_mov_b32 v178, 0
    v_mov_b32 v179, 0
    v_mov_b32 v180, 0
    v_mov_b32 v181, 0
    v_mov_b32 v182, 0
    v_mov_b32 v183, 0
    v_mov_b32 v184, 0
    v_mov_b32 v185, 0
    v_mov_b32 v186, 0
    v_mov_b32 v187, 0
    v_mov_b32 v188, 0
    v_mov_b32 v189, 0
    v_mov_b32 v190, 0
    v_mov_b32 v191, 0
    s_waitcnt vmcnt(4)
    s_barrier
    s_add_u32 m0, s53, 98304
    s_add_u32 s54, s51, 1048576
    buffer_load_dwordx4 v6, s[28:31], s54 offen sc1 lds
    s_add_u32 m0, s53, 106496
    s_add_u32 s54, s51, 1310720
    buffer_load_dwordx4 v6, s[28:31], s54 offen sc1 lds
    s_add_u32 m0, s53, 114688
    s_add_u32 s54, s52, 32768
    buffer_load_dwordx4 v4, s[32:35], s54 offen sc1 lds
    s_add_u32 m0, s53, 122880
    s_add_u32 s54, s52, 40960
    buffer_load_dwordx4 v4, s[32:35], s54 offen sc1 lds
    s_add_u32 m0, s53, 131072
    s_add_u32 s54, s55, 32768
    buffer_load_dwordx4 v4, s[32:35], s54 offen sc1 lds
    s_add_u32 m0, s53, 139264
    s_add_u32 s54, s55, 40960
    buffer_load_dwordx4 v4, s[32:35], s54 offen sc1 lds
    ds_read_b64_tr_b16 v[48:49], v80 offset:0
    ds_read_b64_tr_b16 v[50:51], v80 offset:1024
    ds_read_b128 v[56:59], v86 offset:0
    ds_read_b64_tr_b16 v[52:53], v81 offset:0
    ds_read_b64_tr_b16 v[54:55], v81 offset:1024
    ds_read_b128 v[60:63], v86 offset:512
    s_waitcnt lgkmcnt(0)
    v_mfma_f32_32x32x16_bf16 v[128:143], v[48:51], v[56:59], v[128:143]
    ds_read_b64_tr_b16 v[64:65], v80 offset:4096
    ds_read_b64_tr_b16 v[66:67], v80 offset:5120
    v_mfma_f32_32x32x16_bf16 v[160:175], v[52:55], v[56:59], v[160:175]
    ds_read_b128 v[72:75], v86 offset:4096
    ds_read_b64_tr_b16 v[68:69], v81 offset:4096
    v_mfma_f32_32x32x16_bf16 v[144:159], v[48:51], v[60:63], v[144:159]
    ds_read_b64_tr_b16 v[70:71], v81 offset:5120
    ds_read_b128 v[76:79], v86 offset:4608
    v_mfma_f32_32x32x16_bf16 v[176:191], v[52:55], v[60:63], v[176:191]
    s_waitcnt lgkmcnt(0)
    v_mfma_f32_32x32x16_bf16 v[128:143], v[64:67], v[72:75], v[128:143]
    ds_read_b64_tr_b16 v[48:49], v80 offset:8192
    ds_read_b64_tr_b16 v[50:51], v80 offset:9216
    v_mfma_f32_32x32x16_bf16 v[160:175], v[68:71], v[72:75], v[160:175]
    ds_read_b128 v[56:59], v86 offset:8192
    ds_read_b64_tr_b16 v[52:53], v81 offset:8192
    v_mfma_f32_32x32x16_bf16 v[144:159], v[64:67], v[76:79], v[144:159]
    ds_read_b64_tr_b16 v[54:55], v81 offset:9216
    ds_read_b128 v[60:63], v86 offset:8704
    v_mfma_f32_32x32x16_bf16 v[176:191], v[68:71], v[76:79], v[176:191]
    s_waitcnt lgkmcnt(0)
    v_mfma_f32_32x32x16_bf16 v[128:143], v[48:51], v[56:59], v[128:143]
    ds_read_b64_tr_b16 v[64:65], v80 offset:12288
    ds_read_b64_tr_b16 v[66:67], v80 offset:13312
    v_mfma_f32_32x32x16_bf16 v[160:175], v[52:55], v[56:59], v[160:175]
    ds_read_b128 v[72:75], v86 offset:12288
    ds_read_b64_tr_b16 v[68:69], v81 offset:12288
    v_mfma_f32_32x32x16_bf16 v[144:159], v[48:51], v[60:63], v[144:159]
    ds_read_b64_tr_b16 v[70:71], v81 offset:13312
    ds_read_b128 v[76:79], v86 offset:12800
    v_mfma_f32_32x32x16_bf16 v[176:191], v[52:55], v[60:63], v[176:191]
    s_waitcnt vmcnt(6) lgkmcnt(0)
    s_barrier
    v_mfma_f32_32x32x16_bf16 v[128:143], v[64:67], v[72:75], v[128:143]
    ds_read_b64_tr_b16 v[48:49], v82 offset:0
    ds_read_b64_tr_b16 v[50:51], v82 offset:1024
    ds_read_b128 v[56:59], v87 offset:0
    ds_read_b64_tr_b16 v[52:53], v83 offset:0
    ds_read_b64_tr_b16 v[54:55], v83 offset:1024
    ds_read_b128 v[60:63], v87 offset:512
    s_cmp_eq_u32 s74, 0
    s_mov_b32 s61, 0
    v_mfma_f32_32x32x16_bf16 v[160:175], v[68:71], v[72:75], v[160:175]
    s_cselect_b32 s60, 0, s61
    buffer_store_dwordx4 v[192:195], v47, s[36:39], s60 offen sc1
    s_cmp_eq_u32 s74, 0
    s_mov_b32 s61, 4096
    s_cselect_b32 s60, 2048, s61
    buffer_store_dwordx4 v[196:199], v47, s[36:39], s60 offen sc1
    s_add_u32 m0, s53, 0
    s_add_u32 s54, s51, 1572864
    v_mfma_f32_32x32x16_bf16 v[144:159], v[64:67], v[76:79], v[144:159]
    buffer_load_dwordx4 v6, s[28:31], s54 offen sc1 lds
    s_add_u32 m0, s53, 8192
    s_add_u32 s54, s51, 1835008
    buffer_load_dwordx4 v6, s[28:31], s54 offen sc1 lds
    s_add_u32 m0, s53, 16384
    s_add_u32 s54, s52, 49152
    buffer_load_dwordx4 v4, s[32:35], s54 offen sc1 lds
    s_add_u32 m0, s53, 24576
    v_mfma_f32_32x32x16_bf16 v[176:191], v[68:71], v[76:79], v[176:191]
    s_add_u32 s54, s52, 57344
    buffer_load_dwordx4 v4, s[32:35], s54 offen sc1 lds
    s_add_u32 m0, s53, 32768
    s_add_u32 s54, s55, 49152
    buffer_load_dwordx4 v4, s[32:35], s54 offen sc1 lds
    s_add_u32 m0, s53, 40960
    s_add_u32 s54, s55, 57344
    buffer_load_dwordx4 v4, s[32:35], s54 offen sc1 lds
    s_waitcnt lgkmcnt(0)
    v_mfma_f32_32x32x16_bf16 v[128:143], v[48:51], v[56:59], v[128:143]
    ds_read_b64_tr_b16 v[64:65], v82 offset:4096
    ds_read_b64_tr_b16 v[66:67], v82 offset:5120
    v_mfma_f32_32x32x16_bf16 v[160:175], v[52:55], v[56:59], v[160:175]
    ds_read_b128 v[72:75], v87 offset:4096
    ds_read_b64_tr_b16 v[68:69], v83 offset:4096
    v_mfma_f32_32x32x16_bf16 v[144:159], v[48:51], v[60:63], v[144:159]
    ds_read_b64_tr_b16 v[70:71], v83 offset:5120
    ds_read_b128 v[76:79], v87 offset:4608
    v_mfma_f32_32x32x16_bf16 v[176:191], v[52:55], v[60:63], v[176:191]
    s_waitcnt lgkmcnt(0)
    v_mfma_f32_32x32x16_bf16 v[128:143], v[64:67], v[72:75], v[128:143]
    ds_read_b64_tr_b16 v[48:49], v82 offset:8192
    ds_read_b64_tr_b16 v[50:51], v82 offset:9216
    v_mfma_f32_32x32x16_bf16 v[160:175], v[68:71], v[72:75], v[160:175]
    ds_read_b128 v[56:59], v87 offset:8192
    ds_read_b64_tr_b16 v[52:53], v83 offset:8192
    v_mfma_f32_32x32x16_bf16 v[144:159], v[64:67], v[76:79], v[144:159]
    ds_read_b64_tr_b16 v[54:55], v83 offset:9216
    ds_read_b128 v[60:63], v87 offset:8704
    v_mfma_f32_32x32x16_bf16 v[176:191], v[68:71], v[76:79], v[176:191]
    s_waitcnt lgkmcnt(0)
    v_mfma_f32_32x32x16_bf16 v[128:143], v[48:51], v[56:59], v[128:143]
    ds_read_b64_tr_b16 v[64:65], v82 offset:12288
    ds_read_b64_tr_b16 v[66:67], v82 offset:13312
    v_mfma_f32_32x32x16_bf16 v[160:175], v[52:55], v[56:59], v[160:175]
    ds_read_b128 v[72:75], v87 offset:12288
    ds_read_b64_tr_b16 v[68:69], v83 offset:12288
    v_mfma_f32_32x32x16_bf16 v[144:159], v[48:51], v[60:63], v[144:159]
    ds_read_b64_tr_b16 v[70:71], v83 offset:13312
    ds_read_b128 v[76:79], v87 offset:12800
    v_mfma_f32_32x32x16_bf16 v[176:191], v[52:55], v[60:63], v[176:191]
    s_waitcnt vmcnt(8) lgkmcnt(0)
    s_barrier
    v_mfma_f32_32x32x16_bf16 v[128:143], v[64:67], v[72:75], v[128:143]
    ds_read_b64_tr_b16 v[48:49], v84 offset:0
    ds_read_b64_tr_b16 v[50:51], v84 offset:1024
    ds_read_b128 v[56:59], v88 offset:0
    ds_read_b64_tr_b16 v[52:53], v85 offset:0
    ds_read_b64_tr_b16 v[54:55], v85 offset:1024
    ds_read_b128 v[60:63], v88 offset:512
    s_cmp_eq_u32 s74, 0
    s_mov_b32 s61, 512
    v_mfma_f32_32x32x16_bf16 v[160:175], v[68:71], v[72:75], v[160:175]
    s_cselect_b32 s60, 4096, s61
    buffer_store_dwordx4 v[224:227], v47, s[36:39], s60 offen sc1
    s_cmp_eq_u32 s74, 0
    s_mov_b32 s61, 4608
    s_cselect_b32 s60, 6144, s61
    buffer_store_dwordx4 v[228:231], v47, s[36:39], s60 offen sc1
    s_add_u32 m0, s53, 49152
    s_add_u32 s54, s51, 2097152
    v_mfma_f32_32x32x16_bf16 v[144:159], v[64:67], v[76:79], v[144:159]
    buffer_load_dwordx4 v6, s[28:31], s54 offen sc1 lds
    s_add_u32 m0, s53, 57344
    s_add_u32 s54, s51, 2359296
    buffer_load_dwordx4 v6, s[28:31], s54 offen sc1 lds
    s_add_u32 m0, s53, 65536
    s_add_u32 s54, s52, 65536
    buffer_load_dwordx4 v4, s[32:35], s54 offen sc1 lds
    s_add_u32 m0, s53, 73728
    v_mfma_f32_32x32x16_bf16 v[176:191], v[68:71], v[76:79], v[176:191]
    s_add_u32 s54, s52, 73728
    buffer_load_dwordx4 v4, s[32:35], s54 offen sc1 lds
    s_add_u32 m0, s53, 81920
    s_add_u32 s54, s55, 65536
    buffer_load_dwordx4 v4, s[32:35], s54 offen sc1 lds
    s_add_u32 m0, s53, 90112
    s_add_u32 s54, s55, 73728
    buffer_load_dwordx4 v4, s[32:35], s54 offen sc1 lds
    s_waitcnt lgkmcnt(0)
    v_mfma_f32_32x32x16_bf16 v[128:143], v[48:51], v[56:59], v[128:143]
    ds_read_b64_tr_b16 v[64:65], v84 offset:4096
    ds_read_b64_tr_b16 v[66:67], v84 offset:5120
    v_mfma_f32_32x32x16_bf16 v[160:175], v[52:55], v[56:59], v[160:175]
    ds_read_b128 v[72:75], v88 offset:4096
    ds_read_b64_tr_b16 v[68:69], v85 offset:4096
    v_mfma_f32_32x32x16_bf16 v[144:159], v[48:51], v[60:63], v[144:159]
    ds_read_b64_tr_b16 v[70:71], v85 offset:5120
    ds_read_b128 v[76:79], v88 offset:4608
    v_mfma_f32_32x32x16_bf16 v[176:191], v[52:55], v[60:63], v[176:191]
    s_waitcnt lgkmcnt(0)
    v_mfma_f32_32x32x16_bf16 v[128:143], v[64:67], v[72:75], v[128:143]
    ds_read_b64_tr_b16 v[48:49], v84 offset:8192
    ds_read_b64_tr_b16 v[50:51], v84 offset:9216
    v_mfma_f32_32x32x16_bf16 v[160:175], v[68:71], v[72:75], v[160:175]
    ds_read_b128 v[56:59], v88 offset:8192
    ds_read_b64_tr_b16 v[52:53], v85 offset:8192
    v_mfma_f32_32x32x16_bf16 v[144:159], v[64:67], v[76:79], v[144:159]
    ds_read_b64_tr_b16 v[54:55], v85 offset:9216
    ds_read_b128 v[60:63], v88 offset:8704
    v_mfma_f32_32x32x16_bf16 v[176:191], v[68:71], v[76:79], v[176:191]
    s_waitcnt lgkmcnt(0)
    v_mfma_f32_32x32x16_bf16 v[128:143], v[48:51], v[56:59], v[128:143]
    ds_read_b64_tr_b16 v[64:65], v84 offset:12288
    ds_read_b64_tr_b16 v[66:67], v84 offset:13312
    v_mfma_f32_32x32x16_bf16 v[160:175], v[52:55], v[56:59], v[160:175]
    ds_read_b128 v[72:75], v88 offset:12288
    ds_read_b64_tr_b16 v[68:69], v85 offset:12288
    v_mfma_f32_32x32x16_bf16 v[144:159], v[48:51], v[60:63], v[144:159]
    ds_read_b64_tr_b16 v[70:71], v85 offset:13312
    ds_read_b128 v[76:79], v88 offset:12800
    v_mfma_f32_32x32x16_bf16 v[176:191], v[52:55], v[60:63], v[176:191]
    s_waitcnt vmcnt(8) lgkmcnt(0)
    s_barrier
    v_mfma_f32_32x32x16_bf16 v[128:143], v[64:67], v[72:75], v[128:143]
    ds_read_b64_tr_b16 v[48:49], v80 offset:0
    ds_read_b64_tr_b16 v[50:51], v80 offset:1024
    ds_read_b128 v[56:59], v86 offset:0
    ds_read_b64_tr_b16 v[52:53], v81 offset:0
    ds_read_b64_tr_b16 v[54:55], v81 offset:1024
    ds_read_b128 v[60:63], v86 offset:512
    s_cmp_eq_u32 s74, 0
    s_mov_b32 s61, 8192
    v_mfma_f32_32x32x16_bf16 v[160:175], v[68:71], v[72:75], v[160:175]
    s_cselect_b32 s60, 512, s61
    buffer_store_dwordx4 v[200:203], v47, s[36:39], s60 offen sc1
    s_cmp_eq_u32 s74, 0
    s_mov_b32 s61, 12288
    s_cselect_b32 s60, 2560, s61
    buffer_store_dwordx4 v[204:207], v47, s[36:39], s60 offen sc1
    s_add_u32 m0, s53, 98304
    s_add_u32 s54, s51, 2621440
    v_mfma_f32_32x32x16_bf16 v[144:159], v[64:67], v[76:79], v[144:159]
    buffer_load_dwordx4 v6, s[28:31], s54 offen sc1 lds
    s_add_u32 m0, s53, 106496
    s_add_u32 s54, s51, 2883584
    buffer_load_dwordx4 v6, s[28:31], s54 offen sc1 lds
    s_add_u32 m0, s53, 114688
    s_add_u32 s54, s52, 81920
    buffer_load_dwordx4 v4, s[32:35], s54 offen sc1 lds
    s_add_u32 m0, s53, 122880
    v_mfma_f32_32x32x16_bf16 v[176:191], v[68:71], v[76:79], v[176:191]
    s_add_u32 s54, s52, 90112
    buffer_load_dwordx4 v4, s[32:35], s54 offen sc1 lds
    s_add_u32 m0, s53, 131072
    s_add_u32 s54, s55, 81920
    buffer_load_dwordx4 v4, s[32:35], s54 offen sc1 lds
    s_add_u32 m0, s53, 139264
    s_add_u32 s54, s55, 90112
    buffer_load_dwordx4 v4, s[32:35], s54 offen sc1 lds
    s_waitcnt lgkmcnt(0)
    v_mfma_f32_32x32x16_bf16 v[128:143], v[48:51], v[56:59], v[128:143]
    ds_read_b64_tr_b16 v[64:65], v80 offset:4096
    ds_read_b64_tr_b16 v[66:67], v80 offset:5120
    v_mfma_f32_32x32x16_bf16 v[160:175], v[52:55], v[56:59], v[160:175]
    ds_read_b128 v[72:75], v86 offset:4096
    ds_read_b64_tr_b16 v[68:69], v81 offset:4096
    v_mfma_f32_32x32x16_bf16 v[144:159], v[48:51], v[60:63], v[144:159]
    ds_read_b64_tr_b16 v[70:71], v81 offset:5120
    ds_read_b128 v[76:79], v86 offset:4608
    v_mfma_f32_32x32x16_bf16 v[176:191], v[52:55], v[60:63], v[176:191]
    s_waitcnt lgkmcnt(0)
    v_mfma_f32_32x32x16_bf16 v[128:143], v[64:67], v[72:75], v[128:143]
    ds_read_b64_tr_b16 v[48:49], v80 offset:8192
    ds_read_b64_tr_b16 v[50:51], v80 offset:9216
    v_mfma_f32_32x32x16_bf16 v[160:175], v[68:71], v[72:75], v[160:175]
    ds_read_b128 v[56:59], v86 offset:8192
    ds_read_b64_tr_b16 v[52:53], v81 offset:8192
    v_mfma_f32_32x32x16_bf16 v[144:159], v[64:67], v[76:79], v[144:159]
    ds_read_b64_tr_b16 v[54:55], v81 offset:9216
    ds_read_b128 v[60:63], v86 offset:8704
    v_mfma_f32_32x32x16_bf16 v[176:191], v[68:71], v[76:79], v[176:191]
    s_waitcnt lgkmcnt(0)
    v_mfma_f32_32x32x16_bf16 v[128:143], v[48:51], v[56:59], v[128:143]
    ds_read_b64_tr_b16 v[64:65], v80 offset:12288
    ds_read_b64_tr_b16 v[66:67], v80 offset:13312
    v_mfma_f32_32x32x16_bf16 v[160:175], v[52:55], v[56:59], v[160:175]
    ds_read_b128 v[72:75], v86 offset:12288
    ds_read_b64_tr_b16 v[68:69], v81 offset:12288
    v_mfma_f32_32x32x16_bf16 v[144:159], v[48:51], v[60:63], v[144:159]
    ds_read_b64_tr_b16 v[70:71], v81 offset:13312
    ds_read_b128 v[76:79], v86 offset:12800
    v_mfma_f32_32x32x16_bf16 v[176:191], v[52:55], v[60:63], v[176:191]
    s_waitcnt vmcnt(8) lgkmcnt(0)
    s_barrier
    v_mfma_f32_32x32x16_bf16 v[128:143], v[64:67], v[72:75], v[128:143]
    ds_read_b64_tr_b16 v[48:49], v82 offset:0
    ds_read_b64_tr_b16 v[50:51], v82 offset:1024
    ds_read_b128 v[56:59], v87 offset:0
    ds_read_b64_tr_b16 v[52:53], v83 offset:0
    ds_read_b64_tr_b16 v[54:55], v83 offset:1024
    ds_read_b128 v[60:63], v87 offset:512
    s_cmp_eq_u32 s74, 0
    s_mov_b32 s61, 8704
    v_mfma_f32_32x32x16_bf16 v[160:175], v[68:71], v[72:75], v[160:175]
    s_cselect_b32 s60, 4608, s61
    buffer_store_dwordx4 v[232:235], v47, s[36:39], s60 offen sc1
    s_cmp_eq_u32 s74, 0
    s_mov_b32 s61, 12800
    s_cselect_b32 s60, 6656, s61
    buffer_store_dwordx4 v[236:239], v47, s[36:39], s60 offen sc1
    s_add_u32 m0, s53, 0
    s_add_u32 s54, s51, 3145728
    v_mfma_f32_32x32x16_bf16 v[144:159], v[64:67], v[76:79], v[144:159]
    buffer_load_dwordx4 v6, s[28:31], s54 offen sc1 lds
    s_add_u32 m0, s53, 8192
    s_add_u32 s54, s51, 3407872
    buffer_load_dwordx4 v6, s[28:31], s54 offen sc1 lds
    s_add_u32 m0, s53, 16384
    s_add_u32 s54, s52, 98304
    buffer_load_dwordx4 v4, s[32:35], s54 offen sc1 lds
    s_add_u32 m0, s53, 24576
    v_mfma_f32_32x32x16_bf16 v[176:191], v[68:71], v[76:79], v[176:191]
    s_add_u32 s54, s52, 106496
    buffer_load_dwordx4 v4, s[32:35], s54 offen sc1 lds
    s_add_u32 m0, s53, 32768
    s_add_u32 s54, s55, 98304
    buffer_load_dwordx4 v4, s[32:35], s54 offen sc1 lds
    s_add_u32 m0, s53, 40960
    s_add_u32 s54, s55, 106496
    buffer_load_dwordx4 v4, s[32:35], s54 offen sc1 lds
    s_waitcnt lgkmcnt(0)
    v_mfma_f32_32x32x16_bf16 v[128:143], v[48:51], v[56:59], v[128:143]
    ds_read_b64_tr_b16 v[64:65], v82 offset:4096
    ds_read_b64_tr_b16 v[66:67], v82 offset:5120
    v_mfma_f32_32x32x16_bf16 v[160:175], v[52:55], v[56:59], v[160:175]
    ds_read_b128 v[72:75], v87 offset:4096
    ds_read_b64_tr_b16 v[68:69], v83 offset:4096
    v_mfma_f32_32x32x16_bf16 v[144:159], v[48:51], v[60:63], v[144:159]
    ds_read_b64_tr_b16 v[70:71], v83 offset:5120
    ds_read_b128 v[76:79], v87 offset:4608
    v_mfma_f32_32x32x16_bf16 v[176:191], v[52:55], v[60:63], v[176:191]
    s_waitcnt lgkmcnt(0)
    v_mfma_f32_32x32x16_bf16 v[128:143], v[64:67], v[72:75], v[128:143]
    ds_read_b64_tr_b16 v[48:49], v82 offset:8192
    ds_read_b64_tr_b16 v[50:51], v82 offset:9216
    v_mfma_f32_32x32x16_bf16 v[160:175], v[68:71], v[72:75], v[160:175]
    ds_read_b128 v[56:59], v87 offset:8192
    ds_read_b64_tr_b16 v[52:53], v83 offset:8192
    v_mfma_f32_32x32x16_bf16 v[144:159], v[64:67], v[76:79], v[144:159]
    ds_read_b64_tr_b16 v[54:55], v83 offset:9216
    ds_read_b128 v[60:63], v87 offset:8704
    v_mfma_f32_32x32x16_bf16 v[176:191], v[68:71], v[76:79], v[176:191]
    s_waitcnt lgkmcnt(0)
    v_mfma_f32_32x32x16_bf16 v[128:143], v[48:51], v[56:59], v[128:143]
    ds_read_b64_tr_b16 v[64:65], v82 offset:12288
    ds_read_b64_tr_b16 v[66:67], v82 offset:13312
    v_mfma_f32_32x32x16_bf16 v[160:175], v[52:55], v[56:59], v[160:175]
    ds_read_b128 v[72:75], v87 offset:12288
    ds_read_b64_tr_b16 v[68:69], v83 offset:12288
    v_mfma_f32_32x32x16_bf16 v[144:159], v[48:51], v[60:63], v[144:159]
    ds_read_b64_tr_b16 v[70:71], v83 offset:13312
    ds_read_b128 v[76:79], v87 offset:12800
    v_mfma_f32_32x32x16_bf16 v[176:191], v[52:55], v[60:63], v[176:191]
    s_waitcnt vmcnt(8) lgkmcnt(0)
    s_barrier
    v_mfma_f32_32x32x16_bf16 v[128:143], v[64:67], v[72:75], v[128:143]
    ds_read_b64_tr_b16 v[48:49], v84 offset:0
    ds_read_b64_tr_b16 v[50:51], v84 offset:1024
    ds_read_b128 v[56:59], v88 offset:0
    ds_read_b64_tr_b16 v[52:53], v85 offset:0
    ds_read_b64_tr_b16 v[54:55], v85 offset:1024
    ds_read_b128 v[60:63], v88 offset:512
    s_cmp_eq_u32 s74, 0
    s_mov_b32 s61, 32768
    v_mfma_f32_32x32x16_bf16 v[160:175], v[68:71], v[72:75], v[160:175]
    s_cselect_b32 s60, 32768, s61
    buffer_store_dwordx4 v[208:211], v47, s[36:39], s60 offen sc1
    s_cmp_eq_u32 s74, 0
    s_mov_b32 s61, 36864
    s_cselect_b32 s60, 34816, s61
    buffer_store_dwordx4 v[212:215], v47, s[36:39], s60 offen sc1
    s_add_u32 m0, s53, 49152
    s_add_u32 s54, s51, 3670016
    v_mfma_f32_32x32x16_bf16 v[144:159], v[64:67], v[76:79], v[144:159]
    buffer_load_dwordx4 v6, s[28:31], s54 offen sc1 lds
    s_add_u32 m0, s53, 57344
    s_add_u32 s54, s51, 3932160
    buffer_load_dwordx4 v6, s[28:31], s54 offen sc1 lds
    s_add_u32 m0, s53, 65536
    s_add_u32 s54, s52, 114688
    buffer_load_dwordx4 v4, s[32:35], s54 offen sc1 lds
    s_add_u32 m0, s53, 73728
    v_mfma_f32_32x32x16_bf16 v[176:191], v[68:71], v[76:79], v[176:191]
    s_add_u32 s54, s52, 122880
    buffer_load_dwordx4 v4, s[32:35], s54 offen sc1 lds
    s_add_u32 m0, s53, 81920
    s_add_u32 s54, s55, 114688
    buffer_load_dwordx4 v4, s[32:35], s54 offen sc1 lds
    s_add_u32 m0, s53, 90112
    s_add_u32 s54, s55, 122880
    buffer_load_dwordx4 v4, s[32:35], s54 offen sc1 lds
    s_waitcnt lgkmcnt(0)
    v_mfma_f32_32x32x16_bf16 v[128:143], v[48:51], v[56:59], v[128:143]
    ds_read_b64_tr_b16 v[64:65], v84 offset:4096
    ds_read_b64_tr_b16 v[66:67], v84 offset:5120
    v_mfma_f32_32x32x16_bf16 v[160:175], v[52:55], v[56:59], v[160:175]
    ds_read_b128 v[72:75], v88 offset:4096
    ds_read_b64_tr_b16 v[68:69], v85 offset:4096
    v_mfma_f32_32x32x16_bf16 v[144:159], v[48:51], v[60:63], v[144:159]
    ds_read_b64_tr_b16 v[70:71], v85 offset:5120
    ds_read_b128 v[76:79], v88 offset:4608
    v_mfma_f32_32x32x16_bf16 v[176:191], v[52:55], v[60:63], v[176:191]
    s_waitcnt lgkmcnt(0)
    v_mfma_f32_32x32x16_bf16 v[128:143], v[64:67], v[72:75], v[128:143]
    ds_read_b64_tr_b16 v[48:49], v84 offset:8192
    ds_read_b64_tr_b16 v[50:51], v84 offset:9216
    v_mfma_f32_32x32x16_bf16 v[160:175], v[68:71], v[72:75], v[160:175]
    ds_read_b128 v[56:59], v88 offset:8192
    ds_read_b64_tr_b16 v[52:53], v85 offset:8192
    v_mfma_f32_32x32x16_bf16 v[144:159], v[64:67], v[76:79], v[144:159]
    ds_read_b64_tr_b16 v[54:55], v85 offset:9216
    ds_read_b128 v[60:63], v88 offset:8704
    v_mfma_f32_32x32x16_bf16 v[176:191], v[68:71], v[76:79], v[176:191]
    s_waitcnt lgkmcnt(0)
    v_mfma_f32_32x32x16_bf16 v[128:143], v[48:51], v[56:59], v[128:143]
    ds_read_b64_tr_b16 v[64:65], v84 offset:12288
    ds_read_b64_tr_b16 v[66:67], v84 offset:13312
    v_mfma_f32_32x32x16_bf16 v[160:175], v[52:55], v[56:59], v[160:175]
    ds_read_b128 v[72:75], v88 offset:12288
    ds_read_b64_tr_b16 v[68:69], v85 offset:12288
    v_mfma_f32_32x32x16_bf16 v[144:159], v[48:51], v[60:63], v[144:159]
    ds_read_b64_tr_b16 v[70:71], v85 offset:13312
    ds_read_b128 v[76:79], v88 offset:12800
    v_mfma_f32_32x32x16_bf16 v[176:191], v[52:55], v[60:63], v[176:191]
    s_waitcnt vmcnt(8) lgkmcnt(0)
    s_barrier
    v_mfma_f32_32x32x16_bf16 v[128:143], v[64:67], v[72:75], v[128:143]
    ds_read_b64_tr_b16 v[48:49], v80 offset:0
    ds_read_b64_tr_b16 v[50:51], v80 offset:1024
    ds_read_b128 v[56:59], v86 offset:0
    ds_read_b64_tr_b16 v[52:53], v81 offset:0
    ds_read_b64_tr_b16 v[54:55], v81 offset:1024
    ds_read_b128 v[60:63], v86 offset:512
    s_cmp_eq_u32 s74, 0
    s_mov_b32 s61, 33280
    v_mfma_f32_32x32x16_bf16 v[160:175], v[68:71], v[72:75], v[160:175]
    s_cselect_b32 s60, 36864, s61
    buffer_store_dwordx4 v[240:243], v47, s[36:39], s60 offen sc1
    s_cmp_eq_u32 s74, 0
    s_mov_b32 s61, 37376
    s_cselect_b32 s60, 38912, s61
    buffer_store_dwordx4 v[244:247], v47, s[36:39], s60 offen sc1
    s_add_u32 m0, s53, 98304
    s_add_u32 s54, s51, 4194304
    v_mfma_f32_32x32x16_bf16 v[144:159], v[64:67], v[76:79], v[144:159]
    buffer_load_dwordx4 v6, s[28:31], s54 offen sc1 lds
    s_add_u32 m0, s53, 106496
    s_add_u32 s54, s51, 4456448
    buffer_load_dwordx4 v6, s[28:31], s54 offen sc1 lds
    s_add_u32 m0, s53, 114688
    s_add_u32 s54, s52, 131072
    buffer_load_dwordx4 v4, s[32:35], s54 offen sc1 lds
    s_add_u32 m0, s53, 122880
    v_mfma_f32_32x32x16_bf16 v[176:191], v[68:71], v[76:79], v[176:191]
    s_add_u32 s54, s52, 139264
    buffer_load_dwordx4 v4, s[32:35], s54 offen sc1 lds
    s_add_u32 m0, s53, 131072
    s_add_u32 s54, s55, 131072
    buffer_load_dwordx4 v4, s[32:35], s54 offen sc1 lds
    s_add_u32 m0, s53, 139264
    s_add_u32 s54, s55, 139264
    buffer_load_dwordx4 v4, s[32:35], s54 offen sc1 lds
    s_waitcnt lgkmcnt(0)
    v_mfma_f32_32x32x16_bf16 v[128:143], v[48:51], v[56:59], v[128:143]
    ds_read_b64_tr_b16 v[64:65], v80 offset:4096
    ds_read_b64_tr_b16 v[66:67], v80 offset:5120
    v_mfma_f32_32x32x16_bf16 v[160:175], v[52:55], v[56:59], v[160:175]
    ds_read_b128 v[72:75], v86 offset:4096
    ds_read_b64_tr_b16 v[68:69], v81 offset:4096
    v_mfma_f32_32x32x16_bf16 v[144:159], v[48:51], v[60:63], v[144:159]
    ds_read_b64_tr_b16 v[70:71], v81 offset:5120
    ds_read_b128 v[76:79], v86 offset:4608
    v_mfma_f32_32x32x16_bf16 v[176:191], v[52:55], v[60:63], v[176:191]
    s_waitcnt lgkmcnt(0)
    v_mfma_f32_32x32x16_bf16 v[128:143], v[64:67], v[72:75], v[128:143]
    ds_read_b64_tr_b16 v[48:49], v80 offset:8192
    ds_read_b64_tr_b16 v[50:51], v80 offset:9216
    v_mfma_f32_32x32x16_bf16 v[160:175], v[68:71], v[72:75], v[160:175]
    ds_read_b128 v[56:59], v86 offset:8192
    ds_read_b64_tr_b16 v[52:53], v81 offset:8192
    v_mfma_f32_32x32x16_bf16 v[144:159], v[64:67], v[76:79], v[144:159]
    ds_read_b64_tr_b16 v[54:55], v81 offset:9216
    ds_read_b128 v[60:63], v86 offset:8704
    v_mfma_f32_32x32x16_bf16 v[176:191], v[68:71], v[76:79], v[176:191]
    s_waitcnt lgkmcnt(0)
    v_mfma_f32_32x32x16_bf16 v[128:143], v[48:51], v[56:59], v[128:143]
    ds_read_b64_tr_b16 v[64:65], v80 offset:12288
    ds_read_b64_tr_b16 v[66:67], v80 offset:13312
    v_mfma_f32_32x32x16_bf16 v[160:175], v[52:55], v[56:59], v[160:175]
    ds_read_b128 v[72:75], v86 offset:12288
    ds_read_b64_tr_b16 v[68:69], v81 offset:12288
    v_mfma_f32_32x32x16_bf16 v[144:159], v[48:51], v[60:63], v[144:159]
    ds_read_b64_tr_b16 v[70:71], v81 offset:13312
    ds_read_b128 v[76:79], v86 offset:12800
    v_mfma_f32_32x32x16_bf16 v[176:191], v[52:55], v[60:63], v[176:191]
    s_waitcnt vmcnt(8) lgkmcnt(0)
    s_barrier
    v_mfma_f32_32x32x16_bf16 v[128:143], v[64:67], v[72:75], v[128:143]
    ds_read_b64_tr_b16 v[48:49], v82 offset:0
    ds_read_b64_tr_b16 v[50:51], v82 offset:1024
    ds_read_b128 v[56:59], v87 offset:0
    ds_read_b64_tr_b16 v[52:53], v83 offset:0
    ds_read_b64_tr_b16 v[54:55], v83 offset:1024
    ds_read_b128 v[60:63], v87 offset:512
    s_cmp_eq_u32 s74, 0
    s_mov_b32 s61, 40960
    v_mfma_f32_32x32x16_bf16 v[160:175], v[68:71], v[72:75], v[160:175]
    s_cselect_b32 s60, 33280, s61
    buffer_store_dwordx4 v[216:219], v47, s[36:39], s60 offen sc1
    s_cmp_eq_u32 s74, 0
    s_mov_b32 s61, 45056
    s_cselect_b32 s60, 35328, s61
    buffer_store_dwordx4 v[220:223], v47, s[36:39], s60 offen sc1
    s_add_u32 m0, s53, 0
    s_add_u32 s54, s51, 4718592
    v_mfma_f32_32x32x16_bf16 v[144:159], v[64:67], v[76:79], v[144:159]
    buffer_load_dwordx4 v6, s[28:31], s54 offen sc1 lds
    s_add_u32 m0, s53, 8192
    s_add_u32 s54, s51, 4980736
    buffer_load_dwordx4 v6, s[28:31], s54 offen sc1 lds
    s_add_u32 m0, s53, 16384
    s_add_u32 s54, s52, 147456
    buffer_load_dwordx4 v4, s[32:35], s54 offen sc1 lds
    s_add_u32 m0, s53, 24576
    v_mfma_f32_32x32x16_bf16 v[176:191], v[68:71], v[76:79], v[176:191]
    s_add_u32 s54, s52, 155648
    buffer_load_dwordx4 v4, s[32:35], s54 offen sc1 lds
    s_add_u32 m0, s53, 32768
    s_add_u32 s54, s55, 147456
    buffer_load_dwordx4 v4, s[32:35], s54 offen sc1 lds
    s_add_u32 m0, s53, 40960
    s_add_u32 s54, s55, 155648
    buffer_load_dwordx4 v4, s[32:35], s54 offen sc1 lds
    s_waitcnt lgkmcnt(0)
    v_mfma_f32_32x32x16_bf16 v[128:143], v[48:51], v[56:59], v[128:143]
    ds_read_b64_tr_b16 v[64:65], v82 offset:4096
    ds_read_b64_tr_b16 v[66:67], v82 offset:5120
    v_mfma_f32_32x32x16_bf16 v[160:175], v[52:55], v[56:59], v[160:175]
    ds_read_b128 v[72:75], v87 offset:4096
    ds_read_b64_tr_b16 v[68:69], v83 offset:4096
    v_mfma_f32_32x32x16_bf16 v[144:159], v[48:51], v[60:63], v[144:159]
    ds_read_b64_tr_b16 v[70:71], v83 offset:5120
    ds_read_b128 v[76:79], v87 offset:4608
    v_mfma_f32_32x32x16_bf16 v[176:191], v[52:55], v[60:63], v[176:191]
    s_waitcnt lgkmcnt(0)
    v_mfma_f32_32x32x16_bf16 v[128:143], v[64:67], v[72:75], v[128:143]
    ds_read_b64_tr_b16 v[48:49], v82 offset:8192
    ds_read_b64_tr_b16 v[50:51], v82 offset:9216
    v_mfma_f32_32x32x16_bf16 v[160:175], v[68:71], v[72:75], v[160:175]
    ds_read_b128 v[56:59], v87 offset:8192
    ds_read_b64_tr_b16 v[52:53], v83 offset:8192
    v_mfma_f32_32x32x16_bf16 v[144:159], v[64:67], v[76:79], v[144:159]
    ds_read_b64_tr_b16 v[54:55], v83 offset:9216
    ds_read_b128 v[60:63], v87 offset:8704
    v_mfma_f32_32x32x16_bf16 v[176:191], v[68:71], v[76:79], v[176:191]
    s_waitcnt lgkmcnt(0)
    v_mfma_f32_32x32x16_bf16 v[128:143], v[48:51], v[56:59], v[128:143]
    ds_read_b64_tr_b16 v[64:65], v82 offset:12288
    ds_read_b64_tr_b16 v[66:67], v82 offset:13312
    v_mfma_f32_32x32x16_bf16 v[160:175], v[52:55], v[56:59], v[160:175]
    ds_read_b128 v[72:75], v87 offset:12288
    ds_read_b64_tr_b16 v[68:69], v83 offset:12288
    v_mfma_f32_32x32x16_bf16 v[144:159], v[48:51], v[60:63], v[144:159]
    ds_read_b64_tr_b16 v[70:71], v83 offset:13312
    ds_read_b128 v[76:79], v87 offset:12800
    v_mfma_f32_32x32x16_bf16 v[176:191], v[52:55], v[60:63], v[176:191]
    s_waitcnt vmcnt(8) lgkmcnt(0)
    s_barrier
    v_mfma_f32_32x32x16_bf16 v[128:143], v[64:67], v[72:75], v[128:143]
    ds_read_b64_tr_b16 v[48:49], v84 offset:0
    ds_read_b64_tr_b16 v[50:51], v84 offset:1024
    ds_read_b128 v[56:59], v88 offset:0
    ds_read_b64_tr_b16 v[52:53], v85 offset:0
    ds_read_b64_tr_b16 v[54:55], v85 offset:1024
    ds_read_b128 v[60:63], v88 offset:512
    s_cmp_eq_u32 s74, 0
    s_mov_b32 s61, 41472
    v_mfma_f32_32x32x16_bf16 v[160:175], v[68:71], v[72:75], v[160:175]
    s_cselect_b32 s60, 37376, s61
    buffer_store_dwordx4 v[248:251], v47, s[36:39], s60 offen sc1
    s_cmp_eq_u32 s74, 0
    s_mov_b32 s61, 45568
    s_cselect_b32 s60, 39424, s61
    buffer_store_dwordx4 v[252:255], v47, s[36:39], s60 offen sc1
    v_mfma_f32_32x32x16_bf16 v[144:159], v[64:67], v[76:79], v[144:159]
    v_mfma_f32_32x32x16_bf16 v[176:191], v[68:71], v[76:79], v[176:191]
    s_waitcnt lgkmcnt(0)
    v_mfma_f32_32x32x16_bf16 v[128:143], v[48:51], v[56:59], v[128:143]
    ds_read_b64_tr_b16 v[64:65], v84 offset:4096
    ds_read_b64_tr_b16 v[66:67], v84 offset:5120
    v_mfma_f32_32x32x16_bf16 v[160:175], v[52:55], v[56:59], v[160:175]
    ds_read_b128 v[72:75], v88 offset:4096
    ds_read_b64_tr_b16 v[68:69], v85 offset:4096
    v_mfma_f32_32x32x16_bf16 v[144:159], v[48:51], v[60:63], v[144:159]
    ds_read_b64_tr_b16 v[70:71], v85 offset:5120
    ds_read_b128 v[76:79], v88 offset:4608
    v_mfma_f32_32x32x16_bf16 v[176:191], v[52:55], v[60:63], v[176:191]
    s_waitcnt lgkmcnt(0)
    v_mfma_f32_32x32x16_bf16 v[128:143], v[64:67], v[72:75], v[128:143]
    ds_read_b64_tr_b16 v[48:49], v84 offset:8192
    ds_read_b64_tr_b16 v[50:51], v84 offset:9216
    v_mfma_f32_32x32x16_bf16 v[160:175], v[68:71], v[72:75], v[160:175]
    ds_read_b128 v[56:59], v88 offset:8192
    ds_read_b64_tr_b16 v[52:53], v85 offset:8192
    v_mfma_f32_32x32x16_bf16 v[144:159], v[64:67], v[76:79], v[144:159]
    ds_read_b64_tr_b16 v[54:55], v85 offset:9216
    ds_read_b128 v[60:63], v88 offset:8704
    v_mfma_f32_32x32x16_bf16 v[176:191], v[68:71], v[76:79], v[176:191]
    s_waitcnt lgkmcnt(0)
    v_mfma_f32_32x32x16_bf16 v[128:143], v[48:51], v[56:59], v[128:143]
    ds_read_b64_tr_b16 v[64:65], v84 offset:12288
    ds_read_b64_tr_b16 v[66:67], v84 offset:13312
    v_mfma_f32_32x32x16_bf16 v[160:175], v[52:55], v[56:59], v[160:175]
    ds_read_b128 v[72:75], v88 offset:12288
    ds_read_b64_tr_b16 v[68:69], v85 offset:12288
    v_mfma_f32_32x32x16_bf16 v[144:159], v[48:51], v[60:63], v[144:159]
    ds_read_b64_tr_b16 v[70:71], v85 offset:13312
    ds_read_b128 v[76:79], v88 offset:12800
    v_mfma_f32_32x32x16_bf16 v[176:191], v[52:55], v[60:63], v[176:191]
    s_waitcnt vmcnt(2) lgkmcnt(0)
    s_barrier
    v_mfma_f32_32x32x16_bf16 v[128:143], v[64:67], v[72:75], v[128:143]
    ds_read_b64_tr_b16 v[48:49], v80 offset:0
    ds_read_b64_tr_b16 v[50:51], v80 offset:1024
    ds_read_b128 v[56:59], v86 offset:0
    ds_read_b64_tr_b16 v[52:53], v81 offset:0
    ds_read_b64_tr_b16 v[54:55], v81 offset:1024
    ds_read_b128 v[60:63], v86 offset:512
    v_mfma_f32_32x32x16_bf16 v[160:175], v[68:71], v[72:75], v[160:175]
    v_mfma_f32_32x32x16_bf16 v[144:159], v[64:67], v[76:79], v[144:159]
    v_mfma_f32_32x32x16_bf16 v[176:191], v[68:71], v[76:79], v[176:191]
    s_waitcnt lgkmcnt(0)
    v_mfma_f32_32x32x16_bf16 v[128:143], v[48:51], v[56:59], v[128:143]
    ds_read_b64_tr_b16 v[64:65], v80 offset:4096
    ds_read_b64_tr_b16 v[66:67], v80 offset:5120
    v_mfma_f32_32x32x16_bf16 v[160:175], v[52:55], v[56:59], v[160:175]
    ds_read_b128 v[72:75], v86 offset:4096
    ds_read_b64_tr_b16 v[68:69], v81 offset:4096
    v_mfma_f32_32x32x16_bf16 v[144:159], v[48:51], v[60:63], v[144:159]
    ds_read_b64_tr_b16 v[70:71], v81 offset:5120
    ds_read_b128 v[76:79], v86 offset:4608
    v_mfma_f32_32x32x16_bf16 v[176:191], v[52:55], v[60:63], v[176:191]
    s_waitcnt lgkmcnt(0)
    v_mfma_f32_32x32x16_bf16 v[128:143], v[64:67], v[72:75], v[128:143]
    ds_read_b64_tr_b16 v[48:49], v80 offset:8192
    ds_read_b64_tr_b16 v[50:51], v80 offset:9216
    v_mfma_f32_32x32x16_bf16 v[160:175], v[68:71], v[72:75], v[160:175]
    ds_read_b128 v[56:59], v86 offset:8192
    ds_read_b64_tr_b16 v[52:53], v81 offset:8192
    v_mfma_f32_32x32x16_bf16 v[144:159], v[64:67], v[76:79], v[144:159]
    ds_read_b64_tr_b16 v[54:55], v81 offset:9216
    ds_read_b128 v[60:63], v86 offset:8704
    v_mfma_f32_32x32x16_bf16 v[176:191], v[68:71], v[76:79], v[176:191]
    s_waitcnt lgkmcnt(0)
    v_mfma_f32_32x32x16_bf16 v[128:143], v[48:51], v[56:59], v[128:143]
    ds_read_b64_tr_b16 v[64:65], v80 offset:12288
    ds_read_b64_tr_b16 v[66:67], v80 offset:13312
    v_mfma_f32_32x32x16_bf16 v[160:175], v[52:55], v[56:59], v[160:175]
    ds_read_b128 v[72:75], v86 offset:12288
    ds_read_b64_tr_b16 v[68:69], v81 offset:12288
    v_mfma_f32_32x32x16_bf16 v[144:159], v[48:51], v[60:63], v[144:159]
    ds_read_b64_tr_b16 v[70:71], v81 offset:13312
    ds_read_b128 v[76:79], v86 offset:12800
    v_mfma_f32_32x32x16_bf16 v[176:191], v[52:55], v[60:63], v[176:191]
    s_waitcnt lgkmcnt(0)
    v_mfma_f32_32x32x16_bf16 v[128:143], v[64:67], v[72:75], v[128:143]
    v_mfma_f32_32x32x16_bf16 v[160:175], v[68:71], v[72:75], v[160:175]
    v_mfma_f32_32x32x16_bf16 v[144:159], v[64:67], v[76:79], v[144:159]
    v_mfma_f32_32x32x16_bf16 v[176:191], v[68:71], v[76:79], v[176:191]
    s_barrier
    s_waitcnt vmcnt(0)
    s_barrier
    s_cmp_eq_u32 s25, 0
    s_cbranch_scc0 L_fz_s6
    s_lshl_b32 s88, s2, 3
    s_add_u32 s88, s88, 0
    s_mov_b64 exec, 1
    v_mov_b32 v248, s100
    v_mov_b32 v249, s101
    v_mov_b32 v250, 0
    buffer_store_dwordx2 v[248:249], v250, s[96:99], s88 offen sc0 sc1
    s_mov_b64 exec, -1
L_fz_s6:
    s_lshl_b32 s84, s25, 8
    s_add_u32 s84, s84, s2
    s_cmp_lt_u32 s84, 640
    s_cbranch_scc0 L_pf_at_0
    s_load_dwordx2 s[86:87], s[0:1], 40
    s_sub_u32 s85, s84, 0
    s_lshl_b32 s85, s85, 13
    v_lshlrev_b32 v46, 7, v1
    s_waitcnt lgkmcnt(0)
    s_mov_b32 s76, s86
    s_mov_b32 s77, s87
    s_mov_b32 s78, 0x500000
    s_mov_b32 s79, 0x00020000
    buffer_load_dword v45, v46, s[76:79], s85 offen sc1
L_pf_at_0:
    s_cmp_lt_u32 s84, 910
    s_cbranch_scc0 L_pf_at_1
    s_cmp_ge_u32 s84, 640
    s_cbranch_scc0 L_pf_at_1
    s_load_dwordx2 s[86:87], s[0:1], 56
    s_sub_u32 s85, s84, 640
    s_lshl_b32 s85, s85, 13
    v_lshlrev_b32 v46, 7, v1
    s_waitcnt lgkmcnt(0)
    s_mov_b32 s76, s86
    s_mov_b32 s77, s87
    s_mov_b32 s78, 0x21c000
    s_mov_b32 s79, 0x00020000
    buffer_load_dword v45, v46, s[76:79], s85 offen sc1
L_pf_at_1:
    s_cmp_lt_u32 s84, 1180
    s_cbranch_scc0 L_pf_at_2
    s_cmp_ge_u32 s84, 910
    s_cbranch_scc0 L_pf_at_2
    s_load_dwordx2 s[86:87], s[0:1], 72
    s_sub_u32 s85, s84, 910
    s_lshl_b32 s85, s85, 13
    v_lshlrev_b32 v46, 7, v1
    s_waitcnt lgkmcnt(0)
    s_mov_b32 s76, s86
    s_mov_b32 s77, s87
    s_mov_b32 s78, 0x21c000
    s_mov_b32 s79, 0x00020000
    buffer_load_dword v45, v46, s[76:79], s85 offen sc1
L_pf_at_2:
    s_lshr_b32 s56, s25, 2
    s_lshl_b32 s56, s56, 15
    s_add_u32 s56, s56, 98304
    s_lshr_b32 s57, s25, 1
    s_and_b32 s57, s57, 1
    s_lshl_b32 s57, s57, 10
    s_add_u32 s56, s56, s57
    s_and_b32 s57, s25, 1
    s_lshl_b32 s57, s57, 14
    s_add_u32 s56, s56, s57
    v_add_u32 v7, s56, v7
    s_mov_b32 s62, 0x3e0293ee
    v_mul_f32 v128, s62, v128
    v_mul_f32 v129, s62, v129
    v_mul_f32 v130, s62, v130
    v_mul_f32 v131, s62, v131
    v_mul_f32 v132, s62, v132
    v_mul_f32 v133, s62, v133
    v_mul_f32 v134, s62, v134
    v_mul_f32 v135, s62, v135
    v_cvt_pk_bf16_f32 v48, v128, v129
    v_cvt_pk_bf16_f32 v49, v130, v131
    v_cvt_pk_bf16_f32 v50, v132, v133
    v_cvt_pk_bf16_f32 v51, v134, v135
    ds_write_b128 v7, v[48:51] offset:0
    v_mul_f32 v136, s62, v136
    v_mul_f32 v137, s62, v137
    v_mul_f32 v138, s62, v138
    v_mul_f32 v139, s62, v139
    v_mul_f32 v140, s62, v140
    v_mul_f32 v141, s62, v141
    v_mul_f32 v142, s62, v142
    v_mul_f32 v143, s62, v143
    v_cvt_pk_bf16_f32 v52, v136, v137
    v_cvt_pk_bf16_f32 v53, v138, v139
    v_cvt_pk_bf16_f32 v54, v140, v141
    v_cvt_pk_bf16_f32 v55, v142, v143
    ds_write_b128 v7, v[52:55] offset:4096
    v_mul_f32 v160, s62, v160
    v_mul_f32 v161, s62, v161
    v_mul_f32 v162, s62, v162
    v_mul_f32 v163, s62, v163
    v_mul_f32 v164, s62, v164
    v_mul_f32 v165, s62, v165
    v_mul_f32 v166, s62, v166
    v_mul_f32 v167, s62, v167
    v_cvt_pk_bf16_f32 v56, v160, v161
    v_cvt_pk_bf16_f32 v57, v162, v163
    v_cvt_pk_bf16_f32 v58, v164, v165
    v_cvt_pk_bf16_f32 v59, v166, v167
    ds_write_b128 v7, v[56:59] offset:8192
    v_mul_f32 v168, s62, v168
    v_mul_f32 v169, s62, v169
    v_mul_f32 v170, s62, v170
    v_mul_f32 v171, s62, v171
    v_mul_f32 v172, s62, v172
    v_mul_f32 v173, s62, v173
    v_mul_f32 v174, s62, v174
    v_mul_f32 v175, s62, v175
    v_cvt_pk_bf16_f32 v60, v168, v169
    v_cvt_pk_bf16_f32 v61, v170, v171
    v_cvt_pk_bf16_f32 v62, v172, v173
    v_cvt_pk_bf16_f32 v63, v174, v175
    ds_write_b128 v7, v[60:63] offset:12288
    v_mul_f32 v144, s62, v144
    v_mul_f32 v145, s62, v145
    v_mul_f32 v146, s62, v146
    v_mul_f32 v147, s62, v147
    v_mul_f32 v148, s62, v148
    v_mul_f32 v149, s62, v149
    v_mul_f32 v150, s62, v150
    v_mul_f32 v151, s62, v151
    v_cvt_pk_bf16_f32 v48, v144, v145
    v_cvt_pk_bf16_f32 v49, v146, v147
    v_cvt_pk_bf16_f32 v50, v148, v149
    v_cvt_pk_bf16_f32 v51, v150, v151
    ds_write_b128 v7, v[48:51] offset:512
    v_mul_f32 v152, s62, v152
    v_mul_f32 v153, s62, v153
    v_mul_f32 v154, s62, v154
    v_mul_f32 v155, s62, v155
    v_mul_f32 v156, s62, v156
    v_mul_f32 v157, s62, v157
    v_mul_f32 v158, s62, v158
    v_mul_f32 v159, s62, v159
    v_cvt_pk_bf16_f32 v52, v152, v153
    v_cvt_pk_bf16_f32 v53, v154, v155
    v_cvt_pk_bf16_f32 v54, v156, v157
    v_cvt_pk_bf16_f32 v55, v158, v159
    ds_write_b128 v7, v[52:55] offset:4608
    v_mul_f32 v176, s62, v176
    v_mul_f32 v177, s62, v177
    v_mul_f32 v178, s62, v178
    v_mul_f32 v179, s62, v179
    v_mul_f32 v180, s62, v180
    v_mul_f32 v181, s62, v181
    v_mul_f32 v182, s62, v182
    v_mul_f32 v183, s62, v183
    v_cvt_pk_bf16_f32 v56, v176, v177
    v_cvt_pk_bf16_f32 v57, v178, v179
    v_cvt_pk_bf16_f32 v58, v180, v181
    v_cvt_pk_bf16_f32 v59, v182, v183
    ds_write_b128 v7, v[56:59] offset:8704
    v_mul_f32 v184, s62, v184
    v_mul_f32 v185, s62, v185
    v_mul_f32 v186, s62, v186
    v_mul_f32 v187, s62, v187
    v_mul_f32 v188, s62, v188
    v_mul_f32 v189, s62, v189
    v_mul_f32 v190, s62, v190
    v_mul_f32 v191, s62, v191
    v_cvt_pk_bf16_f32 v60, v184, v185
    v_cvt_pk_bf16_f32 v61, v186, v187
    v_cvt_pk_bf16_f32 v62, v188, v189
    v_cvt_pk_bf16_f32 v63, v190, v191
    ds_write_b128 v7, v[60:63] offset:12800
    s_waitcnt lgkmcnt(0)
    s_barrier
    s_lshr_b32 s26, s25, 2
    s_and_b32 s27, s25, 3
    v_and_b32 v9, 31, v1
    v_and_b32 v10, 0x13, v9
    v_and_b32 v11, 4, v9
    v_lshlrev_b32 v11, 1, v11
    v_or_b32 v10, v10, v11
    v_and_b32 v11, 8, v9
    v_lshrrev_b32 v11, 1, v11
    v_or_b32 v10, v10, v11
    v_lshlrev_b32 v10, 4, v10
    v_lshrrev_b32 v11, 5, v1
    s_lshl_b32 s56, s26, 16
    v_lshlrev_b32 v12, 10, v11
    v_add_u32 v12, v12, v10
    v_add_u32 v2, s56, v12
    v_lshlrev_b32 v12, 11, v11
    v_add_u32 v12, v12, v10
    s_add_u32 s57, s56, 32768
    v_add_u32 v3, s57, v12
    s_lshl_b32 s58, s27, 10
    v_lshlrev_b32 v4, 4, v1
    v_add_u32 v4, s58, v4
    s_add_u32 s59, s56, s58
    s_lshl_b32 s60, s27, 5
    s_lshl_b32 s61, s26, 6
    s_sub_u32 s60, s60, s61
    v_lshlrev_b32 v12, 3, v11
    v_sub_u32 v12, v9, v12
    v_add_u32 v8, s60, v12
    v_lshlrev_b32 v12, 11, v11
    v_lshlrev_b32 v13, 4, v9
    v_add_u32 v12, v12, v13
    s_lshl_b32 s61, s27, 9
    v_add_u32 v9, s61, v12
    s_mov_b32 s63, 0
    s_mov_b32 s64, s21
    s_lshl_b32 s65, s20, 20
    s_lshl_b32 s66, s26, 15
    s_add_u32 s65, s65, s66
    v_mov_b32 v243, 0x41000000
    s_cmp_eq_u32 s25, 0
    s_cbranch_scc0 L_fz_w7d
    v_and_b32 v11, 63, v0
    v_min_u32 v11, 15, v11
    s_lshr_b32 s88, s20, 1
    s_and_b32 s88, s88, 1
    s_lshr_b32 s89, s20, 2
    v_lshrrev_b32 v12, 3, v11
    v_lshlrev_b32 v12, 1, v12
    v_add_u32 v12, s88, v12
    v_lshlrev_b32 v12, 3, v12
    v_and_b32 v10, 7, v11
    v_add_u32 v10, v10, v12
    v_lshlrev_b32 v10, 3, v10
    v_add_u32 v10, s89, v10
    v_add_u32 v10, 0, v10
    v_lshlrev_b32 v10, 3, v10
    s_mov_b32 s88, 0
L_fz_w7:
    buffer_load_dwordx2 v[12:13], v10, s[96:99], 0 offen sc0 sc1
    s_waitcnt vmcnt(0)
    v_cmp_eq_u64 vcc, s[100:101], v[12:13]
    s_add_u32 s88, s88, 1
    s_nop 0
    s_cmp_eq_u64 vcc, exec
    s_cbranch_scc1 L_fz_w7d
    s_sleep 1
    s_cmp_lt_u32 s88, 400000
    s_cbranch_scc1 L_fz_w7
L_fz_w7d:
    s_barrier
L_at_tile:
    s_mul_i32 s66, s63, 32768
    s_add_u32 s66, s66, 98304
    v_add_u32 v12, s66, v9
    ds_read_b128 v[16:19], v12 offset:0
    ds_read_b128 v[20:23], v12 offset:4096
    ds_read_b128 v[24:27], v12 offset:8192
    ds_read_b128 v[28:31], v12 offset:12288
    ds_read_b128 v[32:35], v12 offset:16384
    ds_read_b128 v[36:39], v12 offset:20480
    ds_read_b128 v[40:43], v12 offset:24576
    ds_read_b128 v[44:47], v12 offset:28672
    s_waitcnt lgkmcnt(0)
    s_barrier
    s_add_u32 s67, s64, 1
    s_lshl_b32 s73, s64, 16
    s_add_u32 s73, s73, s65
    s_mov_b32 s77, s65
    s_add_u32 m0, s59, 0
    s_add_u32 s54, s65, 0
    buffer_load_dwordx4 v4, s[36:39], s54 offen sc1 lds
    s_add_u32 m0, s59, 4096
    s_add_u32 s54, s65, 4096
    buffer_load_dwordx4 v4, s[36:39], s54 offen sc1 lds
    s_add_u32 m0, s59, 8192
    s_add_u32 s54, s65, 8192
    buffer_load_dwordx4 v4, s[36:39], s54 offen sc1 lds
    s_add_u32 m0, s59, 12288
    s_add_u32 s54, s65, 12288
    buffer_load_dwordx4 v4, s[36:39], s54 offen sc1 lds
    s_add_u32 s68, s65, 65536
    s_min_u32 s68, s68, s73
    s_add_u32 m0, s59, 16384
    s_add_u32 s54, s68, 0
    buffer_load_dwordx4 v4, s[36:39], s54 offen sc1 lds
    s_add_u32 m0, s59, 20480
    s_add_u32 s54, s68, 4096
    buffer_load_dwordx4 v4, s[36:39], s54 offen sc1 lds
    s_add_u32 m0, s59, 24576
    s_add_u32 s54, s68, 8192
    buffer_load_dwordx4 v4, s[36:39], s54 offen sc1 lds
    s_add_u32 m0, s59, 28672
    s_add_u32 s54, s68, 12288
    buffer_load_dwordx4 v4, s[36:39], s54 offen sc1 lds
    s_add_u32 m0, s59, 32768
    s_add_u32 s54, s65, 16384
    buffer_load_dwordx4 v4, s[36:39], s54 offen sc1 lds
    s_add_u32 m0, s59, 36864
    s_add_u32 s54, s65, 20480
    buffer_load_dwordx4 v4, s[36:39], s54 offen sc1 lds
    s_add_u32 m0, s59, 40960
    s_add_u32 s54, s65, 24576
    buffer_load_dwordx4 v4, s[36:39], s54 offen sc1 lds
    s_add_u32 m0, s59, 45056
    s_add_u32 s54, s65, 28672
    buffer_load_dwordx4 v4, s[36:39], s54 offen sc1 lds
    v_mov_b32 v6, 0
    v_mov_b32 v128, 0
    v_mov_b32 v129, 0
    v_mov_b32 v130, 0
    v_mov_b32 v131, 0
    v_mov_b32 v132, 0
    v_mov_b32 v133, 0
    v_mov_b32 v134, 0
    v_mov_b32 v135, 0
    v_mov_b32 v136, 0
    v_mov_b32 v137, 0
    v_mov_b32 v138, 0
    v_mov_b32 v139, 0
    v_mov_b32 v140, 0
    v_mov_b32 v141, 0
    v_mov_b32 v142, 0
    v_mov_b32 v143, 0
    v_mov_b32 v144, 0
    v_mov_b32 v145, 0
    v_mov_b32 v146, 0
    v_mov_b32 v147, 0
    v_mov_b32 v148, 0
    v_mov_b32 v149, 0
    v_mov_b32 v150, 0
    v_mov_b32 v151, 0
    v_mov_b32 v152, 0
    v_mov_b32 v153, 0
    v_mov_b32 v154, 0
    v_mov_b32 v155, 0
    v_mov_b32 v156, 0
    v_mov_b32 v157, 0
    v_mov_b32 v158, 0
    v_mov_b32 v159, 0
    v_mov_b32 v160, 0
    v_mov_b32 v161, 0
    v_mov_b32 v162, 0
    v_mov_b32 v163, 0
    v_mov_b32 v164, 0
    v_mov_b32 v165, 0
    v_mov_b32 v166, 0
    v_mov_b32 v167, 0
    v_mov_b32 v168, 0
    v_mov_b32 v169, 0
    v_mov_b32 v170, 0
    v_mov_b32 v171, 0
    v_mov_b32 v172, 0
    v_mov_b32 v173, 0
    v_mov_b32 v174, 0
    v_mov_b32 v175, 0
    v_mov_b32 v176, 0
    v_mov_b32 v177, 0
    v_mov_b32 v178, 0
    v_mov_b32 v179, 0
    v_mov_b32 v180, 0
    v_mov_b32 v181, 0
    v_mov_b32 v182, 0
    v_mov_b32 v183, 0
    v_mov_b32 v184, 0
    v_mov_b32 v185, 0
    v_mov_b32 v186, 0
    v_mov_b32 v187, 0
    v_mov_b32 v188, 0
    v_mov_b32 v189, 0
    v_mov_b32 v190, 0
    v_mov_b32 v191, 0
    s_waitcnt vmcnt(8)
    s_barrier
    ds_read_b128 v[192:195], v2 offset:0
    ds_read_b128 v[196:199], v2 offset:2048
    ds_read_b128 v[200:203], v2 offset:4096
    ds_read_b128 v[204:207], v2 offset:6144
    ds_read_b128 v[208:211], v2 offset:8192
    ds_read_b128 v[212:215], v2 offset:10240
    s_waitcnt lgkmcnt(5)
    v_mfma_f32_32x32x16_bf16 v[48:63], v[192:195], v[16:19], 0
    ds_read_b128 v[216:219], v2 offset:12288
    s_waitcnt lgkmcnt(5)
    v_mfma_f32_32x32x16_bf16 v[48:63], v[196:199], v[20:23], v[48:63]
    ds_read_b128 v[220:223], v2 offset:14336
    s_waitcnt lgkmcnt(5)
    v_mfma_f32_32x32x16_bf16 v[48:63], v[200:203], v[24:27], v[48:63]
    ds_read_b128 v[192:195], v2 offset:512
    s_waitcnt lgkmcnt(5)
    v_mfma_f32_32x32x16_bf16 v[48:63], v[204:207], v[28:31], v[48:63]
    ds_read_b128 v[196:199], v2 offset:2560
    s_waitcnt lgkmcnt(5)
    v_mfma_f32_32x32x16_bf16 v[48:63], v[208:211], v[32:35], v[48:63]
    ds_read_b128 v[200:203], v2 offset:4608
    s_waitcnt lgkmcnt(5)
    v_mfma_f32_32x32x16_bf16 v[48:63], v[212:215], v[36:39], v[48:63]
    ds_read_b128 v[204:207], v2 offset:6656
    s_waitcnt lgkmcnt(5)
    v_mfma_f32_32x32x16_bf16 v[48:63], v[216:219], v[40:43], v[48:63]
    ds_read_b128 v[208:211], v2 offset:8704
    s_waitcnt lgkmcnt(5)
    v_mfma_f32_32x32x16_bf16 v[48:63], v[220:223], v[44:47], v[48:63]
    ds_read_b128 v[212:215], v2 offset:10752
    s_waitcnt lgkmcnt(5)
    v_mfma_f32_32x32x16_bf16 v[64:79], v[192:195], v[16:19], 0
    ds_read_b128 v[216:219], v2 offset:12800
    s_waitcnt lgkmcnt(5)
    v_mfma_f32_32x32x16_bf16 v[64:79], v[196:199], v[20:23], v[64:79]
    ds_read_b128 v[220:223], v2 offset:14848
    s_waitcnt lgkmcnt(5)
    v_mfma_f32_32x32x16_bf16 v[64:79], v[200:203], v[24:27], v[64:79]
    s_waitcnt lgkmcnt(4)
    v_mfma_f32_32x32x16_bf16 v[64:79], v[204:207], v[28:31], v[64:79]
    s_waitcnt lgkmcnt(3)
    v_mfma_f32_32x32x16_bf16 v[64:79], v[208:211], v[32:35], v[64:79]
    s_waitcnt lgkmcnt(2)
    v_mfma_f32_32x32x16_bf16 v[64:79], v[212:215], v[36:39], v[64:79]
    s_waitcnt lgkmcnt(1)
    v_mfma_f32_32x32x16_bf16 v[64:79], v[216:219], v[40:43], v[64:79]
    s_waitcnt lgkmcnt(0)
    v_mfma_f32_32x32x16_bf16 v[64:79], v[220:223], v[44:47], v[64:79]
    s_cmp_eq_u32 s67, 1
    s_nop 2
    s_cbranch_scc0 L_at_nomask0
    v_mov_b32 v241, 0xff800000
    v_cmp_le_i32 vcc, 0, v8
    s_nop 1
    v_cndmask_b32 v48, v241, v48, vcc
    v_cmp_le_i32 vcc, 1, v8
    s_nop 1
    v_cndmask_b32 v49, v241, v49, vcc
    v_cmp_le_i32 vcc, 2, v8
    s_nop 1
    v_cndmask_b32 v50, v241, v50, vcc
    v_cmp_le_i32 vcc, 3, v8
    s_nop 1
    v_cndmask_b32 v51, v241, v51, vcc
    v_cmp_le_i32 vcc, 4, v8
    s_nop 1
    v_cndmask_b32 v52, v241, v52, vcc
    v_cmp_le_i32 vcc, 5, v8
    s_nop 1
    v_cndmask_b32 v53, v241, v53, vcc
    v_cmp_le_i32 vcc, 6, v8
    s_nop 1
    v_cndmask_b32 v54, v241, v54, vcc
    v_cmp_le_i32 vcc, 7, v8
    s_nop 1
    v_cndmask_b32 v55, v241, v55, vcc
    v_cmp_le_i32 vcc, 16, v8
    s_nop 1
    v_cndmask_b32 v56, v241, v56, vcc
    v_cmp_le_i32 vcc, 17, v8
    s_nop 1
    v_cndmask_b32 v57, v241, v57, vcc
    v_cmp_le_i32 vcc, 18, v8
    s_nop 1
    v_cndmask_b32 v58, v241, v58, vcc
    v_cmp_le_i32 vcc, 19, v8
    s_nop 1
    v_cndmask_b32 v59, v241, v59, vcc
    v_cmp_le_i32 vcc, 20, v8
    s_nop 1
    v_cndmask_b32 v60, v241, v60, vcc
    v_cmp_le_i32 vcc, 21, v8
    s_nop 1
    v_cndmask_b32 v61, v241, v61, vcc
    v_cmp_le_i32 vcc, 22, v8
    s_nop 1
    v_cndmask_b32 v62, v241, v62, vcc
    v_cmp_le_i32 vcc, 23, v8
    s_nop 1
    v_cndmask_b32 v63, v241, v63, vcc
    v_cmp_le_i32 vcc, 32, v8
    s_nop 1
    v_cndmask_b32 v64, v241, v64, vcc
    v_cmp_le_i32 vcc, 33, v8
    s_nop 1
    v_cndmask_b32 v65, v241, v65, vcc
    v_cmp_le_i32 vcc, 34, v8
    s_nop 1
    v_cndmask_b32 v66, v241, v66, vcc
    v_cmp_le_i32 vcc, 35, v8
    s_nop 1
    v_cndmask_b32 v67, v241, v67, vcc
    v_cmp_le_i32 vcc, 36, v8
    s_nop 1
    v_cndmask_b32 v68, v241, v68, vcc
    v_cmp_le_i32 vcc, 37, v8
    s_nop 1
    v_cndmask_b32 v69, v241, v69, vcc
    v_cmp_le_i32 vcc, 38, v8
    s_nop 1
    v_cndmask_b32 v70, v241, v70, vcc
    v_cmp_le_i32 vcc, 39, v8
    s_nop 1
    v_cndmask_b32 v71, v241, v71, vcc
    v_cmp_le_i32 vcc, 48, v8
    s_nop 1
    v_cndmask_b32 v72, v241, v72, vcc
    v_cmp_le_i32 vcc, 49, v8
    s_nop 1
    v_cndmask_b32 v73, v241, v73, vcc
    v_cmp_le_i32 vcc, 50, v8
    s_nop 1
    v_cndmask_b32 v74, v241, v74, vcc
    v_cmp_le_i32 vcc, 51, v8
    s_nop 1
    v_cndmask_b32 v75, v241, v75, vcc
    v_cmp_le_i32 vcc, 52, v8
    s_nop 1
    v_cndmask_b32 v76, v241, v76, vcc
    v_cmp_le_i32 vcc, 53, v8
    s_nop 1
    v_cndmask_b32 v77, v241, v77, vcc
    v_cmp_le_i32 vcc, 54, v8
    s_nop 1
    v_cndmask_b32 v78, v241, v78, vcc
    v_cmp_le_i32 vcc, 55, v8
    s_nop 1
    v_cndmask_b32 v79, v241, v79, vcc
L_at_nomask0:
    v_max3_f32 v240, v48, v49, v50
    v_max3_f32 v242, v51, v52, v53
    v_max3_f32 v240, v240, v54, v55
    v_max3_f32 v242, v242, v56, v57
    v_max3_f32 v240, v240, v58, v59
    v_max3_f32 v242, v242, v60, v61
    v_max3_f32 v240, v240, v62, v63
    v_max3_f32 v242, v242, v64, v65
    v_max3_f32 v240, v240, v66, v67
    v_max3_f32 v242, v242, v68, v69
    v_max3_f32 v240, v240, v70, v71
    v_max3_f32 v242, v242, v72, v73
    v_max3_f32 v240, v240, v74, v75
    v_max3_f32 v242, v242, v76, v77
    v_max3_f32 v240, v240, v78, v79
    v_max_f32 v240, v240, v242
    v_mov_b32 v242, v240
    s_nop 1
    v_permlane32_swap_b32 v240, v242
    v_max_f32 v240, v240, v242
    v_max_f32 v240, 0xf149f2ca, v240
    v_sub_f32 v48, v48, v240
    v_sub_f32 v49, v49, v240
    v_sub_f32 v50, v50, v240
    v_sub_f32 v51, v51, v240
    v_sub_f32 v52, v52, v240
    v_sub_f32 v53, v53, v240
    v_sub_f32 v54, v54, v240
    v_sub_f32 v55, v55, v240
    v_sub_f32 v56, v56, v240
    v_sub_f32 v57, v57, v240
    v_sub_f32 v58, v58, v240
    v_sub_f32 v59, v59, v240
    v_sub_f32 v60, v60, v240
    v_sub_f32 v61, v61, v240
    v_sub_f32 v62, v62, v240
    v_sub_f32 v63, v63, v240
    v_sub_f32 v64, v64, v240
    v_sub_f32 v65, v65, v240
    v_sub_f32 v66, v66, v240
    v_sub_f32 v67, v67, v240
    v_sub_f32 v68, v68, v240
    v_sub_f32 v69, v69, v240
    v_sub_f32 v70, v70, v240
    v_sub_f32 v71, v71, v240
    v_sub_f32 v72, v72, v240
    v_sub_f32 v73, v73, v240
    v_sub_f32 v74, v74, v240
    v_sub_f32 v75, v75, v240
    v_sub_f32 v76, v76, v240
    v_sub_f32 v77, v77, v240
    v_sub_f32 v78, v78, v240
    v_sub_f32 v79, v79, v240
    v_sub_f32 v224, 0, v240
    v_sub_f32 v225, 0, v240
    v_sub_f32 v226, 0, v240
    v_sub_f32 v227, 0, v240
    v_sub_f32 v228, 0, v240
    v_sub_f32 v229, 0, v240
    v_sub_f32 v230, 0, v240
    v_sub_f32 v231, 0, v240
    v_sub_f32 v232, 0, v240
    v_sub_f32 v233, 0, v240
    v_sub_f32 v234, 0, v240
    v_sub_f32 v235, 0, v240
    v_sub_f32 v236, 0, v240
    v_sub_f32 v237, 0, v240
    v_sub_f32 v238, 0, v240
    v_sub_f32 v239, 0, v240
    v_mov_b32 v240, 0
    s_mov_b32 s69, 0
    s_add_u32 s70, s65, 65536
    s_waitcnt vmcnt(0)
    s_barrier
    ds_read_b128 v[192:195], v2 offset:16384
    ds_read_b128 v[196:199], v2 offset:18432
    ds_read_b128 v[200:203], v2 offset:20480
    ds_read_b128 v[204:207], v2 offset:22528
L_at_loop0:
    s_add_u32 s71, s69, 1
    s_cmp_eq_u32 s71, s67
    s_cbranch_scc1 L_at_last0
    s_add_u32 s72, s70, 65536
    s_add_u32 s71, s69, 2
    s_cmp_ge_u32 s71, s67
    s_cselect_b32 s72, s77, s72
    v_cmp_lt_f32 vcc, v243, v240
    s_nop 4
    s_cbranch_vccz L_at_rs0
    v_max_f32 v240, 0, v240
    v_sub_f32 v242, 0, v240
    v_exp_f32 v242, v242
    v_sub_f32 v48, v48, v240
    v_sub_f32 v49, v49, v240
    v_sub_f32 v50, v50, v240
    v_sub_f32 v51, v51, v240
    v_sub_f32 v52, v52, v240
    v_sub_f32 v53, v53, v240
    v_sub_f32 v54, v54, v240
    v_sub_f32 v55, v55, v240
    v_sub_f32 v56, v56, v240
    v_sub_f32 v57, v57, v240
    v_sub_f32 v58, v58, v240
    v_sub_f32 v59, v59, v240
    v_sub_f32 v60, v60, v240
    v_sub_f32 v61, v61, v240
    v_sub_f32 v62, v62, v240
    v_sub_f32 v63, v63, v240
    v_sub_f32 v64, v64, v240
    v_sub_f32 v65, v65, v240
    v_sub_f32 v66, v66, v240
    v_sub_f32 v67, v67, v240
    v_sub_f32 v68, v68, v240
    v_sub_f32 v69, v69, v240
    v_sub_f32 v70, v70, v240
    v_sub_f32 v71, v71, v240
    v_sub_f32 v72, v72, v240
    v_sub_f32 v73, v73, v240
    v_sub_f32 v74, v74, v240
    v_sub_f32 v75, v75, v240
    v_sub_f32 v76, v76, v240
    v_sub_f32 v77, v77, v240
    v_sub_f32 v78, v78, v240
    v_sub_f32 v79, v79, v240
    v_sub_f32 v224, v224, v240
    v_sub_f32 v225, v225, v240
    v_sub_f32 v226, v226, v240
    v_sub_f32 v227, v227, v240
    v_sub_f32 v228, v228, v240
    v_sub_f32 v229, v229, v240
    v_sub_f32 v230, v230, v240
    v_sub_f32 v231, v231, v240
    v_sub_f32 v232, v232, v240
    v_sub_f32 v233, v233, v240
    v_sub_f32 v234, v234, v240
    v_sub_f32 v235, v235, v240
    v_sub_f32 v236, v236, v240
    v_sub_f32 v237, v237, v240
    v_sub_f32 v238, v238, v240
    v_sub_f32 v239, v239, v240
    v_mul_f32 v6, v6, v242
    v_mul_f32 v128, v128, v242
    v_mul_f32 v129, v129, v242
    v_mul_f32 v130, v130, v242
    v_mul_f32 v131, v131, v242
    v_mul_f32 v132, v132, v242
    v_mul_f32 v133, v133, v242
    v_mul_f32 v134, v134, v242
    v_mul_f32 v135, v135, v242
    v_mul_f32 v136, v136, v242
    v_mul_f32 v137, v137, v242
    v_mul_f32 v138, v138, v242
    v_mul_f32 v139, v139, v242
    v_mul_f32 v140, v140, v242
    v_mul_f32 v141, v141, v242
    v_mul_f32 v142, v142, v242
    v_mul_f32 v143, v143, v242
    v_mul_f32 v144, v144, v242
    v_mul_f32 v145, v145, v242
    v_mul_f32 v146, v146, v242
    v_mul_f32 v147, v147, v242
    v_mul_f32 v148, v148, v242
    v_mul_f32 v149, v149, v242
    v_mul_f32 v150, v150, v242
    v_mul_f32 v151, v151, v242
    v_mul_f32 v152, v152, v242
    v_mul_f32 v153, v153, v242
    v_mul_f32 v154, v154, v242
    v_mul_f32 v155, v155, v242
    v_mul_f32 v156, v156, v242
    v_mul_f32 v157, v157, v242
    v_mul_f32 v158, v158, v242
    v_mul_f32 v159, v159, v242
    v_mul_f32 v160, v160, v242
    v_mul_f32 v161, v161, v242
    v_mul_f32 v162, v162, v242
    v_mul_f32 v163, v163, v242
    v_mul_f32 v164, v164, v242
    v_mul_f32 v165, v165, v242
    v_mul_f32 v166, v166, v242
    v_mul_f32 v167, v167, v242
    v_mul_f32 v168, v168, v242
    v_mul_f32 v169, v169, v242
    v_mul_f32 v170, v170, v242
    v_mul_f32 v171, v171, v242
    v_mul_f32 v172, v172, v242
    v_mul_f32 v173, v173, v242
    v_mul_f32 v174, v174, v242
    v_mul_f32 v175, v175, v242
    v_mul_f32 v176, v176, v242
    v_mul_f32 v177, v177, v242
    v_mul_f32 v178, v178, v242
    v_mul_f32 v179, v179, v242
    v_mul_f32 v180, v180, v242
    v_mul_f32 v181, v181, v242
    v_mul_f32 v182, v182, v242
    v_mul_f32 v183, v183, v242
    v_mul_f32 v184, v184, v242
    v_mul_f32 v185, v185, v242
    v_mul_f32 v186, v186, v242
    v_mul_f32 v187, v187, v242
    v_mul_f32 v188, v188, v242
    v_mul_f32 v189, v189, v242
    v_mul_f32 v190, v190, v242
    v_mul_f32 v191, v191, v242
L_at_rs0:
    ds_read_b128 v[208:211], v2 offset:24576
    ds_read_b128 v[212:215], v2 offset:26624
    s_waitcnt lgkmcnt(5)
    v_mfma_f32_32x32x16_bf16 v[80:95], v[192:195], v[16:19], v[224:239]
    ds_read_b128 v[216:219], v2 offset:28672
    s_add_u32 m0, s59, 0
    s_add_u32 s54, s72, 0
    buffer_load_dwordx4 v4, s[36:39], s54 offen sc1 lds
    v_exp_f32 v48, v48
    v_exp_f32 v49, v49
    s_waitcnt lgkmcnt(5)
    v_mfma_f32_32x32x16_bf16 v[80:95], v[196:199], v[20:23], v[80:95]
    ds_read_b128 v[220:223], v2 offset:30720
    v_add_f32 v6, v6, v48
    v_cvt_pk_bf16_f32 v112, v48, v49
    s_add_u32 m0, s59, 4096
    s_add_u32 s54, s72, 4096
    buffer_load_dwordx4 v4, s[36:39], s54 offen sc1 lds
    s_waitcnt lgkmcnt(5)
    v_mfma_f32_32x32x16_bf16 v[80:95], v[200:203], v[24:27], v[80:95]
    ds_read_b128 v[192:195], v2 offset:16896
    v_add_f32 v6, v6, v49
    v_exp_f32 v50, v50
    v_exp_f32 v51, v51
    v_add_f32 v6, v6, v50
    s_waitcnt lgkmcnt(5)
    v_mfma_f32_32x32x16_bf16 v[80:95], v[204:207], v[28:31], v[80:95]
    ds_read_b128 v[196:199], v2 offset:18944
    s_add_u32 m0, s59, 8192
    s_add_u32 s54, s72, 8192
    buffer_load_dwordx4 v4, s[36:39], s54 offen sc1 lds
    v_cvt_pk_bf16_f32 v113, v50, v51
    v_add_f32 v6, v6, v51
    s_waitcnt lgkmcnt(5)
    v_mfma_f32_32x32x16_bf16 v[80:95], v[208:211], v[32:35], v[80:95]
    ds_read_b128 v[200:203], v2 offset:20992
    v_exp_f32 v52, v52
    v_exp_f32 v53, v53
    s_add_u32 m0, s59, 12288
    s_add_u32 s54, s72, 12288
    buffer_load_dwordx4 v4, s[36:39], s54 offen sc1 lds
    s_waitcnt lgkmcnt(5)
    v_mfma_f32_32x32x16_bf16 v[80:95], v[212:215], v[36:39], v[80:95]
    ds_read_b128 v[204:207], v2 offset:23040
    v_add_f32 v6, v6, v52
    v_cvt_pk_bf16_f32 v114, v52, v53
    v_add_f32 v6, v6, v53
    v_exp_f32 v54, v54
    s_waitcnt lgkmcnt(5)
    v_mfma_f32_32x32x16_bf16 v[80:95], v[216:219], v[40:43], v[80:95]
    ds_read_b128 v[208:211], v2 offset:25088
    s_add_u32 m0, s59, 49152
    s_add_u32 s54, s70, 16384
    buffer_load_dwordx4 v4, s[36:39], s54 offen sc1 lds
    v_exp_f32 v55, v55
    v_add_f32 v6, v6, v54
    s_waitcnt lgkmcnt(5)
    v_mfma_f32_32x32x16_bf16 v[80:95], v[220:223], v[44:47], v[80:95]
    ds_read_b128 v[212:215], v2 offset:27136
    v_cvt_pk_bf16_f32 v115, v54, v55
    v_add_f32 v6, v6, v55
    s_add_u32 m0, s59, 53248
    s_add_u32 s54, s70, 20480
    s_waitcnt lgkmcnt(5)
    v_mfma_f32_32x32x16_bf16 v[96:111], v[192:195], v[16:19], v[224:239]
    ds_read_b128 v[216:219], v2 offset:29184
    buffer_load_dwordx4 v4, s[36:39], s54 offen sc1 lds
    v_exp_f32 v56, v56
    v_exp_f32 v57, v57
    v_add_f32 v6, v6, v56
    v_cvt_pk_bf16_f32 v116, v56, v57
    s_waitcnt lgkmcnt(5)
    v_mfma_f32_32x32x16_bf16 v[96:111], v[196:199], v[20:23], v[96:111]
    ds_read_b128 v[220:223], v2 offset:31232
    s_add_u32 m0, s59, 57344
    s_add_u32 s54, s70, 24576
    buffer_load_dwordx4 v4, s[36:39], s54 offen sc1 lds
    v_add_f32 v6, v6, v57
    v_exp_f32 v58, v58
    s_waitcnt lgkmcnt(5)
    v_mfma_f32_32x32x16_bf16 v[96:111], v[200:203], v[24:27], v[96:111]
    ds_read_b128 v[192:195], v3 offset:0
    v_exp_f32 v59, v59
    v_add_f32 v6, v6, v58
    s_add_u32 m0, s59, 61440
    s_add_u32 s54, s70, 28672
    s_waitcnt lgkmcnt(5)
    v_mfma_f32_32x32x16_bf16 v[96:111], v[204:207], v[28:31], v[96:111]
    ds_read_b128 v[196:199], v3 offset:512
    buffer_load_dwordx4 v4, s[36:39], s54 offen sc1 lds
    v_cvt_pk_bf16_f32 v117, v58, v59
    v_add_f32 v6, v6, v59
    v_exp_f32 v60, v60
    v_exp_f32 v61, v61
    s_waitcnt lgkmcnt(5)
    v_mfma_f32_32x32x16_bf16 v[96:111], v[208:211], v[32:35], v[96:111]
    ds_read_b128 v[200:203], v3 offset:1024
    v_add_f32 v6, v6, v60
    v_cvt_pk_bf16_f32 v118, v60, v61
    v_add_f32 v6, v6, v61
    v_exp_f32 v62, v62
    v_exp_f32 v63, v63
    s_waitcnt lgkmcnt(5)
    v_mfma_f32_32x32x16_bf16 v[96:111], v[212:215], v[36:39], v[96:111]
    ds_read_b128 v[204:207], v3 offset:1536
    v_add_f32 v6, v6, v62
    v_cvt_pk_bf16_f32 v119, v62, v63
    v_add_f32 v6, v6, v63
    v_exp_f32 v64, v64
    s_waitcnt lgkmcnt(5)
    v_mfma_f32_32x32x16_bf16 v[96:111], v[216:219], v[40:43], v[96:111]
    ds_read_b128 v[208:211], v3 offset:4096
    v_exp_f32 v65, v65
    v_add_f32 v6, v6, v64
    v_cvt_pk_bf16_f32 v120, v64, v65
    v_add_f32 v6, v6, v65
    v_exp_f32 v66, v66
    s_waitcnt lgkmcnt(5)
    v_mfma_f32_32x32x16_bf16 v[96:111], v[220:223], v[44:47], v[96:111]
    ds_read_b128 v[212:215], v3 offset:4608
    v_exp_f32 v67, v67
    v_add_f32 v6, v6, v66
    v_cvt_pk_bf16_f32 v121, v66, v67
    v_add_f32 v6, v6, v67
    s_waitcnt lgkmcnt(5)
    v_mfma_f32_32x32x16_bf16 v[128:143], v[192:195], v[112:115], v[128:143]
    ds_read_b128 v[216:219], v3 offset:5120
    v_exp_f32 v68, v68
    v_exp_f32 v69, v69
    v_add_f32 v6, v6, v68
    v_cvt_pk_bf16_f32 v122, v68, v69
    s_waitcnt lgkmcnt(5)
    v_mfma_f32_32x32x16_bf16 v[144:159], v[196:199], v[112:115], v[144:159]
    ds_read_b128 v[220:223], v3 offset:5632
    v_add_f32 v6, v6, v69
    v_exp_f32 v70, v70
    v_exp_f32 v71, v71
    v_add_f32 v6, v6, v70
    s_waitcnt lgkmcnt(5)
    v_mfma_f32_32x32x16_bf16 v[160:175], v[200:203], v[112:115], v[160:175]
    ds_read_b128 v[192:195], v3 offset:8192
    v_cvt_pk_bf16_f32 v123, v70, v71
    v_add_f32 v6, v6, v71
    v_exp_f32 v72, v72
    v_exp_f32 v73, v73
    s_waitcnt lgkmcnt(5)
    v_mfma_f32_32x32x16_bf16 v[176:191], v[204:207], v[112:115], v[176:191]
    ds_read_b128 v[196:199], v3 offset:8704
    v_add_f32 v6, v6, v72
    v_cvt_pk_bf16_f32 v124, v72, v73
    v_add_f32 v6, v6, v73
    s_waitcnt lgkmcnt(5)
    v_mfma_f32_32x32x16_bf16 v[128:143], v[208:211], v[116:119], v[128:143]
    ds_read_b128 v[200:203], v3 offset:9216
    v_exp_f32 v74, v74
    v_exp_f32 v75, v75
    v_add_f32 v6, v6, v74
    v_cvt_pk_bf16_f32 v125, v74, v75
    s_waitcnt lgkmcnt(5)
    v_mfma_f32_32x32x16_bf16 v[144:159], v[212:215], v[116:119], v[144:159]
    ds_read_b128 v[204:207], v3 offset:9728
    v_add_f32 v6, v6, v75
    v_exp_f32 v76, v76
    v_exp_f32 v77, v77
    v_add_f32 v6, v6, v76
    s_waitcnt lgkmcnt(5)
    v_mfma_f32_32x32x16_bf16 v[160:175], v[216:219], v[116:119], v[160:175]
    ds_read_b128 v[208:211], v3 offset:12288
    v_cvt_pk_bf16_f32 v126, v76, v77
    v_add_f32 v6, v6, v77
    v_exp_f32 v78, v78
    v_exp_f32 v79, v79
    s_waitcnt lgkmcnt(5)
    v_mfma_f32_32x32x16_bf16 v[176:191], v[220:223], v[116:119], v[176:191]
    ds_read_b128 v[212:215], v3 offset:12800
    v_add_f32 v6, v6, v78
    v_cvt_pk_bf16_f32 v127, v78, v79
    v_add_f32 v6, v6, v79
    s_cmp_eq_u32 s71, s67
    s_cbranch_scc0 L_at_nomask1
    v_mov_b32 v241, 0xff800000
    v_cmp_le_i32 vcc, 0, v8
    s_nop 1
    v_cndmask_b32 v80, v241, v80, vcc
    v_cmp_le_i32 vcc, 1, v8
    s_nop 1
    v_cndmask_b32 v81, v241, v81, vcc
    v_cmp_le_i32 vcc, 2, v8
    s_nop 1
    v_cndmask_b32 v82, v241, v82, vcc
    v_cmp_le_i32 vcc, 3, v8
    s_nop 1
    v_cndmask_b32 v83, v241, v83, vcc
    v_cmp_le_i32 vcc, 4, v8
    s_nop 1
    v_cndmask_b32 v84, v241, v84, vcc
    v_cmp_le_i32 vcc, 5, v8
    s_nop 1
    v_cndmask_b32 v85, v241, v85, vcc
    v_cmp_le_i32 vcc, 6, v8
    s_nop 1
    v_cndmask_b32 v86, v241, v86, vcc
    v_cmp_le_i32 vcc, 7, v8
    s_nop 1
    v_cndmask_b32 v87, v241, v87, vcc
    v_cmp_le_i32 vcc, 16, v8
    s_nop 1
    v_cndmask_b32 v88, v241, v88, vcc
    v_cmp_le_i32 vcc, 17, v8
    s_nop 1
    v_cndmask_b32 v89, v241, v89, vcc
    v_cmp_le_i32 vcc, 18, v8
    s_nop 1
    v_cndmask_b32 v90, v241, v90, vcc
    v_cmp_le_i32 vcc, 19, v8
    s_nop 1
    v_cndmask_b32 v91, v241, v91, vcc
    v_cmp_le_i32 vcc, 20, v8
    s_nop 1
    v_cndmask_b32 v92, v241, v92, vcc
    v_cmp_le_i32 vcc, 21, v8
    s_nop 1
    v_cndmask_b32 v93, v241, v93, vcc
    v_cmp_le_i32 vcc, 22, v8
    s_nop 1
    v_cndmask_b32 v94, v241, v94, vcc
    v_cmp_le_i32 vcc, 23, v8
    s_nop 1
    v_cndmask_b32 v95, v241, v95, vcc
    v_cmp_le_i32 vcc, 32, v8
    s_nop 1
    v_cndmask_b32 v96, v241, v96, vcc
    v_cmp_le_i32 vcc, 33, v8
    s_nop 1
    v_cndmask_b32 v97, v241, v97, vcc
    v_cmp_le_i32 vcc, 34, v8
    s_nop 1
    v_cndmask_b32 v98, v241, v98, vcc
    v_cmp_le_i32 vcc, 35, v8
    s_nop 1
    v_cndmask_b32 v99, v241, v99, vcc
    v_cmp_le_i32 vcc, 36, v8
    s_nop 1
    v_cndmask_b32 v100, v241, v100, vcc
    v_cmp_le_i32 vcc, 37, v8
    s_nop 1
    v_cndmask_b32 v101, v241, v101, vcc
    v_cmp_le_i32 vcc, 38, v8
    s_nop 1
    v_cndmask_b32 v102, v241, v102, vcc
    v_cmp_le_i32 vcc, 39, v8
    s_nop 1
    v_cndmask_b32 v103, v241, v103, vcc
    v_cmp_le_i32 vcc, 48, v8
    s_nop 1
    v_cndmask_b32 v104, v241, v104, vcc
    v_cmp_le_i32 vcc, 49, v8
    s_nop 1
    v_cndmask_b32 v105, v241, v105, vcc
    v_cmp_le_i32 vcc, 50, v8
    s_nop 1
    v_cndmask_b32 v106, v241, v106, vcc
    v_cmp_le_i32 vcc, 51, v8
    s_nop 1
    v_cndmask_b32 v107, v241, v107, vcc
    v_cmp_le_i32 vcc, 52, v8
    s_nop 1
    v_cndmask_b32 v108, v241, v108, vcc
    v_cmp_le_i32 vcc, 53, v8
    s_nop 1
    v_cndmask_b32 v109, v241, v109, vcc
    v_cmp_le_i32 vcc, 54, v8
    s_nop 1
    v_cndmask_b32 v110, v241, v110, vcc
    v_cmp_le_i32 vcc, 55, v8
    s_nop 1
    v_cndmask_b32 v111, v241, v111, vcc
L_at_nomask1:
    s_waitcnt lgkmcnt(5)
    v_mfma_f32_32x32x16_bf16 v[128:143], v[192:195], v[120:123], v[128:143]
    ds_read_b128 v[216:219], v3 offset:13312
    v_max3_f32 v240, v80, v81, v82
    v_max3_f32 v242, v83, v84, v85
    v_max3_f32 v240, v240, v86, v87
    v_max3_f32 v242, v242, v88, v89
    v_max3_f32 v240, v240, v90, v91
    s_waitcnt lgkmcnt(5)
    v_mfma_f32_32x32x16_bf16 v[144:159], v[196:199], v[120:123], v[144:159]
    ds_read_b128 v[220:223], v3 offset:13824
    v_max3_f32 v242, v242, v92, v93
    v_max3_f32 v240, v240, v94, v95
    v_max3_f32 v242, v242, v96, v97
    v_max3_f32 v240, v240, v98, v99
    v_max3_f32 v242, v242, v100, v101
    s_waitcnt lgkmcnt(5)
    v_mfma_f32_32x32x16_bf16 v[160:175], v[200:203], v[120:123], v[160:175]
    v_max3_f32 v240, v240, v102, v103
    v_max3_f32 v242, v242, v104, v105
    v_max3_f32 v240, v240, v106, v107
    v_max3_f32 v242, v242, v108, v109
    v_max3_f32 v240, v240, v110, v111
    s_waitcnt lgkmcnt(4)
    v_mfma_f32_32x32x16_bf16 v[176:191], v[204:207], v[120:123], v[176:191]
    v_max_f32 v240, v240, v242
    v_mov_b32 v242, v240
    s_nop 1
    v_permlane32_swap_b32 v240, v242
    v_max_f32 v240, v240, v242
    s_waitcnt vmcnt(0) lgkmcnt(0)
    s_barrier
    v_mfma_f32_32x32x16_bf16 v[128:143], v[208:211], v[124:127], v[128:143]
    ds_read_b128 v[192:195], v2 offset:0
    v_mfma_f32_32x32x16_bf16 v[144:159], v[212:215], v[124:127], v[144:159]
    ds_read_b128 v[196:199], v2 offset:2048
    v_mfma_f32_32x32x16_bf16 v[160:175], v[216:219], v[124:127], v[160:175]
    ds_read_b128 v[200:203], v2 offset:4096
    v_mfma_f32_32x32x16_bf16 v[176:191], v[220:223], v[124:127], v[176:191]
    ds_read_b128 v[204:207], v2 offset:6144
    s_add_u32 s69, s69, 1
    s_mov_b32 s70, s72
L_at_loop1:
    s_add_u32 s71, s69, 1
    s_cmp_eq_u32 s71, s67
    s_cbranch_scc1 L_at_last1
    s_add_u32 s72, s70, 65536
    s_add_u32 s71, s69, 2
    s_cmp_ge_u32 s71, s67
    s_cselect_b32 s72, s77, s72
    v_cmp_lt_f32 vcc, v243, v240
    s_nop 4
    s_cbranch_vccz L_at_rs1
    v_max_f32 v240, 0, v240
    v_sub_f32 v242, 0, v240
    v_exp_f32 v242, v242
    v_sub_f32 v80, v80, v240
    v_sub_f32 v81, v81, v240
    v_sub_f32 v82, v82, v240
    v_sub_f32 v83, v83, v240
    v_sub_f32 v84, v84, v240
    v_sub_f32 v85, v85, v240
    v_sub_f32 v86, v86, v240
    v_sub_f32 v87, v87, v240
    v_sub_f32 v88, v88, v240
    v_sub_f32 v89, v89, v240
    v_sub_f32 v90, v90, v240
    v_sub_f32 v91, v91, v240
    v_sub_f32 v92, v92, v240
    v_sub_f32 v93, v93, v240
    v_sub_f32 v94, v94, v240
    v_sub_f32 v95, v95, v240
    v_sub_f32 v96, v96, v240
    v_sub_f32 v97, v97, v240
    v_sub_f32 v98, v98, v240
    v_sub_f32 v99, v99, v240
    v_sub_f32 v100, v100, v240
    v_sub_f32 v101, v101, v240
    v_sub_f32 v102, v102, v240
    v_sub_f32 v103, v103, v240
    v_sub_f32 v104, v104, v240
    v_sub_f32 v105, v105, v240
    v_sub_f32 v106, v106, v240
    v_sub_f32 v107, v107, v240
    v_sub_f32 v108, v108, v240
    v_sub_f32 v109, v109, v240
    v_sub_f32 v110, v110, v240
    v_sub_f32 v111, v111, v240
    v_sub_f32 v224, v224, v240
    v_sub_f32 v225, v225, v240
    v_sub_f32 v226, v226, v240
    v_sub_f32 v227, v227, v240
    v_sub_f32 v228, v228, v240
    v_sub_f32 v229, v229, v240
    v_sub_f32 v230, v230, v240
    v_sub_f32 v231, v231, v240
    v_sub_f32 v232, v232, v240
    v_sub_f32 v233, v233, v240
    v_sub_f32 v234, v234, v240
    v_sub_f32 v235, v235, v240
    v_sub_f32 v236, v236, v240
    v_sub_f32 v237, v237, v240
    v_sub_f32 v238, v238, v240
    v_sub_f32 v239, v239, v240
    v_mul_f32 v6, v6, v242
    v_mul_f32 v128, v128, v242
    v_mul_f32 v129, v129, v242
    v_mul_f32 v130, v130, v242
    v_mul_f32 v131, v131, v242
    v_mul_f32 v132, v132, v242
    v_mul_f32 v133, v133, v242
    v_mul_f32 v134, v134, v242
    v_mul_f32 v135, v135, v242
    v_mul_f32 v136, v136, v242
    v_mul_f32 v137, v137, v242
    v_mul_f32 v138, v138, v242
    v_mul_f32 v139, v139, v242
    v_mul_f32 v140, v140, v242
    v_mul_f32 v141, v141, v242
    v_mul_f32 v142, v142, v242
    v_mul_f32 v143, v143, v242
    v_mul_f32 v144, v144, v242
    v_mul_f32 v145, v145, v242
    v_mul_f32 v146, v146, v242
    v_mul_f32 v147, v147, v242
    v_mul_f32 v148, v148, v242
    v_mul_f32 v149, v149, v242
    v_mul_f32 v150, v150, v242
    v_mul_f32 v151, v151, v242
    v_mul_f32 v152, v152, v242
    v_mul_f32 v153, v153, v242
    v_mul_f32 v154, v154, v242
    v_mul_f32 v155, v155, v242
    v_mul_f32 v156, v156, v242
    v_mul_f32 v157, v157, v242
    v_mul_f32 v158, v158, v242
    v_mul_f32 v159, v159, v242
    v_mul_f32 v160, v160, v242
    v_mul_f32 v161, v161, v242
    v_mul_f32 v162, v162, v242
    v_mul_f32 v163, v163, v242
    v_mul_f32 v164, v164, v242
    v_mul_f32 v165, v165, v242
    v_mul_f32 v166, v166, v242
    v_mul_f32 v167, v167, v242
    v_mul_f32 v168, v168, v242
    v_mul_f32 v169, v169, v242
    v_mul_f32 v170, v170, v242
    v_mul_f32 v171, v171, v242
    v_mul_f32 v172, v172, v242
    v_mul_f32 v173, v173, v242
    v_mul_f32 v174, v174, v242
    v_mul_f32 v175, v175, v242
    v_mul_f32 v176, v176, v242
    v_mul_f32 v177, v177, v242
    v_mul_f32 v178, v178, v242
    v_mul_f32 v179, v179, v242
    v_mul_f32 v180, v180, v242
    v_mul_f32 v181, v181, v242
    v_mul_f32 v182, v182, v242
    v_mul_f32 v183, v183, v242
    v_mul_f32 v184, v184, v242
    v_mul_f32 v185, v185, v242
    v_mul_f32 v186, v186, v242
    v_mul_f32 v187, v187, v242
    v_mul_f32 v188, v188, v242
    v_mul_f32 v189, v189, v242
    v_mul_f32 v190, v190, v242
    v_mul_f32 v191, v191, v242
L_at_rs1:
    ds_read_b128 v[208:211], v2 offset:8192
    ds_read_b128 v[212:215], v2 offset:10240
    s_waitcnt lgkmcnt(5)
    v_mfma_f32_32x32x16_bf16 v[48:63], v[192:195], v[16:19], v[224:239]
    ds_read_b128 v[216:219], v2 offset:12288
    s_add_u32 m0, s59, 16384
    s_add_u32 s54, s72, 0
    buffer_load_dwordx4 v4, s[36:39], s54 offen sc1 lds
    v_exp_f32 v80, v80
    v_exp_f32 v81, v81
    s_waitcnt lgkmcnt(5)
    v_mfma_f32_32x32x16_bf16 v[48:63], v[196:199], v[20:23], v[48:63]
    ds_read_b128 v[220:223], v2 offset:14336
    v_add_f32 v6, v6, v80
    v_cvt_pk_bf16_f32 v112, v80, v81
    s_add_u32 m0, s59, 20480
    s_add_u32 s54, s72, 4096
    buffer_load_dwordx4 v4, s[36:39], s54 offen sc1 lds
    s_waitcnt lgkmcnt(5)
    v_mfma_f32_32x32x16_bf16 v[48:63], v[200:203], v[24:27], v[48:63]
    ds_read_b128 v[192:195], v2 offset:512
    v_add_f32 v6, v6, v81
    v_exp_f32 v82, v82
    v_exp_f32 v83, v83
    v_add_f32 v6, v6, v82
    s_waitcnt lgkmcnt(5)
    v_mfma_f32_32x32x16_bf16 v[48:63], v[204:207], v[28:31], v[48:63]
    ds_read_b128 v[196:199], v2 offset:2560
    s_add_u32 m0, s59, 24576
    s_add_u32 s54, s72, 8192
    buffer_load_dwordx4 v4, s[36:39], s54 offen sc1 lds
    v_cvt_pk_bf16_f32 v113, v82, v83
    v_add_f32 v6, v6, v83
    s_waitcnt lgkmcnt(5)
    v_mfma_f32_32x32x16_bf16 v[48:63], v[208:211], v[32:35], v[48:63]
    ds_read_b128 v[200:203], v2 offset:4608
    v_exp_f32 v84, v84
    v_exp_f32 v85, v85
    s_add_u32 m0, s59, 28672
    s_add_u32 s54, s72, 12288
    buffer_load_dwordx4 v4, s[36:39], s54 offen sc1 lds
    s_waitcnt lgkmcnt(5)
    v_mfma_f32_32x32x16_bf16 v[48:63], v[212:215], v[36:39], v[48:63]
    ds_read_b128 v[204:207], v2 offset:6656
    v_add_f32 v6, v6, v84
    v_cvt_pk_bf16_f32 v114, v84, v85
    v_add_f32 v6, v6, v85
    v_exp_f32 v86, v86
    s_waitcnt lgkmcnt(5)
    v_mfma_f32_32x32x16_bf16 v[48:63], v[216:219], v[40:43], v[48:63]
    ds_read_b128 v[208:211], v2 offset:8704
    s_add_u32 m0, s59, 32768
    s_add_u32 s54, s70, 16384
    buffer_load_dwordx4 v4, s[36:39], s54 offen sc1 lds
    v_exp_f32 v87, v87
    v_add_f32 v6, v6, v86
    s_waitcnt lgkmcnt(5)
    v_mfma_f32_32x32x16_bf16 v[48:63], v[220:223], v[44:47], v[48:63]
    ds_read_b128 v[212:215], v2 offset:10752
    v_cvt_pk_bf16_f32 v115, v86, v87
    v_add_f32 v6, v6, v87
    s_add_u32 m0, s59, 36864
    s_add_u32 s54, s70, 20480
    s_waitcnt lgkmcnt(5)
    v_mfma_f32_32x32x16_bf16 v[64:79], v[192:195], v[16:19], v[224:239]
    ds_read_b128 v[216:219], v2 offset:12800
    buffer_load_dwordx4 v4, s[36:39], s54 offen sc1 lds
    v_exp_f32 v88, v88
    v_exp_f32 v89, v89
    v_add_f32 v6, v6, v88
    v_cvt_pk_bf16_f32 v116, v88, v89
    s_waitcnt lgkmcnt(5)
    v_mfma_f32_32x32x16_bf16 v[64:79], v[196:199], v[20:23], v[64:79]
    ds_read_b128 v[220:223], v2 offset:14848
    s_add_u32 m0, s59, 40960
    s_add_u32 s54, s70, 24576
    buffer_load_dwordx4 v4, s[36:39], s54 offen sc1 lds
    v_add_f32 v6, v6, v89
    v_exp_f32 v90, v90
    s_waitcnt lgkmcnt(5)
    v_mfma_f32_32x32x16_bf16 v[64:79], v[200:203], v[24:27], v[64:79]
    ds_read_b128 v[192:195], v3 offset:16384
    v_exp_f32 v91, v91
    v_add_f32 v6, v6, v90
    s_add_u32 m0, s59, 45056
    s_add_u32 s54, s70, 28672
    s_waitcnt lgkmcnt(5)
    v_mfma_f32_32x32x16_bf16 v[64:79], v[204:207], v[28:31], v[64:79]
    ds_read_b128 v[196:199], v3 offset:16896
    buffer_load_dwordx4 v4, s[36:39], s54 offen sc1 lds
    v_cvt_pk_bf16_f32 v117, v90, v91
    v_add_f32 v6, v6, v91
    v_exp_f32 v92, v92
    v_exp_f32 v93, v93
    s_waitcnt lgkmcnt(5)
    v_mfma_f32_32x32x16_bf16 v[64:79], v[208:211], v[32:35], v[64:79]
    ds_read_b128 v[200:203], v3 offset:17408
    v_add_f32 v6, v6, v92
    v_cvt_pk_bf16_f32 v118, v92, v93
    v_add_f32 v6, v6, v93
    v_exp_f32 v94, v94
    v_exp_f32 v95, v95
    s_waitcnt lgkmcnt(5)
    v_mfma_f32_32x32x16_bf16 v[64:79], v[212:215], v[36:39], v[64:79]
    ds_read_b128 v[204:207], v3 offset:17920
    v_add_f32 v6, v6, v94
    v_cvt_pk_bf16_f32 v119, v94, v95
    v_add_f32 v6, v6, v95
    v_exp_f32 v96, v96
    s_waitcnt lgkmcnt(5)
    v_mfma_f32_32x32x16_bf16 v[64:79], v[216:219], v[40:43], v[64:79]
    ds_read_b128 v[208:211], v3 offset:20480
    v_exp_f32 v97, v97
    v_add_f32 v6, v6, v96
    v_cvt_pk_bf16_f32 v120, v96, v97
    v_add_f32 v6, v6, v97
    v_exp_f32 v98, v98
    s_waitcnt lgkmcnt(5)
    v_mfma_f32_32x32x16_bf16 v[64:79], v[220:223], v[44:47], v[64:79]
    ds_read_b128 v[212:215], v3 offset:20992
    v_exp_f32 v99, v99
    v_add_f32 v6, v6, v98
    v_cvt_pk_bf16_f32 v121, v98, v99
    v_add_f32 v6, v6, v99
    s_waitcnt lgkmcnt(5)
    v_mfma_f32_32x32x16_bf16 v[128:143], v[192:195], v[112:115], v[128:143]
    ds_read_b128 v[216:219], v3 offset:21504
    v_exp_f32 v100, v100
    v_exp_f32 v101, v101
    v_add_f32 v6, v6, v100
    v_cvt_pk_bf16_f32 v122, v100, v101
    s_waitcnt lgkmcnt(5)
    v_mfma_f32_32x32x16_bf16 v[144:159], v[196:199], v[112:115], v[144:159]
    ds_read_b128 v[220:223], v3 offset:22016
    v_add_f32 v6, v6, v101
    v_exp_f32 v102, v102
    v_exp_f32 v103, v103
    v_add_f32 v6, v6, v102
    s_waitcnt lgkmcnt(5)
    v_mfma_f32_32x32x16_bf16 v[160:175], v[200:203], v[112:115], v[160:175]
    ds_read_b128 v[192:195], v3 offset:24576
    v_cvt_pk_bf16_f32 v123, v102, v103
    v_add_f32 v6, v6, v103
    v_exp_f32 v104, v104
    v_exp_f32 v105, v105
    s_waitcnt lgkmcnt(5)
    v_mfma_f32_32x32x16_bf16 v[176:191], v[204:207], v[112:115], v[176:191]
    ds_read_b128 v[196:199], v3 offset:25088
    v_add_f32 v6, v6, v104
    v_cvt_pk_bf16_f32 v124, v104, v105
    v_add_f32 v6, v6, v105
    s_waitcnt lgkmcnt(5)
    v_mfma_f32_32x32x16_bf16 v[128:143], v[208:211], v[116:119], v[128:143]
    ds_read_b128 v[200:203], v3 offset:25600
    v_exp_f32 v106, v106
    v_exp_f32 v107, v107
    v_add_f32 v6, v6, v106
    v_cvt_pk_bf16_f32 v125, v106, v107
    s_waitcnt lgkmcnt(5)
    v_mfma_f32_32x32x16_bf16 v[144:159], v[212:215], v[116:119], v[144:159]
    ds_read_b128 v[204:207], v3 offset:26112
    v_add_f32 v6, v6, v107
    v_exp_f32 v108, v108
    v_exp_f32 v109, v109
    v_add_f32 v6, v6, v108
    s_waitcnt lgkmcnt(5)
    v_mfma_f32_32x32x16_bf16 v[160:175], v[216:219], v[116:119], v[160:175]
    ds_read_b128 v[208:211], v3 offset:28672
    v_cvt_pk_bf16_f32 v126, v108, v109
    v_add_f32 v6, v6, v109
    v_exp_f32 v110, v110
    v_exp_f32 v111, v111
    s_waitcnt lgkmcnt(5)
    v_mfma_f32_32x32x16_bf16 v[176:191], v[220:223], v[116:119], v[176:191]
    ds_read_b128 v[212:215], v3 offset:29184
    v_add_f32 v6, v6, v110
    v_cvt_pk_bf16_f32 v127, v110, v111
    v_add_f32 v6, v6, v111
    s_cmp_eq_u32 s71, s67
    s_cbranch_scc0 L_at_nomask2
    v_mov_b32 v241, 0xff800000
    v_cmp_le_i32 vcc, 0, v8
    s_nop 1
    v_cndmask_b32 v48, v241, v48, vcc
    v_cmp_le_i32 vcc, 1, v8
    s_nop 1
    v_cndmask_b32 v49, v241, v49, vcc
    v_cmp_le_i32 vcc, 2, v8
    s_nop 1
    v_cndmask_b32 v50, v241, v50, vcc
    v_cmp_le_i32 vcc, 3, v8
    s_nop 1
    v_cndmask_b32 v51, v241, v51, vcc
    v_cmp_le_i32 vcc, 4, v8
    s_nop 1
    v_cndmask_b32 v52, v241, v52, vcc
    v_cmp_le_i32 vcc, 5, v8
    s_nop 1
    v_cndmask_b32 v53, v241, v53, vcc
    v_cmp_le_i32 vcc, 6, v8
    s_nop 1
    v_cndmask_b32 v54, v241, v54, vcc
    v_cmp_le_i32 vcc, 7, v8
    s_nop 1
    v_cndmask_b32 v55, v241, v55, vcc
    v_cmp_le_i32 vcc, 16, v8
    s_nop 1
    v_cndmask_b32 v56, v241, v56, vcc
    v_cmp_le_i32 vcc, 17, v8
    s_nop 1
    v_cndmask_b32 v57, v241, v57, vcc
    v_cmp_le_i32 vcc, 18, v8
    s_nop 1
    v_cndmask_b32 v58, v241, v58, vcc
    v_cmp_le_i32 vcc, 19, v8
    s_nop 1
    v_cndmask_b32 v59, v241, v59, vcc
    v_cmp_le_i32 vcc, 20, v8
    s_nop 1
    v_cndmask_b32 v60, v241, v60, vcc
    v_cmp_le_i32 vcc, 21, v8
    s_nop 1
    v_cndmask_b32 v61, v241, v61, vcc
    v_cmp_le_i32 vcc, 22, v8
    s_nop 1
    v_cndmask_b32 v62, v241, v62, vcc
    v_cmp_le_i32 vcc, 23, v8
    s_nop 1
    v_cndmask_b32 v63, v241, v63, vcc
    v_cmp_le_i32 vcc, 32, v8
    s_nop 1
    v_cndmask_b32 v64, v241, v64, vcc
    v_cmp_le_i32 vcc, 33, v8
    s_nop 1
    v_cndmask_b32 v65, v241, v65, vcc
    v_cmp_le_i32 vcc, 34, v8
    s_nop 1
    v_cndmask_b32 v66, v241, v66, vcc
    v_cmp_le_i32 vcc, 35, v8
    s_nop 1
    v_cndmask_b32 v67, v241, v67, vcc
    v_cmp_le_i32 vcc, 36, v8
    s_nop 1
    v_cndmask_b32 v68, v241, v68, vcc
    v_cmp_le_i32 vcc, 37, v8
    s_nop 1
    v_cndmask_b32 v69, v241, v69, vcc
    v_cmp_le_i32 vcc, 38, v8
    s_nop 1
    v_cndmask_b32 v70, v241, v70, vcc
    v_cmp_le_i32 vcc, 39, v8
    s_nop 1
    v_cndmask_b32 v71, v241, v71, vcc
    v_cmp_le_i32 vcc, 48, v8
    s_nop 1
    v_cndmask_b32 v72, v241, v72, vcc
    v_cmp_le_i32 vcc, 49, v8
    s_nop 1
    v_cndmask_b32 v73, v241, v73, vcc
    v_cmp_le_i32 vcc, 50, v8
    s_nop 1
    v_cndmask_b32 v74, v241, v74, vcc
    v_cmp_le_i32 vcc, 51, v8
    s_nop 1
    v_cndmask_b32 v75, v241, v75, vcc
    v_cmp_le_i32 vcc, 52, v8
    s_nop 1
    v_cndmask_b32 v76, v241, v76, vcc
    v_cmp_le_i32 vcc, 53, v8
    s_nop 1
    v_cndmask_b32 v77, v241, v77, vcc
    v_cmp_le_i32 vcc, 54, v8
    s_nop 1
    v_cndmask_b32 v78, v241, v78, vcc
    v_cmp_le_i32 vcc, 55, v8
    s_nop 1
    v_cndmask_b32 v79, v241, v79, vcc
L_at_nomask2:
    s_waitcnt lgkmcnt(5)
    v_mfma_f32_32x32x16_bf16 v[128:143], v[192:195], v[120:123], v[128:143]
    ds_read_b128 v[216:219], v3 offset:29696
    v_max3_f32 v240, v48, v49, v50
    v_max3_f32 v242, v51, v52, v53
    v_max3_f32 v240, v240, v54, v55
    v_max3_f32 v242, v242, v56, v57
    v_max3_f32 v240, v240, v58, v59
    s_waitcnt lgkmcnt(5)
    v_mfma_f32_32x32x16_bf16 v[144:159], v[196:199], v[120:123], v[144:159]
    ds_read_b128 v[220:223], v3 offset:30208
    v_max3_f32 v242, v242, v60, v61
    v_max3_f32 v240, v240, v62, v63
    v_max3_f32 v242, v242, v64, v65
    v_max3_f32 v240, v240, v66, v67
    v_max3_f32 v242, v242, v68, v69
    s_waitcnt lgkmcnt(5)
    v_mfma_f32_32x32x16_bf16 v[160:175], v[200:203], v[120:123], v[160:175]
    v_max3_f32 v240, v240, v70, v71
    v_max3_f32 v242, v242, v72, v73
    v_max3_f32 v240, v240, v74, v75
    v_max3_f32 v242, v242, v76, v77
    v_max3_f32 v240, v240, v78, v79
    s_waitcnt lgkmcnt(4)
    v_mfma_f32_32x32x16_bf16 v[176:191], v[204:207], v[120:123], v[176:191]
    v_max_f32 v240, v240, v242
    v_mov_b32 v242, v240
    s_nop 1
    v_permlane32_swap_b32 v240, v242
    v_max_f32 v240, v240, v242
    s_waitcnt vmcnt(0) lgkmcnt(0)
    s_barrier
    v_mfma_f32_32x32x16_bf16 v[128:143], v[208:211], v[124:127], v[128:143]
    ds_read_b128 v[192:195], v2 offset:16384
    v_mfma_f32_32x32x16_bf16 v[144:159], v[212:215], v[124:127], v[144:159]
    ds_read_b128 v[196:199], v2 offset:18432
    v_mfma_f32_32x32x16_bf16 v[160:175], v[216:219], v[124:127], v[160:175]
    ds_read_b128 v[200:203], v2 offset:20480
    v_mfma_f32_32x32x16_bf16 v[176:191], v[220:223], v[124:127], v[176:191]
    ds_read_b128 v[204:207], v2 offset:22528
    s_add_u32 s69, s69, 1
    s_mov_b32 s70, s72
    s_branch L_at_loop0
L_at_last0:
    s_cmp_eq_u32 s63, 0
    s_cbranch_scc1 L_at_trans0
    v_cmp_lt_f32 vcc, v243, v240
    s_nop 4
    s_cbranch_vccz L_at_rsl0
    v_max_f32 v240, 0, v240
    v_sub_f32 v242, 0, v240
    v_exp_f32 v242, v242
    v_sub_f32 v48, v48, v240
    v_sub_f32 v49, v49, v240
    v_sub_f32 v50, v50, v240
    v_sub_f32 v51, v51, v240
    v_sub_f32 v52, v52, v240
    v_sub_f32 v53, v53, v240
    v_sub_f32 v54, v54, v240
    v_sub_f32 v55, v55, v240
    v_sub_f32 v56, v56, v240
    v_sub_f32 v57, v57, v240
    v_sub_f32 v58, v58, v240
    v_sub_f32 v59, v59, v240
    v_sub_f32 v60, v60, v240
    v_sub_f32 v61, v61, v240
    v_sub_f32 v62, v62, v240
    v_sub_f32 v63, v63, v240
    v_sub_f32 v64, v64, v240
    v_sub_f32 v65, v65, v240
    v_sub_f32 v66, v66, v240
    v_sub_f32 v67, v67, v240
    v_sub_f32 v68, v68, v240
    v_sub_f32 v69, v69, v240
    v_sub_f32 v70, v70, v240
    v_sub_f32 v71, v71, v240
    v_sub_f32 v72, v72, v240
    v_sub_f32 v73, v73, v240
    v_sub_f32 v74, v74, v240
    v_sub_f32 v75, v75, v240
    v_sub_f32 v76, v76, v240
    v_sub_f32 v77, v77, v240
    v_sub_f32 v78, v78, v240
    v_sub_f32 v79, v79, v240
    v_sub_f32 v224, v224, v240
    v_sub_f32 v225, v225, v240
    v_sub_f32 v226, v226, v240
    v_sub_f32 v227, v227, v240
    v_sub_f32 v228, v228, v240
    v_sub_f32 v229, v229, v240
    v_sub_f32 v230, v230, v240
    v_sub_f32 v231, v231, v240
    v_sub_f32 v232, v232, v240
    v_sub_f32 v233, v233, v240
    v_sub_f32 v234, v234, v240
    v_sub_f32 v235, v235, v240
    v_sub_f32 v236, v236, v240
    v_sub_f32 v237, v237, v240
    v_sub_f32 v238, v238, v240
    v_sub_f32 v239, v239, v240
    v_mul_f32 v6, v6, v242
    v_mul_f32 v128, v128, v242
    v_mul_f32 v129, v129, v242
    v_mul_f32 v130, v130, v242
    v_mul_f32 v131, v131, v242
    v_mul_f32 v132, v132, v242
    v_mul_f32 v133, v133, v242
    v_mul_f32 v134, v134, v242
    v_mul_f32 v135, v135, v242
    v_mul_f32 v136, v136, v242
    v_mul_f32 v137, v137, v242
    v_mul_f32 v138, v138, v242
    v_mul_f32 v139, v139, v242
    v_mul_f32 v140, v140, v242
    v_mul_f32 v141, v141, v242
    v_mul_f32 v142, v142, v242
    v_mul_f32 v143, v143, v242
    v_mul_f32 v144, v144, v242
    v_mul_f32 v145, v145, v242
    v_mul_f32 v146, v146, v242
    v_mul_f32 v147, v147, v242
    v_mul_f32 v148, v148, v242
    v_mul_f32 v149, v149, v242
    v_mul_f32 v150, v150, v242
    v_mul_f32 v151, v151, v242
    v_mul_f32 v152, v152, v242
    v_mul_f32 v153, v153, v242
    v_mul_f32 v154, v154, v242
    v_mul_f32 v155, v155, v242
    v_mul_f32 v156, v156, v242
    v_mul_f32 v157, v157, v242
    v_mul_f32 v158, v158, v242
    v_mul_f32 v159, v159, v242
    v_mul_f32 v160, v160, v242
    v_mul_f32 v161, v161, v242
    v_mul_f32 v162, v162, v242
    v_mul_f32 v163, v163, v242
    v_mul_f32 v164, v164, v242
    v_mul_f32 v165, v165, v242
    v_mul_f32 v166, v166, v242
    v_mul_f32 v167, v167, v242
    v_mul_f32 v168, v168, v242
    v_mul_f32 v169, v169, v242
    v_mul_f32 v170, v170, v242
    v_mul_f32 v171, v171, v242
    v_mul_f32 v172, v172, v242
    v_mul_f32 v173, v173, v242
    v_mul_f32 v174, v174, v242
    v_mul_f32 v175, v175, v242
    v_mul_f32 v176, v176, v242
    v_mul_f32 v177, v177, v242
    v_mul_f32 v178, v178, v242
    v_mul_f32 v179, v179, v242
    v_mul_f32 v180, v180, v242
    v_mul_f32 v181, v181, v242
    v_mul_f32 v182, v182, v242
    v_mul_f32 v183, v183, v242
    v_mul_f32 v184, v184, v242
    v_mul_f32 v185, v185, v242
    v_mul_f32 v186, v186, v242
    v_mul_f32 v187, v187, v242
    v_mul_f32 v188, v188, v242
    v_mul_f32 v189, v189, v242
    v_mul_f32 v190, v190, v242
    v_mul_f32 v191, v191, v242
L_at_rsl0:
    ds_read_b128 v[208:211], v3 offset:0
    ds_read_b128 v[212:215], v3 offset:512
    ds_read_b128 v[216:219], v3 offset:1024
    ds_read_b128 v[220:223], v3 offset:1536
    ds_read_b128 v[192:195], v3 offset:4096
    ds_read_b128 v[196:199], v3 offset:4608
    v_exp_f32 v48, v48
    v_exp_f32 v49, v49
    v_add_f32 v6, v6, v48
    v_cvt_pk_bf16_f32 v112, v48, v49
    v_add_f32 v6, v6, v49
    v_exp_f32 v50, v50
    v_exp_f32 v51, v51
    v_add_f32 v6, v6, v50
    v_cvt_pk_bf16_f32 v113, v50, v51
    v_add_f32 v6, v6, v51
    v_exp_f32 v52, v52
    v_exp_f32 v53, v53
    v_add_f32 v6, v6, v52
    v_cvt_pk_bf16_f32 v114, v52, v53
    v_add_f32 v6, v6, v53
    v_exp_f32 v54, v54
    v_exp_f32 v55, v55
    v_add_f32 v6, v6, v54
    v_cvt_pk_bf16_f32 v115, v54, v55
    v_add_f32 v6, v6, v55
    s_waitcnt lgkmcnt(5)
    v_mfma_f32_32x32x16_bf16 v[128:143], v[208:211], v[112:115], v[128:143]
    ds_read_b128 v[200:203], v3 offset:5120
    v_exp_f32 v56, v56
    v_exp_f32 v57, v57
    v_add_f32 v6, v6, v56
    v_cvt_pk_bf16_f32 v116, v56, v57
    v_add_f32 v6, v6, v57
    s_waitcnt lgkmcnt(5)
    v_mfma_f32_32x32x16_bf16 v[144:159], v[212:215], v[112:115], v[144:159]
    ds_read_b128 v[204:207], v3 offset:5632
    v_exp_f32 v58, v58
    v_exp_f32 v59, v59
    v_add_f32 v6, v6, v58
    v_cvt_pk_bf16_f32 v117, v58, v59
    v_add_f32 v6, v6, v59
    s_waitcnt lgkmcnt(5)
    v_mfma_f32_32x32x16_bf16 v[160:175], v[216:219], v[112:115], v[160:175]
    ds_read_b128 v[208:211], v3 offset:8192
    v_exp_f32 v60, v60
    v_exp_f32 v61, v61
    v_add_f32 v6, v6, v60
    v_cvt_pk_bf16_f32 v118, v60, v61
    v_add_f32 v6, v6, v61
    s_waitcnt lgkmcnt(5)
    v_mfma_f32_32x32x16_bf16 v[176:191], v[220:223], v[112:115], v[176:191]
    ds_read_b128 v[212:215], v3 offset:8704
    v_exp_f32 v62, v62
    v_exp_f32 v63, v63
    v_add_f32 v6, v6, v62
    v_cvt_pk_bf16_f32 v119, v62, v63
    v_add_f32 v6, v6, v63
    s_waitcnt lgkmcnt(5)
    v_mfma_f32_32x32x16_bf16 v[128:143], v[192:195], v[116:119], v[128:143]
    ds_read_b128 v[216:219], v3 offset:9216
    v_exp_f32 v64, v64
    v_exp_f32 v65, v65
    v_add_f32 v6, v6, v64
    v_cvt_pk_bf16_f32 v120, v64, v65
    v_add_f32 v6, v6, v65
    s_waitcnt lgkmcnt(5)
    v_mfma_f32_32x32x16_bf16 v[144:159], v[196:199], v[116:119], v[144:159]
    ds_read_b128 v[220:223], v3 offset:9728
    v_exp_f32 v66, v66
    v_exp_f32 v67, v67
    v_add_f32 v6, v6, v66
    v_cvt_pk_bf16_f32 v121, v66, v67
    v_add_f32 v6, v6, v67
    s_waitcnt lgkmcnt(5)
    v_mfma_f32_32x32x16_bf16 v[160:175], v[200:203], v[116:119], v[160:175]
    ds_read_b128 v[192:195], v3 offset:12288
    v_exp_f32 v68, v68
    v_exp_f32 v69, v69
    v_add_f32 v6, v6, v68
    v_cvt_pk_bf16_f32 v122, v68, v69
    v_add_f32 v6, v6, v69
    s_waitcnt lgkmcnt(5)
    v_mfma_f32_32x32x16_bf16 v[176:191], v[204:207], v[116:119], v[176:191]
    ds_read_b128 v[196:199], v3 offset:12800
    v_exp_f32 v70, v70
    v_exp_f32 v71, v71
    v_add_f32 v6, v6, v70
    v_cvt_pk_bf16_f32 v123, v70, v71
    v_add_f32 v6, v6, v71
    s_waitcnt lgkmcnt(5)
    v_mfma_f32_32x32x16_bf16 v[128:143], v[208:211], v[120:123], v[128:143]
    ds_read_b128 v[200:203], v3 offset:13312
    v_exp_f32 v72, v72
    v_exp_f32 v73, v73
    v_add_f32 v6, v6, v72
    v_cvt_pk_bf16_f32 v124, v72, v73
    v_add_f32 v6, v6, v73
    s_waitcnt lgkmcnt(5)
    v_mfma_f32_32x32x16_bf16 v[144:159], v[212:215], v[120:123], v[144:159]
    ds_read_b128 v[204:207], v3 offset:13824
    v_exp_f32 v74, v74
    v_exp_f32 v75, v75
    v_add_f32 v6, v6, v74
    v_cvt_pk_bf16_f32 v125, v74, v75
    v_add_f32 v6, v6, v75
    s_waitcnt lgkmcnt(5)
    v_mfma_f32_32x32x16_bf16 v[160:175], v[216:219], v[120:123], v[160:175]
    v_exp_f32 v76, v76
    v_exp_f32 v77, v77
    v_add_f32 v6, v6, v76
    v_cvt_pk_bf16_f32 v126, v76, v77
    v_add_f32 v6, v6, v77
    s_waitcnt lgkmcnt(4)
    v_mfma_f32_32x32x16_bf16 v[176:191], v[220:223], v[120:123], v[176:191]
    v_exp_f32 v78, v78
    v_exp_f32 v79, v79
    v_add_f32 v6, v6, v78
    v_cvt_pk_bf16_f32 v127, v78, v79
    v_add_f32 v6, v6, v79
    s_waitcnt lgkmcnt(3)
    v_mfma_f32_32x32x16_bf16 v[128:143], v[192:195], v[124:127], v[128:143]
    s_waitcnt lgkmcnt(2)
    v_mfma_f32_32x32x16_bf16 v[144:159], v[196:199], v[124:127], v[144:159]
    s_waitcnt lgkmcnt(1)
    v_mfma_f32_32x32x16_bf16 v[160:175], v[200:203], v[124:127], v[160:175]
    s_waitcnt lgkmcnt(0)
    v_mfma_f32_32x32x16_bf16 v[176:191], v[204:207], v[124:127], v[176:191]
    s_branch L_at_comb
L_at_last1:
    s_cmp_eq_u32 s63, 0
    s_cbranch_scc1 L_at_trans1
    v_cmp_lt_f32 vcc, v243, v240
    s_nop 4
    s_cbranch_vccz L_at_rsl1
    v_max_f32 v240, 0, v240
    v_sub_f32 v242, 0, v240
    v_exp_f32 v242, v242
    v_sub_f32 v80, v80, v240
    v_sub_f32 v81, v81, v240
    v_sub_f32 v82, v82, v240
    v_sub_f32 v83, v83, v240
    v_sub_f32 v84, v84, v240
    v_sub_f32 v85, v85, v240
    v_sub_f32 v86, v86, v240
    v_sub_f32 v87, v87, v240
    v_sub_f32 v88, v88, v240
    v_sub_f32 v89, v89, v240
    v_sub_f32 v90, v90, v240
    v_sub_f32 v91, v91, v240
    v_sub_f32 v92, v92, v240
    v_sub_f32 v93, v93, v240
    v_sub_f32 v94, v94, v240
    v_sub_f32 v95, v95, v240
    v_sub_f32 v96, v96, v240
    v_sub_f32 v97, v97, v240
    v_sub_f32 v98, v98, v240
    v_sub_f32 v99, v99, v240
    v_sub_f32 v100, v100, v240
    v_sub_f32 v101, v101, v240
    v_sub_f32 v102, v102, v240
    v_sub_f32 v103, v103, v240
    v_sub_f32 v104, v104, v240
    v_sub_f32 v105, v105, v240
    v_sub_f32 v106, v106, v240
    v_sub_f32 v107, v107, v240
    v_sub_f32 v108, v108, v240
    v_sub_f32 v109, v109, v240
    v_sub_f32 v110, v110, v240
    v_sub_f32 v111, v111, v240
    v_sub_f32 v224, v224, v240
    v_sub_f32 v225, v225, v240
    v_sub_f32 v226, v226, v240
    v_sub_f32 v227, v227, v240
    v_sub_f32 v228, v228, v240
    v_sub_f32 v229, v229, v240
    v_sub_f32 v230, v230, v240
    v_sub_f32 v231, v231, v240
    v_sub_f32 v232, v232, v240
    v_sub_f32 v233, v233, v240
    v_sub_f32 v234, v234, v240
    v_sub_f32 v235, v235, v240
    v_sub_f32 v236, v236, v240
    v_sub_f32 v237, v237, v240
    v_sub_f32 v238, v238, v240
    v_sub_f32 v239, v239, v240
    v_mul_f32 v6, v6, v242
    v_mul_f32 v128, v128, v242
    v_mul_f32 v129, v129, v242
    v_mul_f32 v130, v130, v242
    v_mul_f32 v131, v131, v242
    v_mul_f32 v132, v132, v242
    v_mul_f32 v133, v133, v242
    v_mul_f32 v134, v134, v242
    v_mul_f32 v135, v135, v242
    v_mul_f32 v136, v136, v242
    v_mul_f32 v137, v137, v242
    v_mul_f32 v138, v138, v242
    v_mul_f32 v139, v139, v242
    v_mul_f32 v140, v140, v242
    v_mul_f32 v141, v141, v242
    v_mul_f32 v142, v142, v242
    v_mul_f32 v143, v143, v242
    v_mul_f32 v144, v144, v242
    v_mul_f32 v145, v145, v242
    v_mul_f32 v146, v146, v242
    v_mul_f32 v147, v147, v242
    v_mul_f32 v148, v148, v242
    v_mul_f32 v149, v149, v242
    v_mul_f32 v150, v150, v242
    v_mul_f32 v151, v151, v242
    v_mul_f32 v152, v152, v242
    v_mul_f32 v153, v153, v242
    v_mul_f32 v154, v154, v242
    v_mul_f32 v155, v155, v242
    v_mul_f32 v156, v156, v242
    v_mul_f32 v157, v157, v242
    v_mul_f32 v158, v158, v242
    v_mul_f32 v159, v159, v242
    v_mul_f32 v160, v160, v242
    v_mul_f32 v161, v161, v242
    v_mul_f32 v162, v162, v242
    v_mul_f32 v163, v163, v242
    v_mul_f32 v164, v164, v242
    v_mul_f32 v165, v165, v242
    v_mul_f32 v166, v166, v242
    v_mul_f32 v167, v167, v242
    v_mul_f32 v168, v168, v242
    v_mul_f32 v169, v169, v242
    v_mul_f32 v170, v170, v242
    v_mul_f32 v171, v171, v242
    v_mul_f32 v172, v172, v242
    v_mul_f32 v173, v173, v242
    v_mul_f32 v174, v174, v242
    v_mul_f32 v175, v175, v242
    v_mul_f32 v176, v176, v242
    v_mul_f32 v177, v177, v242
    v_mul_f32 v178, v178, v242
    v_mul_f32 v179, v179, v242
    v_mul_f32 v180, v180, v242
    v_mul_f32 v181, v181, v242
    v_mul_f32 v182, v182, v242
    v_mul_f32 v183, v183, v242
    v_mul_f32 v184, v184, v242
    v_mul_f32 v185, v185, v242
    v_mul_f32 v186, v186, v242
    v_mul_f32 v187, v187, v242
    v_mul_f32 v188, v188, v242
    v_mul_f32 v189, v189, v242
    v_mul_f32 v190, v190, v242
    v_mul_f32 v191, v191, v242
L_at_rsl1:
    ds_read_b128 v[208:211], v3 offset:16384
    ds_read_b128 v[212:215], v3 offset:16896
    ds_read_b128 v[216:219], v3 offset:17408
    ds_read_b128 v[220:223], v3 offset:17920
    ds_read_b128 v[192:195], v3 offset:20480
    ds_read_b128 v[196:199], v3 offset:20992
    v_exp_f32 v80, v80
    v_exp_f32 v81, v81
    v_add_f32 v6, v6, v80
    v_cvt_pk_bf16_f32 v112, v80, v81
    v_add_f32 v6, v6, v81
    v_exp_f32 v82, v82
    v_exp_f32 v83, v83
    v_add_f32 v6, v6, v82
    v_cvt_pk_bf16_f32 v113, v82, v83
    v_add_f32 v6, v6, v83
    v_exp_f32 v84, v84
    v_exp_f32 v85, v85
    v_add_f32 v6, v6, v84
    v_cvt_pk_bf16_f32 v114, v84, v85
    v_add_f32 v6, v6, v85
    v_exp_f32 v86, v86
    v_exp_f32 v87, v87
    v_add_f32 v6, v6, v86
    v_cvt_pk_bf16_f32 v115, v86, v87
    v_add_f32 v6, v6, v87
    s_waitcnt lgkmcnt(5)
    v_mfma_f32_32x32x16_bf16 v[128:143], v[208:211], v[112:115], v[128:143]
    ds_read_b128 v[200:203], v3 offset:21504
    v_exp_f32 v88, v88
    v_exp_f32 v89, v89
    v_add_f32 v6, v6, v88
    v_cvt_pk_bf16_f32 v116, v88, v89
    v_add_f32 v6, v6, v89
    s_waitcnt lgkmcnt(5)
    v_mfma_f32_32x32x16_bf16 v[144:159], v[212:215], v[112:115], v[144:159]
    ds_read_b128 v[204:207], v3 offset:22016
    v_exp_f32 v90, v90
    v_exp_f32 v91, v91
    v_add_f32 v6, v6, v90
    v_cvt_pk_bf16_f32 v117, v90, v91
    v_add_f32 v6, v6, v91
    s_waitcnt lgkmcnt(5)
    v_mfma_f32_32x32x16_bf16 v[160:175], v[216:219], v[112:115], v[160:175]
    ds_read_b128 v[208:211], v3 offset:24576
    v_exp_f32 v92, v92
    v_exp_f32 v93, v93
    v_add_f32 v6, v6, v92
    v_cvt_pk_bf16_f32 v118, v92, v93
    v_add_f32 v6, v6, v93
    s_waitcnt lgkmcnt(5)
    v_mfma_f32_32x32x16_bf16 v[176:191], v[220:223], v[112:115], v[176:191]
    ds_read_b128 v[212:215], v3 offset:25088
    v_exp_f32 v94, v94
    v_exp_f32 v95, v95
    v_add_f32 v6, v6, v94
    v_cvt_pk_bf16_f32 v119, v94, v95
    v_add_f32 v6, v6, v95
    s_waitcnt lgkmcnt(5)
    v_mfma_f32_32x32x16_bf16 v[128:143], v[192:195], v[116:119], v[128:143]
    ds_read_b128 v[216:219], v3 offset:25600
    v_exp_f32 v96, v96
    v_exp_f32 v97, v97
    v_add_f32 v6, v6, v96
    v_cvt_pk_bf16_f32 v120, v96, v97
    v_add_f32 v6, v6, v97
    s_waitcnt lgkmcnt(5)
    v_mfma_f32_32x32x16_bf16 v[144:159], v[196:199], v[116:119], v[144:159]
    ds_read_b128 v[220:223], v3 offset:26112
    v_exp_f32 v98, v98
    v_exp_f32 v99, v99
    v_add_f32 v6, v6, v98
    v_cvt_pk_bf16_f32 v121, v98, v99
    v_add_f32 v6, v6, v99
    s_waitcnt lgkmcnt(5)
    v_mfma_f32_32x32x16_bf16 v[160:175], v[200:203], v[116:119], v[160:175]
    ds_read_b128 v[192:195], v3 offset:28672
    v_exp_f32 v100, v100
    v_exp_f32 v101, v101
    v_add_f32 v6, v6, v100
    v_cvt_pk_bf16_f32 v122, v100, v101
    v_add_f32 v6, v6, v101
    s_waitcnt lgkmcnt(5)
    v_mfma_f32_32x32x16_bf16 v[176:191], v[204:207], v[116:119], v[176:191]
    ds_read_b128 v[196:199], v3 offset:29184
    v_exp_f32 v102, v102
    v_exp_f32 v103, v103
    v_add_f32 v6, v6, v102
    v_cvt_pk_bf16_f32 v123, v102, v103
    v_add_f32 v6, v6, v103
    s_waitcnt lgkmcnt(5)
    v_mfma_f32_32x32x16_bf16 v[128:143], v[208:211], v[120:123], v[128:143]
    ds_read_b128 v[200:203], v3 offset:29696
    v_exp_f32 v104, v104
    v_exp_f32 v105, v105
    v_add_f32 v6, v6, v104
    v_cvt_pk_bf16_f32 v124, v104, v105
    v_add_f32 v6, v6, v105
    s_waitcnt lgkmcnt(5)
    v_mfma_f32_32x32x16_bf16 v[144:159], v[212:215], v[120:123], v[144:159]
    ds_read_b128 v[204:207], v3 offset:30208
    v_exp_f32 v106, v106
    v_exp_f32 v107, v107
    v_add_f32 v6, v6, v106
    v_cvt_pk_bf16_f32 v125, v106, v107
    v_add_f32 v6, v6, v107
    s_waitcnt lgkmcnt(5)
    v_mfma_f32_32x32x16_bf16 v[160:175], v[216:219], v[120:123], v[160:175]
    v_exp_f32 v108, v108
    v_exp_f32 v109, v109
    v_add_f32 v6, v6, v108
    v_cvt_pk_bf16_f32 v126, v108, v109
    v_add_f32 v6, v6, v109
    s_waitcnt lgkmcnt(4)
    v_mfma_f32_32x32x16_bf16 v[176:191], v[220:223], v[120:123], v[176:191]
    v_exp_f32 v110, v110
    v_exp_f32 v111, v111
    v_add_f32 v6, v6, v110
    v_cvt_pk_bf16_f32 v127, v110, v111
    v_add_f32 v6, v6, v111
    s_waitcnt lgkmcnt(3)
    v_mfma_f32_32x32x16_bf16 v[128:143], v[192:195], v[124:127], v[128:143]
    s_waitcnt lgkmcnt(2)
    v_mfma_f32_32x32x16_bf16 v[144:159], v[196:199], v[124:127], v[144:159]
    s_waitcnt lgkmcnt(1)
    v_mfma_f32_32x32x16_bf16 v[160:175], v[200:203], v[124:127], v[160:175]
    s_waitcnt lgkmcnt(0)
    v_mfma_f32_32x32x16_bf16 v[176:191], v[204:207], v[124:127], v[176:191]
L_at_comb:
    s_branch L_at_comb2
L_at_trans0:
    v_add_u32 v12, 131072, v9
    ds_read_b128 v[16:19], v12 offset:0
    ds_read_b128 v[20:23], v12 offset:4096
    ds_read_b128 v[24:27], v12 offset:8192
    ds_read_b128 v[28:31], v12 offset:12288
    ds_read_b128 v[32:35], v12 offset:16384
    ds_read_b128 v[36:39], v12 offset:20480
    ds_read_b128 v[40:43], v12 offset:24576
    ds_read_b128 v[44:47], v12 offset:28672
    s_add_u32 s72, s65, 65536
    v_cmp_lt_f32 vcc, v243, v240
    s_nop 4
    s_cbranch_vccz L_at_rst0
    v_max_f32 v240, 0, v240
    v_sub_f32 v242, 0, v240
    v_exp_f32 v242, v242
    v_sub_f32 v48, v48, v240
    v_sub_f32 v49, v49, v240
    v_sub_f32 v50, v50, v240
    v_sub_f32 v51, v51, v240
    v_sub_f32 v52, v52, v240
    v_sub_f32 v53, v53, v240
    v_sub_f32 v54, v54, v240
    v_sub_f32 v55, v55, v240
    v_sub_f32 v56, v56, v240
    v_sub_f32 v57, v57, v240
    v_sub_f32 v58, v58, v240
    v_sub_f32 v59, v59, v240
    v_sub_f32 v60, v60, v240
    v_sub_f32 v61, v61, v240
    v_sub_f32 v62, v62, v240
    v_sub_f32 v63, v63, v240
    v_sub_f32 v64, v64, v240
    v_sub_f32 v65, v65, v240
    v_sub_f32 v66, v66, v240
    v_sub_f32 v67, v67, v240
    v_sub_f32 v68, v68, v240
    v_sub_f32 v69, v69, v240
    v_sub_f32 v70, v70, v240
    v_sub_f32 v71, v71, v240
    v_sub_f32 v72, v72, v240
    v_sub_f32 v73, v73, v240
    v_sub_f32 v74, v74, v240
    v_sub_f32 v75, v75, v240
    v_sub_f32 v76, v76, v240
    v_sub_f32 v77, v77, v240
    v_sub_f32 v78, v78, v240
    v_sub_f32 v79, v79, v240
    v_sub_f32 v224, v224, v240
    v_sub_f32 v225, v225, v240
    v_sub_f32 v226, v226, v240
    v_sub_f32 v227, v227, v240
    v_sub_f32 v228, v228, v240
    v_sub_f32 v229, v229, v240
    v_sub_f32 v230, v230, v240
    v_sub_f32 v231, v231, v240
    v_sub_f32 v232, v232, v240
    v_sub_f32 v233, v233, v240
    v_sub_f32 v234, v234, v240
    v_sub_f32 v235, v235, v240
    v_sub_f32 v236, v236, v240
    v_sub_f32 v237, v237, v240
    v_sub_f32 v238, v238, v240
    v_sub_f32 v239, v239, v240
    v_mul_f32 v6, v6, v242
    v_mul_f32 v128, v128, v242
    v_mul_f32 v129, v129, v242
    v_mul_f32 v130, v130, v242
    v_mul_f32 v131, v131, v242
    v_mul_f32 v132, v132, v242
    v_mul_f32 v133, v133, v242
    v_mul_f32 v134, v134, v242
    v_mul_f32 v135, v135, v242
    v_mul_f32 v136, v136, v242
    v_mul_f32 v137, v137, v242
    v_mul_f32 v138, v138, v242
    v_mul_f32 v139, v139, v242
    v_mul_f32 v140, v140, v242
    v_mul_f32 v141, v141, v242
    v_mul_f32 v142, v142, v242
    v_mul_f32 v143, v143, v242
    v_mul_f32 v144, v144, v242
    v_mul_f32 v145, v145, v242
    v_mul_f32 v146, v146, v242
    v_mul_f32 v147, v147, v242
    v_mul_f32 v148, v148, v242
    v_mul_f32 v149, v149, v242
    v_mul_f32 v150, v150, v242
    v_mul_f32 v151, v151, v242
    v_mul_f32 v152, v152, v242
    v_mul_f32 v153, v153, v242
    v_mul_f32 v154, v154, v242
    v_mul_f32 v155, v155, v242
    v_mul_f32 v156, v156, v242
    v_mul_f32 v157, v157, v242
    v_mul_f32 v158, v158, v242
    v_mul_f32 v159, v159, v242
    v_mul_f32 v160, v160, v242
    v_mul_f32 v161, v161, v242
    v_mul_f32 v162, v162, v242
    v_mul_f32 v163, v163, v242
    v_mul_f32 v164, v164, v242
    v_mul_f32 v165, v165, v242
    v_mul_f32 v166, v166, v242
    v_mul_f32 v167, v167, v242
    v_mul_f32 v168, v168, v242
    v_mul_f32 v169, v169, v242
    v_mul_f32 v170, v170, v242
    v_mul_f32 v171, v171, v242
    v_mul_f32 v172, v172, v242
    v_mul_f32 v173, v173, v242
    v_mul_f32 v174, v174, v242
    v_mul_f32 v175, v175, v242
    v_mul_f32 v176, v176, v242
    v_mul_f32 v177, v177, v242
    v_mul_f32 v178, v178, v242
    v_mul_f32 v179, v179, v242
    v_mul_f32 v180, v180, v242
    v_mul_f32 v181, v181, v242
    v_mul_f32 v182, v182, v242
    v_mul_f32 v183, v183, v242
    v_mul_f32 v184, v184, v242
    v_mul_f32 v185, v185, v242
    v_mul_f32 v186, v186, v242
    v_mul_f32 v187, v187, v242
    v_mul_f32 v188, v188, v242
    v_mul_f32 v189, v189, v242
    v_mul_f32 v190, v190, v242
    v_mul_f32 v191, v191, v242
L_at_rst0:
    s_waitcnt lgkmcnt(0)
    ds_read_b128 v[208:211], v2 offset:24576
    ds_read_b128 v[212:215], v2 offset:26624
    s_waitcnt lgkmcnt(5)
    v_mfma_f32_32x32x16_bf16 v[80:95], v[192:195], v[16:19], 0
    ds_read_b128 v[216:219], v2 offset:28672
    s_add_u32 m0, s59, 0
    s_add_u32 s54, s72, 0
    buffer_load_dwordx4 v4, s[36:39], s54 offen sc1 lds
    v_exp_f32 v48, v48
    v_exp_f32 v49, v49
    s_waitcnt lgkmcnt(5)
    v_mfma_f32_32x32x16_bf16 v[80:95], v[196:199], v[20:23], v[80:95]
    ds_read_b128 v[220:223], v2 offset:30720
    v_add_f32 v6, v6, v48
    v_cvt_pk_bf16_f32 v112, v48, v49
    s_add_u32 m0, s59, 4096
    s_add_u32 s54, s72, 4096
    buffer_load_dwordx4 v4, s[36:39], s54 offen sc1 lds
    s_waitcnt lgkmcnt(5)
    v_mfma_f32_32x32x16_bf16 v[80:95], v[200:203], v[24:27], v[80:95]
    ds_read_b128 v[192:195], v2 offset:16896
    v_add_f32 v6, v6, v49
    v_exp_f32 v50, v50
    v_exp_f32 v51, v51
    v_add_f32 v6, v6, v50
    s_waitcnt lgkmcnt(5)
    v_mfma_f32_32x32x16_bf16 v[80:95], v[204:207], v[28:31], v[80:95]
    ds_read_b128 v[196:199], v2 offset:18944
    s_add_u32 m0, s59, 8192
    s_add_u32 s54, s72, 8192
    buffer_load_dwordx4 v4, s[36:39], s54 offen sc1 lds
    v_cvt_pk_bf16_f32 v113, v50, v51
    v_add_f32 v6, v6, v51
    s_waitcnt lgkmcnt(5)
    v_mfma_f32_32x32x16_bf16 v[80:95], v[208:211], v[32:35], v[80:95]
    ds_read_b128 v[200:203], v2 offset:20992
    v_exp_f32 v52, v52
    v_exp_f32 v53, v53
    s_add_u32 m0, s59, 12288
    s_add_u32 s54, s72, 12288
    buffer_load_dwordx4 v4, s[36:39], s54 offen sc1 lds
    s_waitcnt lgkmcnt(5)
    v_mfma_f32_32x32x16_bf16 v[80:95], v[212:215], v[36:39], v[80:95]
    ds_read_b128 v[204:207], v2 offset:23040
    v_add_f32 v6, v6, v52
    v_cvt_pk_bf16_f32 v114, v52, v53
    v_add_f32 v6, v6, v53
    v_exp_f32 v54, v54
    s_waitcnt lgkmcnt(5)
    v_mfma_f32_32x32x16_bf16 v[80:95], v[216:219], v[40:43], v[80:95]
    ds_read_b128 v[208:211], v2 offset:25088
    s_add_u32 m0, s59, 49152
    s_add_u32 s54, s65, 16384
    buffer_load_dwordx4 v4, s[36:39], s54 offen sc1 lds
    v_exp_f32 v55, v55
    v_add_f32 v6, v6, v54
    s_waitcnt lgkmcnt(5)
    v_mfma_f32_32x32x16_bf16 v[80:95], v[220:223], v[44:47], v[80:95]
    ds_read_b128 v[212:215], v2 offset:27136
    v_cvt_pk_bf16_f32 v115, v54, v55
    v_add_f32 v6, v6, v55
    s_add_u32 m0, s59, 53248
    s_add_u32 s54, s65, 20480
    s_waitcnt lgkmcnt(5)
    v_mfma_f32_32x32x16_bf16 v[96:111], v[192:195], v[16:19], 0
    ds_read_b128 v[216:219], v2 offset:29184
    buffer_load_dwordx4 v4, s[36:39], s54 offen sc1 lds
    v_exp_f32 v56, v56
    v_exp_f32 v57, v57
    v_add_f32 v6, v6, v56
    v_cvt_pk_bf16_f32 v116, v56, v57
    s_waitcnt lgkmcnt(5)
    v_mfma_f32_32x32x16_bf16 v[96:111], v[196:199], v[20:23], v[96:111]
    ds_read_b128 v[220:223], v2 offset:31232
    s_add_u32 m0, s59, 57344
    s_add_u32 s54, s65, 24576
    buffer_load_dwordx4 v4, s[36:39], s54 offen sc1 lds
    v_add_f32 v6, v6, v57
    v_exp_f32 v58, v58
    s_waitcnt lgkmcnt(5)
    v_mfma_f32_32x32x16_bf16 v[96:111], v[200:203], v[24:27], v[96:111]
    ds_read_b128 v[192:195], v3 offset:0
    v_exp_f32 v59, v59
    v_add_f32 v6, v6, v58
    s_add_u32 m0, s59, 61440
    s_add_u32 s54, s65, 28672
    s_waitcnt lgkmcnt(5)
    v_mfma_f32_32x32x16_bf16 v[96:111], v[204:207], v[28:31], v[96:111]
    ds_read_b128 v[196:199], v3 offset:512
    buffer_load_dwordx4 v4, s[36:39], s54 offen sc1 lds
    v_cvt_pk_bf16_f32 v117, v58, v59
    v_add_f32 v6, v6, v59
    v_exp_f32 v60, v60
    v_exp_f32 v61, v61
    s_waitcnt lgkmcnt(5)
    v_mfma_f32_32x32x16_bf16 v[96:111], v[208:211], v[32:35], v[96:111]
    ds_read_b128 v[200:203], v3 offset:1024
    v_add_f32 v6, v6, v60
    v_cvt_pk_bf16_f32 v118, v60, v61
    v_add_f32 v6, v6, v61
    v_exp_f32 v62, v62
    v_exp_f32 v63, v63
    s_waitcnt lgkmcnt(5)
    v_mfma_f32_32x32x16_bf16 v[96:111], v[212:215], v[36:39], v[96:111]
    ds_read_b128 v[204:207], v3 offset:1536
    v_add_f32 v6, v6, v62
    v_cvt_pk_bf16_f32 v119, v62, v63
    v_add_f32 v6, v6, v63
    v_exp_f32 v64, v64
    s_waitcnt lgkmcnt(5)
    v_mfma_f32_32x32x16_bf16 v[96:111], v[216:219], v[40:43], v[96:111]
    ds_read_b128 v[208:211], v3 offset:4096
    v_exp_f32 v65, v65
    v_add_f32 v6, v6, v64
    v_cvt_pk_bf16_f32 v120, v64, v65
    v_add_f32 v6, v6, v65
    v_exp_f32 v66, v66
    s_waitcnt lgkmcnt(5)
    v_mfma_f32_32x32x16_bf16 v[96:111], v[220:223], v[44:47], v[96:111]
    ds_read_b128 v[212:215], v3 offset:4608
    v_exp_f32 v67, v67
    v_add_f32 v6, v6, v66
    v_cvt_pk_bf16_f32 v121, v66, v67
    v_add_f32 v6, v6, v67
    s_waitcnt lgkmcnt(5)
    v_mfma_f32_32x32x16_bf16 v[128:143], v[192:195], v[112:115], v[128:143]
    ds_read_b128 v[216:219], v3 offset:5120
    v_exp_f32 v68, v68
    v_exp_f32 v69, v69
    v_add_f32 v6, v6, v68
    v_cvt_pk_bf16_f32 v122, v68, v69
    s_waitcnt lgkmcnt(5)
    v_mfma_f32_32x32x16_bf16 v[144:159], v[196:199], v[112:115], v[144:159]
    ds_read_b128 v[220:223], v3 offset:5632
    v_add_f32 v6, v6, v69
    v_exp_f32 v70, v70
    v_exp_f32 v71, v71
    v_add_f32 v6, v6, v70
    s_waitcnt lgkmcnt(5)
    v_mfma_f32_32x32x16_bf16 v[160:175], v[200:203], v[112:115], v[160:175]
    ds_read_b128 v[192:195], v3 offset:8192
    v_cvt_pk_bf16_f32 v123, v70, v71
    v_add_f32 v6, v6, v71
    v_exp_f32 v72, v72
    v_exp_f32 v73, v73
    s_waitcnt lgkmcnt(5)
    v_mfma_f32_32x32x16_bf16 v[176:191], v[204:207], v[112:115], v[176:191]
    ds_read_b128 v[196:199], v3 offset:8704
    v_add_f32 v6, v6, v72
    v_cvt_pk_bf16_f32 v124, v72, v73
    v_add_f32 v6, v6, v73
    s_waitcnt lgkmcnt(5)
    v_mfma_f32_32x32x16_bf16 v[128:143], v[208:211], v[116:119], v[128:143]
    ds_read_b128 v[200:203], v3 offset:9216
    v_exp_f32 v74, v74
    v_exp_f32 v75, v75
    v_add_f32 v6, v6, v74
    v_cvt_pk_bf16_f32 v125, v74, v75
    s_waitcnt lgkmcnt(5)
    v_mfma_f32_32x32x16_bf16 v[144:159], v[212:215], v[116:119], v[144:159]
    ds_read_b128 v[204:207], v3 offset:9728
    v_add_f32 v6, v6, v75
    v_exp_f32 v76, v76
    v_exp_f32 v77, v77
    v_add_f32 v6, v6, v76
    s_waitcnt lgkmcnt(5)
    v_mfma_f32_32x32x16_bf16 v[160:175], v[216:219], v[116:119], v[160:175]
    ds_read_b128 v[208:211], v3 offset:12288
    v_cvt_pk_bf16_f32 v126, v76, v77
    v_add_f32 v6, v6, v77
    v_exp_f32 v78, v78
    v_exp_f32 v79, v79
    s_waitcnt lgkmcnt(5)
    v_mfma_f32_32x32x16_bf16 v[176:191], v[220:223], v[116:119], v[176:191]
    ds_read_b128 v[212:215], v3 offset:12800
    v_add_f32 v6, v6, v78
    v_cvt_pk_bf16_f32 v127, v78, v79
    v_add_f32 v6, v6, v79
    s_waitcnt lgkmcnt(5)
    v_mfma_f32_32x32x16_bf16 v[128:143], v[192:195], v[120:123], v[128:143]
    ds_read_b128 v[216:219], v3 offset:13312
    v_max3_f32 v240, v80, v81, v82
    v_max3_f32 v242, v83, v84, v85
    v_max3_f32 v240, v240, v86, v87
    v_max3_f32 v242, v242, v88, v89
    v_max3_f32 v240, v240, v90, v91
    v_max3_f32 v242, v242, v92, v93
    v_max3_f32 v240, v240, v94, v95
    v_max3_f32 v242, v242, v96, v97
    v_max3_f32 v240, v240, v98, v99
    v_max3_f32 v242, v242, v100, v101
    v_max3_f32 v240, v240, v102, v103
    v_max3_f32 v242, v242, v104, v105
    v_max3_f32 v240, v240, v106, v107
    s_waitcnt lgkmcnt(5)
    v_mfma_f32_32x32x16_bf16 v[144:159], v[196:199], v[120:123], v[144:159]
    ds_read_b128 v[220:223], v3 offset:13824
    v_max3_f32 v242, v242, v108, v109
    v_max3_f32 v240, v240, v110, v111
    v_max_f32 v240, v240, v242
    v_mov_b32 v242, v240
    s_nop 1
    v_permlane32_swap_b32 v240, v242
    v_max_f32 v240, v240, v242
    v_max_f32 v247, 0xf149f2ca, v240
    v_sub_f32 v80, v80, v247
    v_sub_f32 v81, v81, v247
    v_sub_f32 v82, v82, v247
    v_sub_f32 v83, v83, v247
    v_sub_f32 v84, v84, v247
    v_sub_f32 v85, v85, v247
    s_waitcnt lgkmcnt(5)
    v_mfma_f32_32x32x16_bf16 v[160:175], v[200:203], v[120:123], v[160:175]
    v_sub_f32 v86, v86, v247
    v_sub_f32 v87, v87, v247
    v_sub_f32 v88, v88, v247
    v_sub_f32 v89, v89, v247
    v_sub_f32 v90, v90, v247
    v_sub_f32 v91, v91, v247
    v_sub_f32 v92, v92, v247
    v_sub_f32 v93, v93, v247
    v_sub_f32 v94, v94, v247
    v_sub_f32 v95, v95, v247
    v_sub_f32 v96, v96, v247
    v_sub_f32 v97, v97, v247
    v_sub_f32 v98, v98, v247
    s_waitcnt lgkmcnt(4)
    v_mfma_f32_32x32x16_bf16 v[176:191], v[204:207], v[120:123], v[176:191]
    v_sub_f32 v99, v99, v247
    v_sub_f32 v100, v100, v247
    v_sub_f32 v101, v101, v247
    v_sub_f32 v102, v102, v247
    v_sub_f32 v103, v103, v247
    v_sub_f32 v104, v104, v247
    v_sub_f32 v105, v105, v247
    v_sub_f32 v106, v106, v247
    v_sub_f32 v107, v107, v247
    v_sub_f32 v108, v108, v247
    v_sub_f32 v109, v109, v247
    v_sub_f32 v110, v110, v247
    v_sub_f32 v111, v111, v247
    s_waitcnt vmcnt(0) lgkmcnt(0)
    s_barrier
    v_mfma_f32_32x32x16_bf16 v[128:143], v[208:211], v[124:127], v[128:143]
    ds_read_b128 v[192:195], v2 offset:0
    v_mfma_f32_32x32x16_bf16 v[144:159], v[212:215], v[124:127], v[144:159]
    ds_read_b128 v[196:199], v2 offset:2048
    v_mfma_f32_32x32x16_bf16 v[160:175], v[216:219], v[124:127], v[160:175]
    ds_read_b128 v[200:203], v2 offset:4096
    v_mfma_f32_32x32x16_bf16 v[176:191], v[220:223], v[124:127], v[176:191]
    ds_read_b128 v[204:207], v2 offset:6144
    v_sub_f32 v5, 0, v224
    v_mov_b32 v240, v6
    s_nop 1
    v_permlane32_swap_b32 v6, v240
    v_add_f32 v6, v6, v240
    s_barrier
    s_lshl_b32 s56, s27, 13
    s_add_u32 s56, s56, 131072
    s_lshr_b32 s57, s27, 1
    s_lshl_b32 s57, s57, 16
    s_and_b32 s60, s27, 1
    s_lshl_b32 s60, s60, 13
    s_add_u32 s57, s57, s60
    s_add_u32 s57, s57, 32768
    s_cmp_eq_u32 s26, 0
    s_cselect_b32 s56, s56, s57
    s_lshl_b32 s57, s25, 9
    s_add_u32 s57, s57, 16384
    v_lshlrev_b32 v12, 2, v1
    v_add_u32 v12, s57, v12
    ds_write_b32 v12, v5
    ds_write_b32 v12, v6 offset:256
    v_lshlrev_b32 v13, 4, v1
    v_add_u32 v13, s56, v13
    s_cmp_eq_u32 s26, 0
    s_cbranch_scc0 L_at_cw1t0
    ds_write_b128 v13, v[160:163] offset:0
    ds_write_b128 v13, v[164:167] offset:1024
    ds_write_b128 v13, v[168:171] offset:2048
    ds_write_b128 v13, v[172:175] offset:3072
    ds_write_b128 v13, v[176:179] offset:4096
    ds_write_b128 v13, v[180:183] offset:5120
    ds_write_b128 v13, v[184:187] offset:6144
    ds_write_b128 v13, v[188:191] offset:7168
    s_branch L_at_cw2t0
L_at_cw1t0:
    ds_write_b128 v13, v[128:131] offset:0
    ds_write_b128 v13, v[132:135] offset:1024
    ds_write_b128 v13, v[136:139] offset:2048
    ds_write_b128 v13, v[140:143] offset:3072
    ds_write_b128 v13, v[144:147] offset:4096
    ds_write_b128 v13, v[148:151] offset:5120
    ds_write_b128 v13, v[152:155] offset:6144
    ds_write_b128 v13, v[156:159] offset:7168
L_at_cw2t0:
    s_waitcnt lgkmcnt(0)
    s_barrier
    s_lshl_b32 s56, s27, 13
    s_add_u32 s56, s56, 131072
    s_lshr_b32 s57, s27, 1
    s_lshl_b32 s57, s57, 16
    s_and_b32 s60, s27, 1
    s_lshl_b32 s60, s60, 13
    s_add_u32 s57, s57, s60
    s_add_u32 s57, s57, 32768
    s_cmp_eq_u32 s26, 1
    s_cselect_b32 s56, s56, s57
    s_xor_b32 s57, s25, 4
    s_lshl_b32 s57, s57, 9
    s_add_u32 s57, s57, 16384
    v_lshlrev_b32 v12, 2, v1
    v_add_u32 v12, s57, v12
    v_lshlrev_b32 v13, 4, v1
    v_add_u32 v13, s56, v13
    ds_read_b32 v240, v12
    ds_read_b32 v241, v12 offset:256
    ds_read_b128 v[48:51], v13 offset:0
    ds_read_b128 v[52:55], v13 offset:1024
    ds_read_b128 v[56:59], v13 offset:2048
    ds_read_b128 v[60:63], v13 offset:3072
    ds_read_b128 v[64:67], v13 offset:4096
    ds_read_b128 v[68:71], v13 offset:5120
    ds_read_b128 v[72:75], v13 offset:6144
    ds_read_b128 v[76:79], v13 offset:7168
    s_waitcnt lgkmcnt(8)
    v_max_f32 v242, v240, v5
    v_sub_f32 v244, v5, v242
    v_sub_f32 v245, v240, v242
    v_exp_f32 v244, v244
    v_exp_f32 v245, v245
    v_mul_f32 v246, v6, v244
    v_fmac_f32 v246, v241, v245
    v_rcp_f32 v246, v246
    s_nop 0
    v_mul_f32 v244, v244, v246
    v_mul_f32 v245, v245, v246
    s_waitcnt lgkmcnt(0)
    s_lshl_b32 s56, s64, 9
    s_lshl_b32 s57, s20, 4
    s_add_u32 s56, s56, s57
    s_lshl_b32 s57, s26, 3
    s_add_u32 s56, s56, s57
    s_lshl_b32 s56, s56, 11
    s_lshl_b32 s57, s27, 9
    s_add_u32 s56, s56, s57
    v_lshrrev_b32 v12, 5, v1
    v_lshlrev_b32 v12, 11, v12
    v_and_b32 v13, 31, v1
    v_lshlrev_b32 v13, 4, v13
    v_add_u32 v12, v12, v13
    v_add_u32 v12, s56, v12
    s_cmp_eq_u32 s26, 0
    s_cbranch_scc0 L_at_fin1t0
    v_mul_f32 v128, v128, v244
    v_fmac_f32 v128, v48, v245
    v_mul_f32 v129, v129, v244
    v_fmac_f32 v129, v49, v245
    v_mul_f32 v130, v130, v244
    v_fmac_f32 v130, v50, v245
    v_mul_f32 v131, v131, v244
    v_fmac_f32 v131, v51, v245
    v_mul_f32 v132, v132, v244
    v_fmac_f32 v132, v52, v245
    v_mul_f32 v133, v133, v244
    v_fmac_f32 v133, v53, v245
    v_mul_f32 v134, v134, v244
    v_fmac_f32 v134, v54, v245
    v_mul_f32 v135, v135, v244
    v_fmac_f32 v135, v55, v245
    v_mul_f32 v136, v136, v244
    v_fmac_f32 v136, v56, v245
    v_mul_f32 v137, v137, v244
    v_fmac_f32 v137, v57, v245
    v_mul_f32 v138, v138, v244
    v_fmac_f32 v138, v58, v245
    v_mul_f32 v139, v139, v244
    v_fmac_f32 v139, v59, v245
    v_mul_f32 v140, v140, v244
    v_fmac_f32 v140, v60, v245
    v_mul_f32 v141, v141, v244
    v_fmac_f32 v141, v61, v245
    v_mul_f32 v142, v142, v244
    v_fmac_f32 v142, v62, v245
    v_mul_f32 v143, v143, v244
    v_fmac_f32 v143, v63, v245
    v_mul_f32 v144, v144, v244
    v_fmac_f32 v144, v64, v245
    v_mul_f32 v145, v145, v244
    v_fmac_f32 v145, v65, v245
    v_mul_f32 v146, v146, v244
    v_fmac_f32 v146, v66, v245
    v_mul_f32 v147, v147, v244
    v_fmac_f32 v147, v67, v245
    v_mul_f32 v148, v148, v244
    v_fmac_f32 v148, v68, v245
    v_mul_f32 v149, v149, v244
    v_fmac_f32 v149, v69, v245
    v_mul_f32 v150, v150, v244
    v_fmac_f32 v150, v70, v245
    v_mul_f32 v151, v151, v244
    v_fmac_f32 v151, v71, v245
    v_mul_f32 v152, v152, v244
    v_fmac_f32 v152, v72, v245
    v_mul_f32 v153, v153, v244
    v_fmac_f32 v153, v73, v245
    v_mul_f32 v154, v154, v244
    v_fmac_f32 v154, v74, v245
    v_mul_f32 v155, v155, v244
    v_fmac_f32 v155, v75, v245
    v_mul_f32 v156, v156, v244
    v_fmac_f32 v156, v76, v245
    v_mul_f32 v157, v157, v244
    v_fmac_f32 v157, v77, v245
    v_mul_f32 v158, v158, v244
    v_fmac_f32 v158, v78, v245
    v_mul_f32 v159, v159, v244
    v_fmac_f32 v159, v79, v245
    v_cvt_pk_bf16_f32 v112, v128, v129
    v_cvt_pk_bf16_f32 v113, v130, v131
    v_cvt_pk_bf16_f32 v114, v132, v133
    v_cvt_pk_bf16_f32 v115, v134, v135
    s_mov_b32 s60, 0
    buffer_store_dwordx4 v[112:115], v12, s[40:43], s60 offen sc1
    v_cvt_pk_bf16_f32 v116, v136, v137
    v_cvt_pk_bf16_f32 v117, v138, v139
    v_cvt_pk_bf16_f32 v118, v140, v141
    v_cvt_pk_bf16_f32 v119, v142, v143
    s_mov_b32 s60, 4096
    buffer_store_dwordx4 v[116:119], v12, s[40:43], s60 offen sc1
    v_cvt_pk_bf16_f32 v120, v144, v145
    v_cvt_pk_bf16_f32 v121, v146, v147
    v_cvt_pk_bf16_f32 v122, v148, v149
    v_cvt_pk_bf16_f32 v123, v150, v151
    s_mov_b32 s60, 8192
    buffer_store_dwordx4 v[120:123], v12, s[40:43], s60 offen sc1
    v_cvt_pk_bf16_f32 v124, v152, v153
    v_cvt_pk_bf16_f32 v125, v154, v155
    v_cvt_pk_bf16_f32 v126, v156, v157
    v_cvt_pk_bf16_f32 v127, v158, v159
    s_mov_b32 s60, 12288
    buffer_store_dwordx4 v[124:127], v12, s[40:43], s60 offen sc1
    s_branch L_at_fin2t0
L_at_fin1t0:
    v_mul_f32 v160, v160, v244
    v_fmac_f32 v160, v48, v245
    v_mul_f32 v161, v161, v244
    v_fmac_f32 v161, v49, v245
    v_mul_f32 v162, v162, v244
    v_fmac_f32 v162, v50, v245
    v_mul_f32 v163, v163, v244
    v_fmac_f32 v163, v51, v245
    v_mul_f32 v164, v164, v244
    v_fmac_f32 v164, v52, v245
    v_mul_f32 v165, v165, v244
    v_fmac_f32 v165, v53, v245
    v_mul_f32 v166, v166, v244
    v_fmac_f32 v166, v54, v245
    v_mul_f32 v167, v167, v244
    v_fmac_f32 v167, v55, v245
    v_mul_f32 v168, v168, v244
    v_fmac_f32 v168, v56, v245
    v_mul_f32 v169, v169, v244
    v_fmac_f32 v169, v57, v245
    v_mul_f32 v170, v170, v244
    v_fmac_f32 v170, v58, v245
    v_mul_f32 v171, v171, v244
    v_fmac_f32 v171, v59, v245
    v_mul_f32 v172, v172, v244
    v_fmac_f32 v172, v60, v245
    v_mul_f32 v173, v173, v244
    v_fmac_f32 v173, v61, v245
    v_mul_f32 v174, v174, v244
    v_fmac_f32 v174, v62, v245
    v_mul_f32 v175, v175, v244
    v_fmac_f32 v175, v63, v245
    v_mul_f32 v176, v176, v244
    v_fmac_f32 v176, v64, v245
    v_mul_f32 v177, v177, v244
    v_fmac_f32 v177, v65, v245
    v_mul_f32 v178, v178, v244
    v_fmac_f32 v178, v66, v245
    v_mul_f32 v179, v179, v244
    v_fmac_f32 v179, v67, v245
    v_mul_f32 v180, v180, v244
    v_fmac_f32 v180, v68, v245
    v_mul_f32 v181, v181, v244
    v_fmac_f32 v181, v69, v245
    v_mul_f32 v182, v182, v244
    v_fmac_f32 v182, v70, v245
    v_mul_f32 v183, v183, v244
    v_fmac_f32 v183, v71, v245
    v_mul_f32 v184, v184, v244
    v_fmac_f32 v184, v72, v245
    v_mul_f32 v185, v185, v244
    v_fmac_f32 v185, v73, v245
    v_mul_f32 v186, v186, v244
    v_fmac_f32 v186, v74, v245
    v_mul_f32 v187, v187, v244
    v_fmac_f32 v187, v75, v245
    v_mul_f32 v188, v188, v244
    v_fmac_f32 v188, v76, v245
    v_mul_f32 v189, v189, v244
    v_fmac_f32 v189, v77, v245
    v_mul_f32 v190, v190, v244
    v_fmac_f32 v190, v78, v245
    v_mul_f32 v191, v191, v244
    v_fmac_f32 v191, v79, v245
    v_cvt_pk_bf16_f32 v112, v160, v161
    v_cvt_pk_bf16_f32 v113, v162, v163
    v_cvt_pk_bf16_f32 v114, v164, v165
    v_cvt_pk_bf16_f32 v115, v166, v167
    s_mov_b32 s60, 0
    buffer_store_dwordx4 v[112:115], v12, s[40:43], s60 offen sc1
    v_cvt_pk_bf16_f32 v116, v168, v169
    v_cvt_pk_bf16_f32 v117, v170, v171
    v_cvt_pk_bf16_f32 v118, v172, v173
    v_cvt_pk_bf16_f32 v119, v174, v175
    s_mov_b32 s60, 4096
    buffer_store_dwordx4 v[116:119], v12, s[40:43], s60 offen sc1
    v_cvt_pk_bf16_f32 v120, v176, v177
    v_cvt_pk_bf16_f32 v121, v178, v179
    v_cvt_pk_bf16_f32 v122, v180, v181
    v_cvt_pk_bf16_f32 v123, v182, v183
    s_mov_b32 s60, 8192
    buffer_store_dwordx4 v[120:123], v12, s[40:43], s60 offen sc1
    v_cvt_pk_bf16_f32 v124, v184, v185
    v_cvt_pk_bf16_f32 v125, v186, v187
    v_cvt_pk_bf16_f32 v126, v188, v189
    v_cvt_pk_bf16_f32 v127, v190, v191
    s_mov_b32 s60, 12288
    buffer_store_dwordx4 v[124:127], v12, s[40:43], s60 offen sc1
L_at_fin2t0:
    s_waitcnt vmcnt(0)
    s_barrier
    s_cmp_eq_u32 s25, 0
    s_cbranch_scc0 L_fz_s8
    s_lshl_b32 s88, s2, 3
    s_add_u32 s88, s88, 2048
    s_mov_b64 exec, 1
    v_mov_b32 v248, s100
    v_mov_b32 v249, s101
    v_mov_b32 v250, 0
    buffer_store_dwordx2 v[248:249], v250, s[96:99], s88 offen sc0 sc1
    s_mov_b64 exec, -1
L_fz_s8:
    v_mov_b32 v6, 0
    v_mov_b32 v128, 0
    v_mov_b32 v129, 0
    v_mov_b32 v130, 0
    v_mov_b32 v131, 0
    v_mov_b32 v132, 0
    v_mov_b32 v133, 0
    v_mov_b32 v134, 0
    v_mov_b32 v135, 0
    v_mov_b32 v136, 0
    v_mov_b32 v137, 0
    v_mov_b32 v138, 0
    v_mov_b32 v139, 0
    v_mov_b32 v140, 0
    v_mov_b32 v141, 0
    v_mov_b32 v142, 0
    v_mov_b32 v143, 0
    v_mov_b32 v144, 0
    v_mov_b32 v145, 0
    v_mov_b32 v146, 0
    v_mov_b32 v147, 0
    v_mov_b32 v148, 0
    v_mov_b32 v149, 0
    v_mov_b32 v150, 0
    v_mov_b32 v151, 0
    v_mov_b32 v152, 0
    v_mov_b32 v153, 0
    v_mov_b32 v154, 0
    v_mov_b32 v155, 0
    v_mov_b32 v156, 0
    v_mov_b32 v157, 0
    v_mov_b32 v158, 0
    v_mov_b32 v159, 0
    v_mov_b32 v160, 0
    v_mov_b32 v161, 0
    v_mov_b32 v162, 0
    v_mov_b32 v163, 0
    v_mov_b32 v164, 0
    v_mov_b32 v165, 0
    v_mov_b32 v166, 0
    v_mov_b32 v167, 0
    v_mov_b32 v168, 0
    v_mov_b32 v169, 0
    v_mov_b32 v170, 0
    v_mov_b32 v171, 0
    v_mov_b32 v172, 0
    v_mov_b32 v173, 0
    v_mov_b32 v174, 0
    v_mov_b32 v175, 0
    v_mov_b32 v176, 0
    v_mov_b32 v177, 0
    v_mov_b32 v178, 0
    v_mov_b32 v179, 0
    v_mov_b32 v180, 0
    v_mov_b32 v181, 0
    v_mov_b32 v182, 0
    v_mov_b32 v183, 0
    v_mov_b32 v184, 0
    v_mov_b32 v185, 0
    v_mov_b32 v186, 0
    v_mov_b32 v187, 0
    v_mov_b32 v188, 0
    v_mov_b32 v189, 0
    v_mov_b32 v190, 0
    v_mov_b32 v191, 0
    v_sub_f32 v224, 0, v247
    v_sub_f32 v225, 0, v247
    v_sub_f32 v226, 0, v247
    v_sub_f32 v227, 0, v247
    v_sub_f32 v228, 0, v247
    v_sub_f32 v229, 0, v247
    v_sub_f32 v230, 0, v247
    v_sub_f32 v231, 0, v247
    v_sub_f32 v232, 0, v247
    v_sub_f32 v233, 0, v247
    v_sub_f32 v234, 0, v247
    v_sub_f32 v235, 0, v247
    v_sub_f32 v236, 0, v247
    v_sub_f32 v237, 0, v247
    v_sub_f32 v238, 0, v247
    v_sub_f32 v239, 0, v247
    v_mov_b32 v240, 0
    s_mov_b32 s63, 1
    s_mov_b32 s64, s22
    s_add_u32 s67, s64, 1
    s_lshl_b32 s73, s64, 16
    s_add_u32 s73, s73, s65
    s_mov_b32 s77, s73
    s_mov_b32 s69, 0
    s_add_u32 s70, s65, 65536
    s_branch L_at_loop1
L_at_trans1:
    v_add_u32 v12, 131072, v9
    ds_read_b128 v[16:19], v12 offset:0
    ds_read_b128 v[20:23], v12 offset:4096
    ds_read_b128 v[24:27], v12 offset:8192
    ds_read_b128 v[28:31], v12 offset:12288
    ds_read_b128 v[32:35], v12 offset:16384
    ds_read_b128 v[36:39], v12 offset:20480
    ds_read_b128 v[40:43], v12 offset:24576
    ds_read_b128 v[44:47], v12 offset:28672
    s_add_u32 s72, s65, 65536
    v_cmp_lt_f32 vcc, v243, v240
    s_nop 4
    s_cbranch_vccz L_at_rst1
    v_max_f32 v240, 0, v240
    v_sub_f32 v242, 0, v240
    v_exp_f32 v242, v242
    v_sub_f32 v80, v80, v240
    v_sub_f32 v81, v81, v240
    v_sub_f32 v82, v82, v240
    v_sub_f32 v83, v83, v240
    v_sub_f32 v84, v84, v240
    v_sub_f32 v85, v85, v240
    v_sub_f32 v86, v86, v240
    v_sub_f32 v87, v87, v240
    v_sub_f32 v88, v88, v240
    v_sub_f32 v89, v89, v240
    v_sub_f32 v90, v90, v240
    v_sub_f32 v91, v91, v240
    v_sub_f32 v92, v92, v240
    v_sub_f32 v93, v93, v240
    v_sub_f32 v94, v94, v240
    v_sub_f32 v95, v95, v240
    v_sub_f32 v96, v96, v240
    v_sub_f32 v97, v97, v240
    v_sub_f32 v98, v98, v240
    v_sub_f32 v99, v99, v240
    v_sub_f32 v100, v100, v240
    v_sub_f32 v101, v101, v240
    v_sub_f32 v102, v102, v240
    v_sub_f32 v103, v103, v240
    v_sub_f32 v104, v104, v240
    v_sub_f32 v105, v105, v240
    v_sub_f32 v106, v106, v240
    v_sub_f32 v107, v107, v240
    v_sub_f32 v108, v108, v240
    v_sub_f32 v109, v109, v240
    v_sub_f32 v110, v110, v240
    v_sub_f32 v111, v111, v240
    v_sub_f32 v224, v224, v240
    v_sub_f32 v225, v225, v240
    v_sub_f32 v226, v226, v240
    v_sub_f32 v227, v227, v240
    v_sub_f32 v228, v228, v240
    v_sub_f32 v229, v229, v240
    v_sub_f32 v230, v230, v240
    v_sub_f32 v231, v231, v240
    v_sub_f32 v232, v232, v240
    v_sub_f32 v233, v233, v240
    v_sub_f32 v234, v234, v240
    v_sub_f32 v235, v235, v240
    v_sub_f32 v236, v236, v240
    v_sub_f32 v237, v237, v240
    v_sub_f32 v238, v238, v240
    v_sub_f32 v239, v239, v240
    v_mul_f32 v6, v6, v242
    v_mul_f32 v128, v128, v242
    v_mul_f32 v129, v129, v242
    v_mul_f32 v130, v130, v242
    v_mul_f32 v131, v131, v242
    v_mul_f32 v132, v132, v242
    v_mul_f32 v133, v133, v242
    v_mul_f32 v134, v134, v242
    v_mul_f32 v135, v135, v242
    v_mul_f32 v136, v136, v242
    v_mul_f32 v137, v137, v242
    v_mul_f32 v138, v138, v242
    v_mul_f32 v139, v139, v242
    v_mul_f32 v140, v140, v242
    v_mul_f32 v141, v141, v242
    v_mul_f32 v142, v142, v242
    v_mul_f32 v143, v143, v242
    v_mul_f32 v144, v144, v242
    v_mul_f32 v145, v145, v242
    v_mul_f32 v146, v146, v242
    v_mul_f32 v147, v147, v242
    v_mul_f32 v148, v148, v242
    v_mul_f32 v149, v149, v242
    v_mul_f32 v150, v150, v242
    v_mul_f32 v151, v151, v242
    v_mul_f32 v152, v152, v242
    v_mul_f32 v153, v153, v242
    v_mul_f32 v154, v154, v242
    v_mul_f32 v155, v155, v242
    v_mul_f32 v156, v156, v242
    v_mul_f32 v157, v157, v242
    v_mul_f32 v158, v158, v242
    v_mul_f32 v159, v159, v242
    v_mul_f32 v160, v160, v242
    v_mul_f32 v161, v161, v242
    v_mul_f32 v162, v162, v242
    v_mul_f32 v163, v163, v242
    v_mul_f32 v164, v164, v242
    v_mul_f32 v165, v165, v242
    v_mul_f32 v166, v166, v242
    v_mul_f32 v167, v167, v242
    v_mul_f32 v168, v168, v242
    v_mul_f32 v169, v169, v242
    v_mul_f32 v170, v170, v242
    v_mul_f32 v171, v171, v242
    v_mul_f32 v172, v172, v242
    v_mul_f32 v173, v173, v242
    v_mul_f32 v174, v174, v242
    v_mul_f32 v175, v175, v242
    v_mul_f32 v176, v176, v242
    v_mul_f32 v177, v177, v242
    v_mul_f32 v178, v178, v242
    v_mul_f32 v179, v179, v242
    v_mul_f32 v180, v180, v242
    v_mul_f32 v181, v181, v242
    v_mul_f32 v182, v182, v242
    v_mul_f32 v183, v183, v242
    v_mul_f32 v184, v184, v242
    v_mul_f32 v185, v185, v242
    v_mul_f32 v186, v186, v242
    v_mul_f32 v187, v187, v242
    v_mul_f32 v188, v188, v242
    v_mul_f32 v189, v189, v242
    v_mul_f32 v190, v190, v242
    v_mul_f32 v191, v191, v242
L_at_rst1:
    s_waitcnt lgkmcnt(0)
    ds_read_b128 v[208:211], v2 offset:8192
    ds_read_b128 v[212:215], v2 offset:10240
    s_waitcnt lgkmcnt(5)
    v_mfma_f32_32x32x16_bf16 v[48:63], v[192:195], v[16:19], 0
    ds_read_b128 v[216:219], v2 offset:12288
    s_add_u32 m0, s59, 16384
    s_add_u32 s54, s72, 0
    buffer_load_dwordx4 v4, s[36:39], s54 offen sc1 lds
    v_exp_f32 v80, v80
    v_exp_f32 v81, v81
    s_waitcnt lgkmcnt(5)
    v_mfma_f32_32x32x16_bf16 v[48:63], v[196:199], v[20:23], v[48:63]
    ds_read_b128 v[220:223], v2 offset:14336
    v_add_f32 v6, v6, v80
    v_cvt_pk_bf16_f32 v112, v80, v81
    s_add_u32 m0, s59, 20480
    s_add_u32 s54, s72, 4096
    buffer_load_dwordx4 v4, s[36:39], s54 offen sc1 lds
    s_waitcnt lgkmcnt(5)
    v_mfma_f32_32x32x16_bf16 v[48:63], v[200:203], v[24:27], v[48:63]
    ds_read_b128 v[192:195], v2 offset:512
    v_add_f32 v6, v6, v81
    v_exp_f32 v82, v82
    v_exp_f32 v83, v83
    v_add_f32 v6, v6, v82
    s_waitcnt lgkmcnt(5)
    v_mfma_f32_32x32x16_bf16 v[48:63], v[204:207], v[28:31], v[48:63]
    ds_read_b128 v[196:199], v2 offset:2560
    s_add_u32 m0, s59, 24576
    s_add_u32 s54, s72, 8192
    buffer_load_dwordx4 v4, s[36:39], s54 offen sc1 lds
    v_cvt_pk_bf16_f32 v113, v82, v83
    v_add_f32 v6, v6, v83
    s_waitcnt lgkmcnt(5)
    v_mfma_f32_32x32x16_bf16 v[48:63], v[208:211], v[32:35], v[48:63]
    ds_read_b128 v[200:203], v2 offset:4608
    v_exp_f32 v84, v84
    v_exp_f32 v85, v85
    s_add_u32 m0, s59, 28672
    s_add_u32 s54, s72, 12288
    buffer_load_dwordx4 v4, s[36:39], s54 offen sc1 lds
    s_waitcnt lgkmcnt(5)
    v_mfma_f32_32x32x16_bf16 v[48:63], v[212:215], v[36:39], v[48:63]
    ds_read_b128 v[204:207], v2 offset:6656
    v_add_f32 v6, v6, v84
    v_cvt_pk_bf16_f32 v114, v84, v85
    v_add_f32 v6, v6, v85
    v_exp_f32 v86, v86
    s_waitcnt lgkmcnt(5)
    v_mfma_f32_32x32x16_bf16 v[48:63], v[216:219], v[40:43], v[48:63]
    ds_read_b128 v[208:211], v2 offset:8704
    s_add_u32 m0, s59, 32768
    s_add_u32 s54, s65, 16384
    buffer_load_dwordx4 v4, s[36:39], s54 offen sc1 lds
    v_exp_f32 v87, v87
    v_add_f32 v6, v6, v86
    s_waitcnt lgkmcnt(5)
    v_mfma_f32_32x32x16_bf16 v[48:63], v[220:223], v[44:47], v[48:63]
    ds_read_b128 v[212:215], v2 offset:10752
    v_cvt_pk_bf16_f32 v115, v86, v87
    v_add_f32 v6, v6, v87
    s_add_u32 m0, s59, 36864
    s_add_u32 s54, s65, 20480
    s_waitcnt lgkmcnt(5)
    v_mfma_f32_32x32x16_bf16 v[64:79], v[192:195], v[16:19], 0
    ds_read_b128 v[216:219], v2 offset:12800
    buffer_load_dwordx4 v4, s[36:39], s54 offen sc1 lds
    v_exp_f32 v88, v88
    v_exp_f32 v89, v89
    v_add_f32 v6, v6, v88
    v_cvt_pk_bf16_f32 v116, v88, v89
    s_waitcnt lgkmcnt(5)
    v_mfma_f32_32x32x16_bf16 v[64:79], v[196:199], v[20:23], v[64:79]
    ds_read_b128 v[220:223], v2 offset:14848
    s_add_u32 m0, s59, 40960
    s_add_u32 s54, s65, 24576
    buffer_load_dwordx4 v4, s[36:39], s54 offen sc1 lds
    v_add_f32 v6, v6, v89
    v_exp_f32 v90, v90
    s_waitcnt lgkmcnt(5)
    v_mfma_f32_32x32x16_bf16 v[64:79], v[200:203], v[24:27], v[64:79]
    ds_read_b128 v[192:195], v3 offset:16384
    v_exp_f32 v91, v91
    v_add_f32 v6, v6, v90
    s_add_u32 m0, s59, 45056
    s_add_u32 s54, s65, 28672
    s_waitcnt lgkmcnt(5)
    v_mfma_f32_32x32x16_bf16 v[64:79], v[204:207], v[28:31], v[64:79]
    ds_read_b128 v[196:199], v3 offset:16896
    buffer_load_dwordx4 v4, s[36:39], s54 offen sc1 lds
    v_cvt_pk_bf16_f32 v117, v90, v91
    v_add_f32 v6, v6, v91
    v_exp_f32 v92, v92
    v_exp_f32 v93, v93
    s_waitcnt lgkmcnt(5)
    v_mfma_f32_32x32x16_bf16 v[64:79], v[208:211], v[32:35], v[64:79]
    ds_read_b128 v[200:203], v3 offset:17408
    v_add_f32 v6, v6, v92
    v_cvt_pk_bf16_f32 v118, v92, v93
    v_add_f32 v6, v6, v93
    v_exp_f32 v94, v94
    v_exp_f32 v95, v95
    s_waitcnt lgkmcnt(5)
    v_mfma_f32_32x32x16_bf16 v[64:79], v[212:215], v[36:39], v[64:79]
    ds_read_b128 v[204:207], v3 offset:17920
    v_add_f32 v6, v6, v94
    v_cvt_pk_bf16_f32 v119, v94, v95
    v_add_f32 v6, v6, v95
    v_exp_f32 v96, v96
    s_waitcnt lgkmcnt(5)
    v_mfma_f32_32x32x16_bf16 v[64:79], v[216:219], v[40:43], v[64:79]
    ds_read_b128 v[208:211], v3 offset:20480
    v_exp_f32 v97, v97
    v_add_f32 v6, v6, v96
    v_cvt_pk_bf16_f32 v120, v96, v97
    v_add_f32 v6, v6, v97
    v_exp_f32 v98, v98
    s_waitcnt lgkmcnt(5)
    v_mfma_f32_32x32x16_bf16 v[64:79], v[220:223], v[44:47], v[64:79]
    ds_read_b128 v[212:215], v3 offset:20992
    v_exp_f32 v99, v99
    v_add_f32 v6, v6, v98
    v_cvt_pk_bf16_f32 v121, v98, v99
    v_add_f32 v6, v6, v99
    s_waitcnt lgkmcnt(5)
    v_mfma_f32_32x32x16_bf16 v[128:143], v[192:195], v[112:115], v[128:143]
    ds_read_b128 v[216:219], v3 offset:21504
    v_exp_f32 v100, v100
    v_exp_f32 v101, v101
    v_add_f32 v6, v6, v100
    v_cvt_pk_bf16_f32 v122, v100, v101
    s_waitcnt lgkmcnt(5)
    v_mfma_f32_32x32x16_bf16 v[144:159], v[196:199], v[112:115], v[144:159]
    ds_read_b128 v[220:223], v3 offset:22016
    v_add_f32 v6, v6, v101
    v_exp_f32 v102, v102
    v_exp_f32 v103, v103
    v_add_f32 v6, v6, v102
    s_waitcnt lgkmcnt(5)
    v_mfma_f32_32x32x16_bf16 v[160:175], v[200:203], v[112:115], v[160:175]
    ds_read_b128 v[192:195], v3 offset:24576
    v_cvt_pk_bf16_f32 v123, v102, v103
    v_add_f32 v6, v6, v103
    v_exp_f32 v104, v104
    v_exp_f32 v105, v105
    s_waitcnt lgkmcnt(5)
    v_mfma_f32_32x32x16_bf16 v[176:191], v[204:207], v[112:115], v[176:191]
    ds_read_b128 v[196:199], v3 offset:25088
    v_add_f32 v6, v6, v104
    v_cvt_pk_bf16_f32 v124, v104, v105
    v_add_f32 v6, v6, v105
    s_waitcnt lgkmcnt(5)
    v_mfma_f32_32x32x16_bf16 v[128:143], v[208:211], v[116:119], v[128:143]
    ds_read_b128 v[200:203], v3 offset:25600
    v_exp_f32 v106, v106
    v_exp_f32 v107, v107
    v_add_f32 v6, v6, v106
    v_cvt_pk_bf16_f32 v125, v106, v107
    s_waitcnt lgkmcnt(5)
    v_mfma_f32_32x32x16_bf16 v[144:159], v[212:215], v[116:119], v[144:159]
    ds_read_b128 v[204:207], v3 offset:26112
    v_add_f32 v6, v6, v107
    v_exp_f32 v108, v108
    v_exp_f32 v109, v109
    v_add_f32 v6, v6, v108
    s_waitcnt lgkmcnt(5)
    v_mfma_f32_32x32x16_bf16 v[160:175], v[216:219], v[116:119], v[160:175]
    ds_read_b128 v[208:211], v3 offset:28672
    v_cvt_pk_bf16_f32 v126, v108, v109
    v_add_f32 v6, v6, v109
    v_exp_f32 v110, v110
    v_exp_f32 v111, v111
    s_waitcnt lgkmcnt(5)
    v_mfma_f32_32x32x16_bf16 v[176:191], v[220:223], v[116:119], v[176:191]
    ds_read_b128 v[212:215], v3 offset:29184
    v_add_f32 v6, v6, v110
    v_cvt_pk_bf16_f32 v127, v110, v111
    v_add_f32 v6, v6, v111
    s_waitcnt lgkmcnt(5)
    v_mfma_f32_32x32x16_bf16 v[128:143], v[192:195], v[120:123], v[128:143]
    ds_read_b128 v[216:219], v3 offset:29696
    v_max3_f32 v240, v48, v49, v50
    v_max3_f32 v242, v51, v52, v53
    v_max3_f32 v240, v240, v54, v55
    v_max3_f32 v242, v242, v56, v57
    v_max3_f32 v240, v240, v58, v59
    v_max3_f32 v242, v242, v60, v61
    v_max3_f32 v240, v240, v62, v63
    v_max3_f32 v242, v242, v64, v65
    v_max3_f32 v240, v240, v66, v67
    v_max3_f32 v242, v242, v68, v69
    v_max3_f32 v240, v240, v70, v71
    v_max3_f32 v242, v242, v72, v73
    v_max3_f32 v240, v240, v74, v75
    s_waitcnt lgkmcnt(5)
    v_mfma_f32_32x32x16_bf16 v[144:159], v[196:199], v[120:123], v[144:159]
    ds_read_b128 v[220:223], v3 offset:30208
    v_max3_f32 v242, v242, v76, v77
    v_max3_f32 v240, v240, v78, v79
    v_max_f32 v240, v240, v242
    v_mov_b32 v242, v240
    s_nop 1
    v_permlane32_swap_b32 v240, v242
    v_max_f32 v240, v240, v242
    v_max_f32 v247, 0xf149f2ca, v240
    v_sub_f32 v48, v48, v247
    v_sub_f32 v49, v49, v247
    v_sub_f32 v50, v50, v247
    v_sub_f32 v51, v51, v247
    v_sub_f32 v52, v52, v247
    v_sub_f32 v53, v53, v247
    s_waitcnt lgkmcnt(5)
    v_mfma_f32_32x32x16_bf16 v[160:175], v[200:203], v[120:123], v[160:175]
    v_sub_f32 v54, v54, v247
    v_sub_f32 v55, v55, v247
    v_sub_f32 v56, v56, v247
    v_sub_f32 v57, v57, v247
    v_sub_f32 v58, v58, v247
    v_sub_f32 v59, v59, v247
    v_sub_f32 v60, v60, v247
    v_sub_f32 v61, v61, v247
    v_sub_f32 v62, v62, v247
    v_sub_f32 v63, v63, v247
    v_sub_f32 v64, v64, v247
    v_sub_f32 v65, v65, v247
    v_sub_f32 v66, v66, v247
    s_waitcnt lgkmcnt(4)
    v_mfma_f32_32x32x16_bf16 v[176:191], v[204:207], v[120:123], v[176:191]
    v_sub_f32 v67, v67, v247
    v_sub_f32 v68, v68, v247
    v_sub_f32 v69, v69, v247
    v_sub_f32 v70, v70, v247
    v_sub_f32 v71, v71, v247
    v_sub_f32 v72, v72, v247
    v_sub_f32 v73, v73, v247
    v_sub_f32 v74, v74, v247
    v_sub_f32 v75, v75, v247
    v_sub_f32 v76, v76, v247
    v_sub_f32 v77, v77, v247
    v_sub_f32 v78, v78, v247
    v_sub_f32 v79, v79, v247
    s_waitcnt vmcnt(0) lgkmcnt(0)
    s_barrier
    v_mfma_f32_32x32x16_bf16 v[128:143], v[208:211], v[124:127], v[128:143]
    ds_read_b128 v[192:195], v2 offset:16384
    v_mfma_f32_32x32x16_bf16 v[144:159], v[212:215], v[124:127], v[144:159]
    ds_read_b128 v[196:199], v2 offset:18432
    v_mfma_f32_32x32x16_bf16 v[160:175], v[216:219], v[124:127], v[160:175]
    ds_read_b128 v[200:203], v2 offset:20480
    v_mfma_f32_32x32x16_bf16 v[176:191], v[220:223], v[124:127], v[176:191]
    ds_read_b128 v[204:207], v2 offset:22528
    v_sub_f32 v5, 0, v224
    v_mov_b32 v240, v6
    s_nop 1
    v_permlane32_swap_b32 v6, v240
    v_add_f32 v6, v6, v240
    s_barrier
    s_lshl_b32 s56, s27, 13
    s_add_u32 s56, s56, 131072
    s_lshr_b32 s57, s27, 1
    s_lshl_b32 s57, s57, 16
    s_and_b32 s60, s27, 1
    s_lshl_b32 s60, s60, 13
    s_add_u32 s57, s57, s60
    s_add_u32 s57, s57, 49152
    s_cmp_eq_u32 s26, 0
    s_cselect_b32 s56, s56, s57
    s_lshl_b32 s57, s25, 9
    s_add_u32 s57, s57, 0
    v_lshlrev_b32 v12, 2, v1
    v_add_u32 v12, s57, v12
    ds_write_b32 v12, v5
    ds_write_b32 v12, v6 offset:256
    v_lshlrev_b32 v13, 4, v1
    v_add_u32 v13, s56, v13
    s_cmp_eq_u32 s26, 0
    s_cbranch_scc0 L_at_cw1t1
    ds_write_b128 v13, v[160:163] offset:0
    ds_write_b128 v13, v[164:167] offset:1024
    ds_write_b128 v13, v[168:171] offset:2048
    ds_write_b128 v13, v[172:175] offset:3072
    ds_write_b128 v13, v[176:179] offset:4096
    ds_write_b128 v13, v[180:183] offset:5120
    ds_write_b128 v13, v[184:187] offset:6144
    ds_write_b128 v13, v[188:191] offset:7168
    s_branch L_at_cw2t1
L_at_cw1t1:
    ds_write_b128 v13, v[128:131] offset:0
    ds_write_b128 v13, v[132:135] offset:1024
    ds_write_b128 v13, v[136:139] offset:2048
    ds_write_b128 v13, v[140:143] offset:3072
    ds_write_b128 v13, v[144:147] offset:4096
    ds_write_b128 v13, v[148:151] offset:5120
    ds_write_b128 v13, v[152:155] offset:6144
    ds_write_b128 v13, v[156:159] offset:7168
L_at_cw2t1:
    s_waitcnt lgkmcnt(0)
    s_barrier
    s_lshl_b32 s56, s27, 13
    s_add_u32 s56, s56, 131072
    s_lshr_b32 s57, s27, 1
    s_lshl_b32 s57, s57, 16
    s_and_b32 s60, s27, 1
    s_lshl_b32 s60, s60, 13
    s_add_u32 s57, s57, s60
    s_add_u32 s57, s57, 49152
    s_cmp_eq_u32 s26, 1
    s_cselect_b32 s56, s56, s57
    s_xor_b32 s57, s25, 4
    s_lshl_b32 s57, s57, 9
    s_add_u32 s57, s57, 0
    v_lshlrev_b32 v12, 2, v1
    v_add_u32 v12, s57, v12
    v_lshlrev_b32 v13, 4, v1
    v_add_u32 v13, s56, v13
    ds_read_b32 v240, v12
    ds_read_b32 v241, v12 offset:256
    ds_read_b128 v[80:83], v13 offset:0
    ds_read_b128 v[84:87], v13 offset:1024
    ds_read_b128 v[88:91], v13 offset:2048
    ds_read_b128 v[92:95], v13 offset:3072
    ds_read_b128 v[96:99], v13 offset:4096
    ds_read_b128 v[100:103], v13 offset:5120
    ds_read_b128 v[104:107], v13 offset:6144
    ds_read_b128 v[108:111], v13 offset:7168
    s_waitcnt lgkmcnt(8)
    v_max_f32 v242, v240, v5
    v_sub_f32 v244, v5, v242
    v_sub_f32 v245, v240, v242
    v_exp_f32 v244, v244
    v_exp_f32 v245, v245
    v_mul_f32 v246, v6, v244
    v_fmac_f32 v246, v241, v245
    v_rcp_f32 v246, v246
    s_nop 0
    v_mul_f32 v244, v244, v246
    v_mul_f32 v245, v245, v246
    s_waitcnt lgkmcnt(0)
    s_lshl_b32 s56, s64, 9
    s_lshl_b32 s57, s20, 4
    s_add_u32 s56, s56, s57
    s_lshl_b32 s57, s26, 3
    s_add_u32 s56, s56, s57
    s_lshl_b32 s56, s56, 11
    s_lshl_b32 s57, s27, 9
    s_add_u32 s56, s56, s57
    v_lshrrev_b32 v12, 5, v1
    v_lshlrev_b32 v12, 11, v12
    v_and_b32 v13, 31, v1
    v_lshlrev_b32 v13, 4, v13
    v_add_u32 v12, v12, v13
    v_add_u32 v12, s56, v12
    s_cmp_eq_u32 s26, 0
    s_cbranch_scc0 L_at_fin1t1
    v_mul_f32 v128, v128, v244
    v_fmac_f32 v128, v80, v245
    v_mul_f32 v129, v129, v244
    v_fmac_f32 v129, v81, v245
    v_mul_f32 v130, v130, v244
    v_fmac_f32 v130, v82, v245
    v_mul_f32 v131, v131, v244
    v_fmac_f32 v131, v83, v245
    v_mul_f32 v132, v132, v244
    v_fmac_f32 v132, v84, v245
    v_mul_f32 v133, v133, v244
    v_fmac_f32 v133, v85, v245
    v_mul_f32 v134, v134, v244
    v_fmac_f32 v134, v86, v245
    v_mul_f32 v135, v135, v244
    v_fmac_f32 v135, v87, v245
    v_mul_f32 v136, v136, v244
    v_fmac_f32 v136, v88, v245
    v_mul_f32 v137, v137, v244
    v_fmac_f32 v137, v89, v245
    v_mul_f32 v138, v138, v244
    v_fmac_f32 v138, v90, v245
    v_mul_f32 v139, v139, v244
    v_fmac_f32 v139, v91, v245
    v_mul_f32 v140, v140, v244
    v_fmac_f32 v140, v92, v245
    v_mul_f32 v141, v141, v244
    v_fmac_f32 v141, v93, v245
    v_mul_f32 v142, v142, v244
    v_fmac_f32 v142, v94, v245
    v_mul_f32 v143, v143, v244
    v_fmac_f32 v143, v95, v245
    v_mul_f32 v144, v144, v244
    v_fmac_f32 v144, v96, v245
    v_mul_f32 v145, v145, v244
    v_fmac_f32 v145, v97, v245
    v_mul_f32 v146, v146, v244
    v_fmac_f32 v146, v98, v245
    v_mul_f32 v147, v147, v244
    v_fmac_f32 v147, v99, v245
    v_mul_f32 v148, v148, v244
    v_fmac_f32 v148, v100, v245
    v_mul_f32 v149, v149, v244
    v_fmac_f32 v149, v101, v245
    v_mul_f32 v150, v150, v244
    v_fmac_f32 v150, v102, v245
    v_mul_f32 v151, v151, v244
    v_fmac_f32 v151, v103, v245
    v_mul_f32 v152, v152, v244
    v_fmac_f32 v152, v104, v245
    v_mul_f32 v153, v153, v244
    v_fmac_f32 v153, v105, v245
    v_mul_f32 v154, v154, v244
    v_fmac_f32 v154, v106, v245
    v_mul_f32 v155, v155, v244
    v_fmac_f32 v155, v107, v245
    v_mul_f32 v156, v156, v244
    v_fmac_f32 v156, v108, v245
    v_mul_f32 v157, v157, v244
    v_fmac_f32 v157, v109, v245
    v_mul_f32 v158, v158, v244
    v_fmac_f32 v158, v110, v245
    v_mul_f32 v159, v159, v244
    v_fmac_f32 v159, v111, v245
    v_cvt_pk_bf16_f32 v112, v128, v129
    v_cvt_pk_bf16_f32 v113, v130, v131
    v_cvt_pk_bf16_f32 v114, v132, v133
    v_cvt_pk_bf16_f32 v115, v134, v135
    s_mov_b32 s60, 0
    buffer_store_dwordx4 v[112:115], v12, s[40:43], s60 offen sc1
    v_cvt_pk_bf16_f32 v116, v136, v137
    v_cvt_pk_bf16_f32 v117, v138, v139
    v_cvt_pk_bf16_f32 v118, v140, v141
    v_cvt_pk_bf16_f32 v119, v142, v143
    s_mov_b32 s60, 4096
    buffer_store_dwordx4 v[116:119], v12, s[40:43], s60 offen sc1
    v_cvt_pk_bf16_f32 v120, v144, v145
    v_cvt_pk_bf16_f32 v121, v146, v147
    v_cvt_pk_bf16_f32 v122, v148, v149
    v_cvt_pk_bf16_f32 v123, v150, v151
    s_mov_b32 s60, 8192
    buffer_store_dwordx4 v[120:123], v12, s[40:43], s60 offen sc1
    v_cvt_pk_bf16_f32 v124, v152, v153
    v_cvt_pk_bf16_f32 v125, v154, v155
    v_cvt_pk_bf16_f32 v126, v156, v157
    v_cvt_pk_bf16_f32 v127, v158, v159
    s_mov_b32 s60, 12288
    buffer_store_dwordx4 v[124:127], v12, s[40:43], s60 offen sc1
    s_branch L_at_fin2t1
L_at_fin1t1:
    v_mul_f32 v160, v160, v244
    v_fmac_f32 v160, v80, v245
    v_mul_f32 v161, v161, v244
    v_fmac_f32 v161, v81, v245
    v_mul_f32 v162, v162, v244
    v_fmac_f32 v162, v82, v245
    v_mul_f32 v163, v163, v244
    v_fmac_f32 v163, v83, v245
    v_mul_f32 v164, v164, v244
    v_fmac_f32 v164, v84, v245
    v_mul_f32 v165, v165, v244
    v_fmac_f32 v165, v85, v245
    v_mul_f32 v166, v166, v244
    v_fmac_f32 v166, v86, v245
    v_mul_f32 v167, v167, v244
    v_fmac_f32 v167, v87, v245
    v_mul_f32 v168, v168, v244
    v_fmac_f32 v168, v88, v245
    v_mul_f32 v169, v169, v244
    v_fmac_f32 v169, v89, v245
    v_mul_f32 v170, v170, v244
    v_fmac_f32 v170, v90, v245
    v_mul_f32 v171, v171, v244
    v_fmac_f32 v171, v91, v245
    v_mul_f32 v172, v172, v244
    v_fmac_f32 v172, v92, v245
    v_mul_f32 v173, v173, v244
    v_fmac_f32 v173, v93, v245
    v_mul_f32 v174, v174, v244
    v_fmac_f32 v174, v94, v245
    v_mul_f32 v175, v175, v244
    v_fmac_f32 v175, v95, v245
    v_mul_f32 v176, v176, v244
    v_fmac_f32 v176, v96, v245
    v_mul_f32 v177, v177, v244
    v_fmac_f32 v177, v97, v245
    v_mul_f32 v178, v178, v244
    v_fmac_f32 v178, v98, v245
    v_mul_f32 v179, v179, v244
    v_fmac_f32 v179, v99, v245
    v_mul_f32 v180, v180, v244
    v_fmac_f32 v180, v100, v245
    v_mul_f32 v181, v181, v244
    v_fmac_f32 v181, v101, v245
    v_mul_f32 v182, v182, v244
    v_fmac_f32 v182, v102, v245
    v_mul_f32 v183, v183, v244
    v_fmac_f32 v183, v103, v245
    v_mul_f32 v184, v184, v244
    v_fmac_f32 v184, v104, v245
    v_mul_f32 v185, v185, v244
    v_fmac_f32 v185, v105, v245
    v_mul_f32 v186, v186, v244
    v_fmac_f32 v186, v106, v245
    v_mul_f32 v187, v187, v244
    v_fmac_f32 v187, v107, v245
    v_mul_f32 v188, v188, v244
    v_fmac_f32 v188, v108, v245
    v_mul_f32 v189, v189, v244
    v_fmac_f32 v189, v109, v245
    v_mul_f32 v190, v190, v244
    v_fmac_f32 v190, v110, v245
    v_mul_f32 v191, v191, v244
    v_fmac_f32 v191, v111, v245
    v_cvt_pk_bf16_f32 v112, v160, v161
    v_cvt_pk_bf16_f32 v113, v162, v163
    v_cvt_pk_bf16_f32 v114, v164, v165
    v_cvt_pk_bf16_f32 v115, v166, v167
    s_mov_b32 s60, 0
    buffer_store_dwordx4 v[112:115], v12, s[40:43], s60 offen sc1
    v_cvt_pk_bf16_f32 v116, v168, v169
    v_cvt_pk_bf16_f32 v117, v170, v171
    v_cvt_pk_bf16_f32 v118, v172, v173
    v_cvt_pk_bf16_f32 v119, v174, v175
    s_mov_b32 s60, 4096
    buffer_store_dwordx4 v[116:119], v12, s[40:43], s60 offen sc1
    v_cvt_pk_bf16_f32 v120, v176, v177
    v_cvt_pk_bf16_f32 v121, v178, v179
    v_cvt_pk_bf16_f32 v122, v180, v181
    v_cvt_pk_bf16_f32 v123, v182, v183
    s_mov_b32 s60, 8192
    buffer_store_dwordx4 v[120:123], v12, s[40:43], s60 offen sc1
    v_cvt_pk_bf16_f32 v124, v184, v185
    v_cvt_pk_bf16_f32 v125, v186, v187
    v_cvt_pk_bf16_f32 v126, v188, v189
    v_cvt_pk_bf16_f32 v127, v190, v191
    s_mov_b32 s60, 12288
    buffer_store_dwordx4 v[124:127], v12, s[40:43], s60 offen sc1
L_at_fin2t1:
    s_waitcnt vmcnt(0)
    s_barrier
    s_cmp_eq_u32 s25, 0
    s_cbranch_scc0 L_fz_s9
    s_lshl_b32 s88, s2, 3
    s_add_u32 s88, s88, 2048
    s_mov_b64 exec, 1
    v_mov_b32 v248, s100
    v_mov_b32 v249, s101
    v_mov_b32 v250, 0
    buffer_store_dwordx2 v[248:249], v250, s[96:99], s88 offen sc0 sc1
    s_mov_b64 exec, -1
L_fz_s9:
    v_mov_b32 v6, 0
    v_mov_b32 v128, 0
    v_mov_b32 v129, 0
    v_mov_b32 v130, 0
    v_mov_b32 v131, 0
    v_mov_b32 v132, 0
    v_mov_b32 v133, 0
    v_mov_b32 v134, 0
    v_mov_b32 v135, 0
    v_mov_b32 v136, 0
    v_mov_b32 v137, 0
    v_mov_b32 v138, 0
    v_mov_b32 v139, 0
    v_mov_b32 v140, 0
    v_mov_b32 v141, 0
    v_mov_b32 v142, 0
    v_mov_b32 v143, 0
    v_mov_b32 v144, 0
    v_mov_b32 v145, 0
    v_mov_b32 v146, 0
    v_mov_b32 v147, 0
    v_mov_b32 v148, 0
    v_mov_b32 v149, 0
    v_mov_b32 v150, 0
    v_mov_b32 v151, 0
    v_mov_b32 v152, 0
    v_mov_b32 v153, 0
    v_mov_b32 v154, 0
    v_mov_b32 v155, 0
    v_mov_b32 v156, 0
    v_mov_b32 v157, 0
    v_mov_b32 v158, 0
    v_mov_b32 v159, 0
    v_mov_b32 v160, 0
    v_mov_b32 v161, 0
    v_mov_b32 v162, 0
    v_mov_b32 v163, 0
    v_mov_b32 v164, 0
    v_mov_b32 v165, 0
    v_mov_b32 v166, 0
    v_mov_b32 v167, 0
    v_mov_b32 v168, 0
    v_mov_b32 v169, 0
    v_mov_b32 v170, 0
    v_mov_b32 v171, 0
    v_mov_b32 v172, 0
    v_mov_b32 v173, 0
    v_mov_b32 v174, 0
    v_mov_b32 v175, 0
    v_mov_b32 v176, 0
    v_mov_b32 v177, 0
    v_mov_b32 v178, 0
    v_mov_b32 v179, 0
    v_mov_b32 v180, 0
    v_mov_b32 v181, 0
    v_mov_b32 v182, 0
    v_mov_b32 v183, 0
    v_mov_b32 v184, 0
    v_mov_b32 v185, 0
    v_mov_b32 v186, 0
    v_mov_b32 v187, 0
    v_mov_b32 v188, 0
    v_mov_b32 v189, 0
    v_mov_b32 v190, 0
    v_mov_b32 v191, 0
    v_sub_f32 v224, 0, v247
    v_sub_f32 v225, 0, v247
    v_sub_f32 v226, 0, v247
    v_sub_f32 v227, 0, v247
    v_sub_f32 v228, 0, v247
    v_sub_f32 v229, 0, v247
    v_sub_f32 v230, 0, v247
    v_sub_f32 v231, 0, v247
    v_sub_f32 v232, 0, v247
    v_sub_f32 v233, 0, v247
    v_sub_f32 v234, 0, v247
    v_sub_f32 v235, 0, v247
    v_sub_f32 v236, 0, v247
    v_sub_f32 v237, 0, v247
    v_sub_f32 v238, 0, v247
    v_sub_f32 v239, 0, v247
    v_mov_b32 v240, 0
    s_mov_b32 s63, 1
    s_mov_b32 s64, s22
    s_add_u32 s67, s64, 1
    s_lshl_b32 s73, s64, 16
    s_add_u32 s73, s73, s65
    s_mov_b32 s77, s73
    s_mov_b32 s69, 0
    s_add_u32 s70, s65, 65536
    s_branch L_at_loop0
L_at_comb2:
    v_sub_f32 v5, 0, v224
    v_mov_b32 v240, v6
    s_nop 1
    v_permlane32_swap_b32 v6, v240
    v_add_f32 v6, v6, v240
    s_barrier
    s_mul_i32 s56, s25, 8704
    s_add_u32 s57, s56, 8192
    v_lshlrev_b32 v12, 2, v1
    v_add_u32 v12, s57, v12
    ds_write_b32 v12, v5
    ds_write_b32 v12, v6 offset:256
    v_lshlrev_b32 v13, 4, v1
    v_add_u32 v13, s56, v13
    s_cmp_eq_u32 s26, 0
    s_cbranch_scc0 L_at_cw1f
    ds_write_b128 v13, v[160:163] offset:0
    ds_write_b128 v13, v[164:167] offset:1024
    ds_write_b128 v13, v[168:171] offset:2048
    ds_write_b128 v13, v[172:175] offset:3072
    ds_write_b128 v13, v[176:179] offset:4096
    ds_write_b128 v13, v[180:183] offset:5120
    ds_write_b128 v13, v[184:187] offset:6144
    ds_write_b128 v13, v[188:191] offset:7168
    s_branch L_at_cw2f
L_at_cw1f:
    ds_write_b128 v13, v[128:131] offset:0
    ds_write_b128 v13, v[132:135] offset:1024
    ds_write_b128 v13, v[136:139] offset:2048
    ds_write_b128 v13, v[140:143] offset:3072
    ds_write_b128 v13, v[144:147] offset:4096
    ds_write_b128 v13, v[148:151] offset:5120
    ds_write_b128 v13, v[152:155] offset:6144
    ds_write_b128 v13, v[156:159] offset:7168
L_at_cw2f:
    s_waitcnt lgkmcnt(0)
    s_barrier
    s_xor_b32 s56, s25, 4
    s_mul_i32 s56, s56, 8704
    s_add_u32 s57, s56, 8192
    v_lshlrev_b32 v12, 2, v1
    v_add_u32 v12, s57, v12
    v_lshlrev_b32 v13, 4, v1
    v_add_u32 v13, s56, v13
    ds_read_b32 v240, v12
    ds_read_b32 v241, v12 offset:256
    ds_read_b128 v[48:51], v13 offset:0
    ds_read_b128 v[52:55], v13 offset:1024
    ds_read_b128 v[56:59], v13 offset:2048
    ds_read_b128 v[60:63], v13 offset:3072
    ds_read_b128 v[64:67], v13 offset:4096
    ds_read_b128 v[68:71], v13 offset:5120
    ds_read_b128 v[72:75], v13 offset:6144
    ds_read_b128 v[76:79], v13 offset:7168
    s_waitcnt lgkmcnt(8)
    v_max_f32 v242, v240, v5
    v_sub_f32 v244, v5, v242
    v_sub_f32 v245, v240, v242
    v_exp_f32 v244, v244
    v_exp_f32 v245, v245
    v_mul_f32 v246, v6, v244
    v_fmac_f32 v246, v241, v245
    v_rcp_f32 v246, v246
    s_nop 0
    v_mul_f32 v244, v244, v246
    v_mul_f32 v245, v245, v246
    s_waitcnt lgkmcnt(0)
    s_lshl_b32 s56, s64, 9
    s_lshl_b32 s57, s20, 4
    s_add_u32 s56, s56, s57
    s_lshl_b32 s57, s26, 3
    s_add_u32 s56, s56, s57
    s_lshl_b32 s56, s56, 11
    s_lshl_b32 s57, s27, 9
    s_add_u32 s56, s56, s57
    v_lshrrev_b32 v12, 5, v1
    v_lshlrev_b32 v12, 11, v12
    v_and_b32 v13, 31, v1
    v_lshlrev_b32 v13, 4, v13
    v_add_u32 v12, v12, v13
    v_add_u32 v12, s56, v12
    s_cmp_eq_u32 s26, 0
    s_cbranch_scc0 L_at_fin1f
    v_mul_f32 v128, v128, v244
    v_fmac_f32 v128, v48, v245
    v_mul_f32 v129, v129, v244
    v_fmac_f32 v129, v49, v245
    v_mul_f32 v130, v130, v244
    v_fmac_f32 v130, v50, v245
    v_mul_f32 v131, v131, v244
    v_fmac_f32 v131, v51, v245
    v_mul_f32 v132, v132, v244
    v_fmac_f32 v132, v52, v245
    v_mul_f32 v133, v133, v244
    v_fmac_f32 v133, v53, v245
    v_mul_f32 v134, v134, v244
    v_fmac_f32 v134, v54, v245
    v_mul_f32 v135, v135, v244
    v_fmac_f32 v135, v55, v245
    v_mul_f32 v136, v136, v244
    v_fmac_f32 v136, v56, v245
    v_mul_f32 v137, v137, v244
    v_fmac_f32 v137, v57, v245
    v_mul_f32 v138, v138, v244
    v_fmac_f32 v138, v58, v245
    v_mul_f32 v139, v139, v244
    v_fmac_f32 v139, v59, v245
    v_mul_f32 v140, v140, v244
    v_fmac_f32 v140, v60, v245
    v_mul_f32 v141, v141, v244
    v_fmac_f32 v141, v61, v245
    v_mul_f32 v142, v142, v244
    v_fmac_f32 v142, v62, v245
    v_mul_f32 v143, v143, v244
    v_fmac_f32 v143, v63, v245
    v_mul_f32 v144, v144, v244
    v_fmac_f32 v144, v64, v245
    v_mul_f32 v145, v145, v244
    v_fmac_f32 v145, v65, v245
    v_mul_f32 v146, v146, v244
    v_fmac_f32 v146, v66, v245
    v_mul_f32 v147, v147, v244
    v_fmac_f32 v147, v67, v245
    v_mul_f32 v148, v148, v244
    v_fmac_f32 v148, v68, v245
    v_mul_f32 v149, v149, v244
    v_fmac_f32 v149, v69, v245
    v_mul_f32 v150, v150, v244
    v_fmac_f32 v150, v70, v245
    v_mul_f32 v151, v151, v244
    v_fmac_f32 v151, v71, v245
    v_mul_f32 v152, v152, v244
    v_fmac_f32 v152, v72, v245
    v_mul_f32 v153, v153, v244
    v_fmac_f32 v153, v73, v245
    v_mul_f32 v154, v154, v244
    v_fmac_f32 v154, v74, v245
    v_mul_f32 v155, v155, v244
    v_fmac_f32 v155, v75, v245
    v_mul_f32 v156, v156, v244
    v_fmac_f32 v156, v76, v245
    v_mul_f32 v157, v157, v244
    v_fmac_f32 v157, v77, v245
    v_mul_f32 v158, v158, v244
    v_fmac_f32 v158, v78, v245
    v_mul_f32 v159, v159, v244
    v_fmac_f32 v159, v79, v245
    v_cvt_pk_bf16_f32 v80, v128, v129
    v_cvt_pk_bf16_f32 v81, v130, v131
    v_cvt_pk_bf16_f32 v82, v132, v133
    v_cvt_pk_bf16_f32 v83, v134, v135
    s_mov_b32 s60, 0
    buffer_store_dwordx4 v[80:83], v12, s[40:43], s60 offen sc1
    v_cvt_pk_bf16_f32 v84, v136, v137
    v_cvt_pk_bf16_f32 v85, v138, v139
    v_cvt_pk_bf16_f32 v86, v140, v141
    v_cvt_pk_bf16_f32 v87, v142, v143
    s_mov_b32 s60, 4096
    buffer_store_dwordx4 v[84:87], v12, s[40:43], s60 offen sc1
    v_cvt_pk_bf16_f32 v88, v144, v145
    v_cvt_pk_bf16_f32 v89, v146, v147
    v_cvt_pk_bf16_f32 v90, v148, v149
    v_cvt_pk_bf16_f32 v91, v150, v151
    s_mov_b32 s60, 8192
    buffer_store_dwordx4 v[88:91], v12, s[40:43], s60 offen sc1
    v_cvt_pk_bf16_f32 v92, v152, v153
    v_cvt_pk_bf16_f32 v93, v154, v155
    v_cvt_pk_bf16_f32 v94, v156, v157
    v_cvt_pk_bf16_f32 v95, v158, v159
    s_mov_b32 s60, 12288
    buffer_store_dwordx4 v[92:95], v12, s[40:43], s60 offen sc1
    s_branch L_at_fin2f
L_at_fin1f:
    v_mul_f32 v160, v160, v244
    v_fmac_f32 v160, v48, v245
    v_mul_f32 v161, v161, v244
    v_fmac_f32 v161, v49, v245
    v_mul_f32 v162, v162, v244
    v_fmac_f32 v162, v50, v245
    v_mul_f32 v163, v163, v244
    v_fmac_f32 v163, v51, v245
    v_mul_f32 v164, v164, v244
    v_fmac_f32 v164, v52, v245
    v_mul_f32 v165, v165, v244
    v_fmac_f32 v165, v53, v245
    v_mul_f32 v166, v166, v244
    v_fmac_f32 v166, v54, v245
    v_mul_f32 v167, v167, v244
    v_fmac_f32 v167, v55, v245
    v_mul_f32 v168, v168, v244
    v_fmac_f32 v168, v56, v245
    v_mul_f32 v169, v169, v244
    v_fmac_f32 v169, v57, v245
    v_mul_f32 v170, v170, v244
    v_fmac_f32 v170, v58, v245
    v_mul_f32 v171, v171, v244
    v_fmac_f32 v171, v59, v245
    v_mul_f32 v172, v172, v244
    v_fmac_f32 v172, v60, v245
    v_mul_f32 v173, v173, v244
    v_fmac_f32 v173, v61, v245
    v_mul_f32 v174, v174, v244
    v_fmac_f32 v174, v62, v245
    v_mul_f32 v175, v175, v244
    v_fmac_f32 v175, v63, v245
    v_mul_f32 v176, v176, v244
    v_fmac_f32 v176, v64, v245
    v_mul_f32 v177, v177, v244
    v_fmac_f32 v177, v65, v245
    v_mul_f32 v178, v178, v244
    v_fmac_f32 v178, v66, v245
    v_mul_f32 v179, v179, v244
    v_fmac_f32 v179, v67, v245
    v_mul_f32 v180, v180, v244
    v_fmac_f32 v180, v68, v245
    v_mul_f32 v181, v181, v244
    v_fmac_f32 v181, v69, v245
    v_mul_f32 v182, v182, v244
    v_fmac_f32 v182, v70, v245
    v_mul_f32 v183, v183, v244
    v_fmac_f32 v183, v71, v245
    v_mul_f32 v184, v184, v244
    v_fmac_f32 v184, v72, v245
    v_mul_f32 v185, v185, v244
    v_fmac_f32 v185, v73, v245
    v_mul_f32 v186, v186, v244
    v_fmac_f32 v186, v74, v245
    v_mul_f32 v187, v187, v244
    v_fmac_f32 v187, v75, v245
    v_mul_f32 v188, v188, v244
    v_fmac_f32 v188, v76, v245
    v_mul_f32 v189, v189, v244
    v_fmac_f32 v189, v77, v245
    v_mul_f32 v190, v190, v244
    v_fmac_f32 v190, v78, v245
    v_mul_f32 v191, v191, v244
    v_fmac_f32 v191, v79, v245
    v_cvt_pk_bf16_f32 v80, v160, v161
    v_cvt_pk_bf16_f32 v81, v162, v163
    v_cvt_pk_bf16_f32 v82, v164, v165
    v_cvt_pk_bf16_f32 v83, v166, v167
    s_mov_b32 s60, 0
    buffer_store_dwordx4 v[80:83], v12, s[40:43], s60 offen sc1
    v_cvt_pk_bf16_f32 v84, v168, v169
    v_cvt_pk_bf16_f32 v85, v170, v171
    v_cvt_pk_bf16_f32 v86, v172, v173
    v_cvt_pk_bf16_f32 v87, v174, v175
    s_mov_b32 s60, 4096
    buffer_store_dwordx4 v[84:87], v12, s[40:43], s60 offen sc1
    v_cvt_pk_bf16_f32 v88, v176, v177
    v_cvt_pk_bf16_f32 v89, v178, v179
    v_cvt_pk_bf16_f32 v90, v180, v181
    v_cvt_pk_bf16_f32 v91, v182, v183
    s_mov_b32 s60, 8192
    buffer_store_dwordx4 v[88:91], v12, s[40:43], s60 offen sc1
    v_cvt_pk_bf16_f32 v92, v184, v185
    v_cvt_pk_bf16_f32 v93, v186, v187
    v_cvt_pk_bf16_f32 v94, v188, v189
    v_cvt_pk_bf16_f32 v95, v190, v191
    s_mov_b32 s60, 12288
    buffer_store_dwordx4 v[92:95], v12, s[40:43], s60 offen sc1
L_at_fin2f:
    s_barrier
    s_cmp_eq_u32 s63, 0
    s_cbranch_scc0 L_at_sigB
    s_waitcnt vmcnt(0)
    s_barrier
    s_cmp_eq_u32 s25, 0
    s_cbranch_scc0 L_fz_s10
    s_lshl_b32 s88, s2, 3
    s_add_u32 s88, s88, 2048
    s_mov_b64 exec, 1
    v_mov_b32 v248, s100
    v_mov_b32 v249, s101
    v_mov_b32 v250, 0
    buffer_store_dwordx2 v[248:249], v250, s[96:99], s88 offen sc0 sc1
    s_mov_b64 exec, -1
L_fz_s10:
    s_branch L_at_sigD
L_at_sigB:
    s_waitcnt vmcnt(0)
    s_barrier
    s_cmp_eq_u32 s25, 0
    s_cbranch_scc0 L_fz_s11
    s_lshl_b32 s88, s2, 3
    s_add_u32 s88, s88, 4096
    s_mov_b64 exec, 1
    v_mov_b32 v248, s100
    v_mov_b32 v249, s101
    v_mov_b32 v250, 0
    buffer_store_dwordx2 v[248:249], v250, s[96:99], s88 offen sc0 sc1
    s_mov_b64 exec, -1
L_fz_s11:
L_at_sigD:
    s_add_u32 s63, s63, 1
    s_mov_b32 s64, s22
    s_cmp_lt_u32 s63, 2
    s_cbranch_scc1 L_at_tile
L_at_end:
    s_cmp_ge_u32 s2, 256
    s_cbranch_scc1 oproj_kernel_end
    s_load_dwordx2 s[4:5], s[0:1], 40
    s_load_dwordx2 s[12:13], s[0:1], 104
    v_lshrrev_b32 v2, 6, v0
    v_and_b32 v1, 63, v0
    v_readfirstlane_b32 s25, v2
    s_and_b32 s19, s2, 3
    s_lshr_b32 s23, s2, 2
    s_and_b32 s23, s23, 1
    s_lshl_b32 s23, s23, 3
    s_lshr_b32 s21, s2, 3
    s_and_b32 s24, s21, 3
    s_lshr_b32 s21, s21, 2
    s_add_u32 s23, s23, s21
    s_mul_i32 s20, s24, 160
    s_lshl_b32 s21, s23, 7
    s_lshl_b32 s22, s19, 10
    s_waitcnt lgkmcnt(0)
    s_mov_b32 s28, s4
    s_mov_b32 s29, s5
    s_mov_b32 s30, 0x500000
    s_mov_b32 s31, 0x00020000
    s_add_u32 s32, s12, 0x2800000
    s_addc_u32 s33, s13, 0
    s_mov_b32 s34, 0x1000000
    s_mov_b32 s35, 0x00020000
    s_lshl_b32 s53, s25, 10
    v_lshlrev_b32 v3, 4, v1
    s_add_u32 s54, s25, 0
    s_lshl_b32 s54, s54, 6
    v_add_u32 v4, s54, v1
    s_mov_b32 s55, 0xccccccd
    v_mul_hi_u32 v5, s55, v4
    v_mul_u32_u24 v6, 20, v5
    v_sub_u32 v6, v4, v6
    v_mul_u32_u24 v5, 1280, v5
    v_lshlrev_b32 v6, 4, v6
    v_add_u32 v8, v5, v6
    s_add_u32 s54, s25, 8
    s_lshl_b32 s54, s54, 6
    v_add_u32 v4, s54, v1
    s_mov_b32 s55, 0xccccccd
    v_mul_hi_u32 v5, s55, v4
    v_mul_u32_u24 v6, 20, v5
    v_sub_u32 v6, v4, v6
    v_mul_u32_u24 v5, 1280, v5
    v_lshlrev_b32 v6, 4, v6
    v_add_u32 v9, v5, v6
    s_add_u32 s54, s25, 16
    s_lshl_b32 s54, s54, 6
    v_add_u32 v4, s54, v1
    s_mov_b32 s55, 0xccccccd
    v_mul_hi_u32 v5, s55, v4
    v_mul_u32_u24 v6, 20, v5
    v_sub_u32 v6, v4, v6
    v_mul_u32_u24 v5, 1280, v5
    v_lshlrev_b32 v6, 4, v6
    v_add_u32 v10, v5, v6
    s_add_u32 s54, s25, -4
    s_lshl_b32 s54, s54, 10
    v_add_u32 v4, s54, v3
    v_lshrrev_b32 v5, 11, v4
    v_and_b32 v6, 2047, v4
    v_lshlrev_b32 v5, 11, v5
    v_add_u32 v13, v5, v6
    s_add_u32 s54, s25, 4
    s_lshl_b32 s54, s54, 10
    v_add_u32 v4, s54, v3
    v_lshrrev_b32 v5, 11, v4
    v_and_b32 v6, 2047, v4
    v_lshlrev_b32 v5, 11, v5
    v_add_u32 v11, v5, v6
    s_add_u32 s54, s25, 12
    s_lshl_b32 s54, s54, 10
    v_add_u32 v4, s54, v3
    v_lshrrev_b32 v5, 11, v4
    v_and_b32 v6, 2047, v4
    v_lshlrev_b32 v5, 11, v5
    v_add_u32 v12, v5, v6
    s_mul_i32 s51, s22, 1280
    s_lshl_b32 s54, s20, 1
    s_add_u32 s51, s51, s54
    s_lshr_b32 s52, s21, 7
    s_mul_i32 s52, s52, 512
    s_lshr_b32 s54, s22, 3
    s_add_u32 s52, s52, s54
    s_lshl_b32 s52, s52, 11
    s_and_b32 s54, s21, 127
    s_lshl_b32 s54, s54, 4
    s_add_u32 s52, s52, s54
    s_add_u32 m0, s53, 0
    s_add_u32 s54, s51, 0
    buffer_load_dwordx4 v8, s[28:31], s54 offen sc1 lds
    s_add_u32 m0, s53, 8192
    s_add_u32 s54, s51, 0
    buffer_load_dwordx4 v9, s[28:31], s54 offen sc1 lds
    s_add_u32 m0, s53, 36864
    s_add_u32 s54, s51, 81920
    buffer_load_dwordx4 v8, s[28:31], s54 offen sc1 lds
    s_add_u32 m0, s53, 45056
    s_add_u32 s54, s51, 81920
    buffer_load_dwordx4 v9, s[28:31], s54 offen sc1 lds
    s_add_u32 m0, s53, 73728
    s_add_u32 s54, s51, 163840
    buffer_load_dwordx4 v8, s[28:31], s54 offen sc1 lds
    s_add_u32 m0, s53, 81920
    s_add_u32 s54, s51, 163840
    buffer_load_dwordx4 v9, s[28:31], s54 offen sc1 lds
    s_add_u32 m0, s53, 110592
    s_add_u32 s54, s51, 245760
    buffer_load_dwordx4 v8, s[28:31], s54 offen sc1 lds
    s_add_u32 m0, s53, 118784
    s_add_u32 s54, s51, 245760
    buffer_load_dwordx4 v9, s[28:31], s54 offen sc1 lds
    s_cmp_eq_u32 s25, 0
    s_cbranch_scc0 L_fz_w12d
    v_and_b32 v41, 63, v0
    v_min_u32 v41, 7, v41
    s_lshr_b32 s88, s21, 7
    s_sub_u32 s89, 15, s88
    s_cmp_lt_u32 s88, 8
    s_cselect_b32 s88, s88, s89
    s_mov_b32 s87, 512
    s_cselect_b32 s89, 256, s87
    s_lshl_b32 s88, s88, 5
    s_add_u32 s88, s88, s89
    s_lshl_b32 s89, s19, 3
    v_add_u32 v42, s89, v41
    v_and_b32 v40, 3, v42
    v_lshlrev_b32 v40, 3, v40
    v_lshrrev_b32 v42, 2, v42
    v_add_u32 v40, v40, v42
    v_add_u32 v40, s88, v40
    v_lshlrev_b32 v40, 3, v40
    s_mov_b32 s88, 0
L_fz_w12:
    buffer_load_dwordx2 v[42:43], v40, s[96:99], 0 offen sc0 sc1
    s_waitcnt vmcnt(0)
    v_cmp_eq_u64 vcc, s[100:101], v[42:43]
    s_add_u32 s88, s88, 1
    s_nop 0
    s_cmp_eq_u64 vcc, exec
    s_cbranch_scc1 L_fz_w12d
    s_sleep 1
    s_cmp_lt_u32 s88, 400000
    s_cbranch_scc1 L_fz_w12
L_fz_w12d:
    s_barrier
    s_cmp_lt_u32 s25, 4
    s_cbranch_scc0 oproj_kernel_d1a
    s_add_u32 m0, s53, 16384
    s_add_u32 s54, s51, 0
    buffer_load_dwordx4 v10, s[28:31], s54 offen sc1 lds
    s_branch oproj_kernel_d1b
oproj_kernel_d1a:
    s_add_u32 m0, s53, 16384
    s_add_u32 s54, s52, 0
    buffer_load_dwordx4 v13, s[32:35], s54 offen sc1 lds
oproj_kernel_d1b:
    s_add_u32 m0, s53, 24576
    s_add_u32 s54, s52, 0
    buffer_load_dwordx4 v11, s[32:35], s54 offen sc1 lds
    s_cmp_lt_u32 s25, 4
    s_cbranch_scc0 oproj_kernel_d2b
    s_add_u32 m0, s53, 32768
    s_add_u32 s54, s52, 0
    buffer_load_dwordx4 v12, s[32:35], s54 offen sc1 lds
oproj_kernel_d2b:
    s_cmp_lt_u32 s25, 4
    s_cbranch_scc0 oproj_kernel_d3a
    s_add_u32 m0, s53, 53248
    s_add_u32 s54, s51, 81920
    buffer_load_dwordx4 v10, s[28:31], s54 offen sc1 lds
    s_branch oproj_kernel_d3b
oproj_kernel_d3a:
    s_add_u32 m0, s53, 53248
    s_add_u32 s54, s52, 16384
    buffer_load_dwordx4 v13, s[32:35], s54 offen sc1 lds
oproj_kernel_d3b:
    s_add_u32 m0, s53, 61440
    s_add_u32 s54, s52, 16384
    buffer_load_dwordx4 v11, s[32:35], s54 offen sc1 lds
    s_cmp_lt_u32 s25, 4
    s_cbranch_scc0 oproj_kernel_d4b
    s_add_u32 m0, s53, 69632
    s_add_u32 s54, s52, 16384
    buffer_load_dwordx4 v12, s[32:35], s54 offen sc1 lds
oproj_kernel_d4b:
    s_cmp_lt_u32 s25, 4
    s_cbranch_scc0 oproj_kernel_d5a
    s_add_u32 m0, s53, 90112
    s_add_u32 s54, s51, 163840
    buffer_load_dwordx4 v10, s[28:31], s54 offen sc1 lds
    s_branch oproj_kernel_d5b
oproj_kernel_d5a:
    s_add_u32 m0, s53, 90112
    s_add_u32 s54, s52, 32768
    buffer_load_dwordx4 v13, s[32:35], s54 offen sc1 lds
oproj_kernel_d5b:
    s_add_u32 m0, s53, 98304
    s_add_u32 s54, s52, 32768
    buffer_load_dwordx4 v11, s[32:35], s54 offen sc1 lds
    s_cmp_lt_u32 s25, 4
    s_cbranch_scc0 oproj_kernel_d6b
    s_add_u32 m0, s53, 106496
    s_add_u32 s54, s52, 32768
    buffer_load_dwordx4 v12, s[32:35], s54 offen sc1 lds
oproj_kernel_d6b:
    s_cmp_lt_u32 s25, 4
    s_cbranch_scc0 oproj_kernel_d7a
    s_add_u32 m0, s53, 126976
    s_add_u32 s54, s51, 245760
    buffer_load_dwordx4 v10, s[28:31], s54 offen sc1 lds
    s_branch oproj_kernel_d7b
oproj_kernel_d7a:
    s_add_u32 m0, s53, 126976
    s_add_u32 s54, s52, 49152
    buffer_load_dwordx4 v13, s[32:35], s54 offen sc1 lds
oproj_kernel_d7b:
    s_add_u32 m0, s53, 135168
    s_add_u32 s54, s52, 49152
    buffer_load_dwordx4 v11, s[32:35], s54 offen sc1 lds
    s_cmp_lt_u32 s25, 4
    s_cbranch_scc0 oproj_kernel_d8b
    s_add_u32 m0, s53, 143360
    s_add_u32 s54, s52, 49152
    buffer_load_dwordx4 v12, s[32:35], s54 offen sc1 lds
oproj_kernel_d8b:
    s_mov_b32 s56, 0
    s_mov_b32 s26, 0
    s_mov_b32 s57, s25
    s_and_b32 s27, s57, 3
    s_lshr_b32 s24, s57, 2
    v_and_b32 v4, 3, v1
    v_lshrrev_b32 v5, 1, v4
    v_and_b32 v4, 1, v4
    v_lshlrev_b32 v4, 3, v4
    v_lshrrev_b32 v6, 4, v1
    v_and_b32 v6, 1, v6
    v_lshlrev_b32 v6, 1, v6
    v_add_u32 v5, v5, v6
    s_mul_i32 s57, s26, 20
    v_add_u32 v5, s57, v5
    v_lshrrev_b32 v6, 2, v1
    v_and_b32 v6, 3, v6
    v_lshrrev_b32 v7, 5, v1
    v_lshlrev_b32 v7, 3, v7
    v_add_u32 v7, v7, v6
    s_mul_i32 s57, s24, 32
    v_add_u32 v7, s57, v7
    v_mul_u32_u24 v7, 320, v7
    v_add_u32 v7, v7, v4
    v_lshlrev_b32 v5, 4, v5
    v_add_u32 v14, v7, v5
    v_add_u32 v15, 36864, v14
    v_add_u32 v16, 73728, v14
    v_add_u32 v17, 110592, v14
    v_lshrrev_b32 v4, 5, v1
    s_mul_i32 s57, s24, 4
    v_add_u32 v4, s57, v4
    v_mul_u32_u24 v4, 2048, v4
    v_and_b32 v5, 31, v1
    v_lshlrev_b32 v5, 4, v5
    v_add_u32 v4, v4, v5
    s_mul_i32 s57, s27, 512
    s_add_u32 s57, s57, 20480
    v_add_u32 v18, s57, v4
    v_add_u32 v19, 36864, v18
    v_add_u32 v20, 73728, v18
    v_add_u32 v21, 110592, v18
    v_mov_b32 v72, 0
    v_mov_b32 v73, 0
    v_mov_b32 v74, 0
    v_mov_b32 v75, 0
    v_mov_b32 v76, 0
    v_mov_b32 v77, 0
    v_mov_b32 v78, 0
    v_mov_b32 v79, 0
    v_mov_b32 v80, 0
    v_mov_b32 v81, 0
    v_mov_b32 v82, 0
    v_mov_b32 v83, 0
    v_mov_b32 v84, 0
    v_mov_b32 v85, 0
    v_mov_b32 v86, 0
    v_mov_b32 v87, 0
    v_mov_b32 v88, 0
    v_mov_b32 v89, 0
    v_mov_b32 v90, 0
    v_mov_b32 v91, 0
    v_mov_b32 v92, 0
    v_mov_b32 v93, 0
    v_mov_b32 v94, 0
    v_mov_b32 v95, 0
    v_mov_b32 v96, 0
    v_mov_b32 v97, 0
    v_mov_b32 v98, 0
    v_mov_b32 v99, 0
    v_mov_b32 v100, 0
    v_mov_b32 v101, 0
    v_mov_b32 v102, 0
    v_mov_b32 v103, 0
    v_mov_b32 v104, 0
    v_mov_b32 v105, 0
    v_mov_b32 v106, 0
    v_mov_b32 v107, 0
    v_mov_b32 v108, 0
    v_mov_b32 v109, 0
    v_mov_b32 v110, 0
    v_mov_b32 v111, 0
    v_mov_b32 v112, 0
    v_mov_b32 v113, 0
    v_mov_b32 v114, 0
    v_mov_b32 v115, 0
    v_mov_b32 v116, 0
    v_mov_b32 v117, 0
    v_mov_b32 v118, 0
    v_mov_b32 v119, 0
    v_mov_b32 v120, 0
    v_mov_b32 v121, 0
    v_mov_b32 v122, 0
    v_mov_b32 v123, 0
    v_mov_b32 v124, 0
    v_mov_b32 v125, 0
    v_mov_b32 v126, 0
    v_mov_b32 v127, 0
    v_mov_b32 v128, 0
    v_mov_b32 v129, 0
    v_mov_b32 v130, 0
    v_mov_b32 v131, 0
    v_mov_b32 v132, 0
    v_mov_b32 v133, 0
    v_mov_b32 v134, 0
    v_mov_b32 v135, 0
    v_mov_b32 v136, 0
    v_mov_b32 v137, 0
    v_mov_b32 v138, 0
    v_mov_b32 v139, 0
    v_mov_b32 v140, 0
    v_mov_b32 v141, 0
    v_mov_b32 v142, 0
    v_mov_b32 v143, 0
    v_mov_b32 v144, 0
    v_mov_b32 v145, 0
    v_mov_b32 v146, 0
    v_mov_b32 v147, 0
    v_mov_b32 v148, 0
    v_mov_b32 v149, 0
    v_mov_b32 v150, 0
    v_mov_b32 v151, 0
    s_waitcnt vmcnt(6)
    s_barrier
    ds_read_b128 v[44:47], v18 offset:0
    ds_read_b64_tr_b16 v[24:25], v14 offset:0
    ds_read_b64_tr_b16 v[26:27], v14 offset:1280
    ds_read_b64_tr_b16 v[28:29], v14 offset:64
    ds_read_b64_tr_b16 v[30:31], v14 offset:1344
    ds_read_b64_tr_b16 v[32:33], v14 offset:128
    ds_read_b64_tr_b16 v[34:35], v14 offset:1408
    ds_read_b64_tr_b16 v[36:37], v14 offset:192
    ds_read_b64_tr_b16 v[38:39], v14 offset:1472
    ds_read_b64_tr_b16 v[40:41], v14 offset:256
    ds_read_b64_tr_b16 v[42:43], v14 offset:1536
    s_waitcnt lgkmcnt(0)
    v_mfma_f32_32x32x16_bf16 v[72:87], v[24:27], v[44:47], v[72:87]
    ds_read_b128 v[68:71], v18 offset:4096
    ds_read_b64_tr_b16 v[48:49], v14 offset:5120
    ds_read_b64_tr_b16 v[50:51], v14 offset:6400
    v_mfma_f32_32x32x16_bf16 v[88:103], v[28:31], v[44:47], v[88:103]
    ds_read_b64_tr_b16 v[52:53], v14 offset:5184
    ds_read_b64_tr_b16 v[54:55], v14 offset:6464
    ds_read_b64_tr_b16 v[56:57], v14 offset:5248
    v_mfma_f32_32x32x16_bf16 v[104:119], v[32:35], v[44:47], v[104:119]
    ds_read_b64_tr_b16 v[58:59], v14 offset:6528
    ds_read_b64_tr_b16 v[60:61], v14 offset:5312
    ds_read_b64_tr_b16 v[62:63], v14 offset:6592
    v_mfma_f32_32x32x16_bf16 v[120:135], v[36:39], v[44:47], v[120:135]
    ds_read_b64_tr_b16 v[64:65], v14 offset:5376
    ds_read_b64_tr_b16 v[66:67], v14 offset:6656
    v_mfma_f32_32x32x16_bf16 v[136:151], v[40:43], v[44:47], v[136:151]
    s_waitcnt vmcnt(4) lgkmcnt(0)
    s_barrier
    v_mfma_f32_32x32x16_bf16 v[72:87], v[48:51], v[68:71], v[72:87]
    ds_read_b128 v[44:47], v19 offset:0
    ds_read_b64_tr_b16 v[24:25], v15 offset:0
    ds_read_b64_tr_b16 v[26:27], v15 offset:1280
    v_mfma_f32_32x32x16_bf16 v[88:103], v[52:55], v[68:71], v[88:103]
    ds_read_b64_tr_b16 v[28:29], v15 offset:64
    ds_read_b64_tr_b16 v[30:31], v15 offset:1344
    ds_read_b64_tr_b16 v[32:33], v15 offset:128
    v_mfma_f32_32x32x16_bf16 v[104:119], v[56:59], v[68:71], v[104:119]
    ds_read_b64_tr_b16 v[34:35], v15 offset:1408
    ds_read_b64_tr_b16 v[36:37], v15 offset:192
    ds_read_b64_tr_b16 v[38:39], v15 offset:1472
    v_mfma_f32_32x32x16_bf16 v[120:135], v[60:63], v[68:71], v[120:135]
    ds_read_b64_tr_b16 v[40:41], v15 offset:256
    ds_read_b64_tr_b16 v[42:43], v15 offset:1536
    v_mfma_f32_32x32x16_bf16 v[136:151], v[64:67], v[68:71], v[136:151]
    s_add_u32 m0, s53, 0
    s_add_u32 s54, s51, 327680
    buffer_load_dwordx4 v8, s[28:31], s54 offen sc1 lds
    s_add_u32 m0, s53, 8192
    s_add_u32 s54, s51, 327680
    buffer_load_dwordx4 v9, s[28:31], s54 offen sc1 lds
    s_cmp_lt_u32 s25, 4
    s_cbranch_scc0 oproj_kernel_d9a
    s_add_u32 m0, s53, 16384
    s_add_u32 s54, s51, 327680
    buffer_load_dwordx4 v10, s[28:31], s54 offen sc1 lds
    s_branch oproj_kernel_d9b
oproj_kernel_d9a:
    s_add_u32 m0, s53, 16384
    s_add_u32 s54, s52, 65536
    buffer_load_dwordx4 v13, s[32:35], s54 offen sc1 lds
oproj_kernel_d9b:
    s_add_u32 m0, s53, 24576
    s_add_u32 s54, s52, 65536
    buffer_load_dwordx4 v11, s[32:35], s54 offen sc1 lds
    s_cmp_lt_u32 s25, 4
    s_cbranch_scc0 oproj_kernel_d10b
    s_add_u32 m0, s53, 32768
    s_add_u32 s54, s52, 65536
    buffer_load_dwordx4 v12, s[32:35], s54 offen sc1 lds
oproj_kernel_d10b:
    s_waitcnt lgkmcnt(0)
    v_mfma_f32_32x32x16_bf16 v[72:87], v[24:27], v[44:47], v[72:87]
    ds_read_b128 v[68:71], v19 offset:4096
    ds_read_b64_tr_b16 v[48:49], v15 offset:5120
    ds_read_b64_tr_b16 v[50:51], v15 offset:6400
    v_mfma_f32_32x32x16_bf16 v[88:103], v[28:31], v[44:47], v[88:103]
    ds_read_b64_tr_b16 v[52:53], v15 offset:5184
    ds_read_b64_tr_b16 v[54:55], v15 offset:6464
    ds_read_b64_tr_b16 v[56:57], v15 offset:5248
    v_mfma_f32_32x32x16_bf16 v[104:119], v[32:35], v[44:47], v[104:119]
    ds_read_b64_tr_b16 v[58:59], v15 offset:6528
    ds_read_b64_tr_b16 v[60:61], v15 offset:5312
    ds_read_b64_tr_b16 v[62:63], v15 offset:6592
    v_mfma_f32_32x32x16_bf16 v[120:135], v[36:39], v[44:47], v[120:135]
    ds_read_b64_tr_b16 v[64:65], v15 offset:5376
    ds_read_b64_tr_b16 v[66:67], v15 offset:6656
    v_mfma_f32_32x32x16_bf16 v[136:151], v[40:43], v[44:47], v[136:151]
    s_waitcnt vmcnt(6) lgkmcnt(0)
    s_barrier
    v_mfma_f32_32x32x16_bf16 v[72:87], v[48:51], v[68:71], v[72:87]
    ds_read_b128 v[44:47], v20 offset:0
    ds_read_b64_tr_b16 v[24:25], v16 offset:0
    ds_read_b64_tr_b16 v[26:27], v16 offset:1280
    v_mfma_f32_32x32x16_bf16 v[88:103], v[52:55], v[68:71], v[88:103]
    ds_read_b64_tr_b16 v[28:29], v16 offset:64
    ds_read_b64_tr_b16 v[30:31], v16 offset:1344
    ds_read_b64_tr_b16 v[32:33], v16 offset:128
    v_mfma_f32_32x32x16_bf16 v[104:119], v[56:59], v[68:71], v[104:119]
    ds_read_b64_tr_b16 v[34:35], v16 offset:1408
    ds_read_b64_tr_b16 v[36:37], v16 offset:192
    ds_read_b64_tr_b16 v[38:39], v16 offset:1472
    v_mfma_f32_32x32x16_bf16 v[120:135], v[60:63], v[68:71], v[120:135]
    ds_read_b64_tr_b16 v[40:41], v16 offset:256
    ds_read_b64_tr_b16 v[42:43], v16 offset:1536
    v_mfma_f32_32x32x16_bf16 v[136:151], v[64:67], v[68:71], v[136:151]
    s_add_u32 m0, s53, 36864
    s_add_u32 s54, s51, 409600
    buffer_load_dwordx4 v8, s[28:31], s54 offen sc1 lds
    s_add_u32 m0, s53, 45056
    s_add_u32 s54, s51, 409600
    buffer_load_dwordx4 v9, s[28:31], s54 offen sc1 lds
    s_cmp_lt_u32 s25, 4
    s_cbranch_scc0 oproj_kernel_d11a
    s_add_u32 m0, s53, 53248
    s_add_u32 s54, s51, 409600
    buffer_load_dwordx4 v10, s[28:31], s54 offen sc1 lds
    s_branch oproj_kernel_d11b
oproj_kernel_d11a:
    s_add_u32 m0, s53, 53248
    s_add_u32 s54, s52, 81920
    buffer_load_dwordx4 v13, s[32:35], s54 offen sc1 lds
oproj_kernel_d11b:
    s_add_u32 m0, s53, 61440
    s_add_u32 s54, s52, 81920
    buffer_load_dwordx4 v11, s[32:35], s54 offen sc1 lds
    s_cmp_lt_u32 s25, 4
    s_cbranch_scc0 oproj_kernel_d12b
    s_add_u32 m0, s53, 69632
    s_add_u32 s54, s52, 81920
    buffer_load_dwordx4 v12, s[32:35], s54 offen sc1 lds
oproj_kernel_d12b:
    s_waitcnt lgkmcnt(0)
    v_mfma_f32_32x32x16_bf16 v[72:87], v[24:27], v[44:47], v[72:87]
    ds_read_b128 v[68:71], v20 offset:4096
    ds_read_b64_tr_b16 v[48:49], v16 offset:5120
    ds_read_b64_tr_b16 v[50:51], v16 offset:6400
    v_mfma_f32_32x32x16_bf16 v[88:103], v[28:31], v[44:47], v[88:103]
    ds_read_b64_tr_b16 v[52:53], v16 offset:5184
    ds_read_b64_tr_b16 v[54:55], v16 offset:6464
    ds_read_b64_tr_b16 v[56:57], v16 offset:5248
    v_mfma_f32_32x32x16_bf16 v[104:119], v[32:35], v[44:47], v[104:119]
    ds_read_b64_tr_b16 v[58:59], v16 offset:6528
    ds_read_b64_tr_b16 v[60:61], v16 offset:5312
    ds_read_b64_tr_b16 v[62:63], v16 offset:6592
    v_mfma_f32_32x32x16_bf16 v[120:135], v[36:39], v[44:47], v[120:135]
    ds_read_b64_tr_b16 v[64:65], v16 offset:5376
    ds_read_b64_tr_b16 v[66:67], v16 offset:6656
    v_mfma_f32_32x32x16_bf16 v[136:151], v[40:43], v[44:47], v[136:151]
    s_waitcnt vmcnt(8) lgkmcnt(0)
    s_barrier
    v_mfma_f32_32x32x16_bf16 v[72:87], v[48:51], v[68:71], v[72:87]
    ds_read_b128 v[44:47], v21 offset:0
    ds_read_b64_tr_b16 v[24:25], v17 offset:0
    ds_read_b64_tr_b16 v[26:27], v17 offset:1280
    v_mfma_f32_32x32x16_bf16 v[88:103], v[52:55], v[68:71], v[88:103]
    ds_read_b64_tr_b16 v[28:29], v17 offset:64
    ds_read_b64_tr_b16 v[30:31], v17 offset:1344
    ds_read_b64_tr_b16 v[32:33], v17 offset:128
    v_mfma_f32_32x32x16_bf16 v[104:119], v[56:59], v[68:71], v[104:119]
    ds_read_b64_tr_b16 v[34:35], v17 offset:1408
    ds_read_b64_tr_b16 v[36:37], v17 offset:192
    ds_read_b64_tr_b16 v[38:39], v17 offset:1472
    v_mfma_f32_32x32x16_bf16 v[120:135], v[60:63], v[68:71], v[120:135]
    ds_read_b64_tr_b16 v[40:41], v17 offset:256
    ds_read_b64_tr_b16 v[42:43], v17 offset:1536
    v_mfma_f32_32x32x16_bf16 v[136:151], v[64:67], v[68:71], v[136:151]
    s_add_u32 m0, s53, 73728
    s_add_u32 s54, s51, 491520
    buffer_load_dwordx4 v8, s[28:31], s54 offen sc1 lds
    s_add_u32 m0, s53, 81920
    s_add_u32 s54, s51, 491520
    buffer_load_dwordx4 v9, s[28:31], s54 offen sc1 lds
    s_cmp_lt_u32 s25, 4
    s_cbranch_scc0 oproj_kernel_d13a
    s_add_u32 m0, s53, 90112
    s_add_u32 s54, s51, 491520
    buffer_load_dwordx4 v10, s[28:31], s54 offen sc1 lds
    s_branch oproj_kernel_d13b
oproj_kernel_d13a:
    s_add_u32 m0, s53, 90112
    s_add_u32 s54, s52, 98304
    buffer_load_dwordx4 v13, s[32:35], s54 offen sc1 lds
oproj_kernel_d13b:
    s_add_u32 m0, s53, 98304
    s_add_u32 s54, s52, 98304
    buffer_load_dwordx4 v11, s[32:35], s54 offen sc1 lds
    s_cmp_lt_u32 s25, 4
    s_cbranch_scc0 oproj_kernel_d14b
    s_add_u32 m0, s53, 106496
    s_add_u32 s54, s52, 98304
    buffer_load_dwordx4 v12, s[32:35], s54 offen sc1 lds
oproj_kernel_d14b:
    s_waitcnt lgkmcnt(0)
    v_mfma_f32_32x32x16_bf16 v[72:87], v[24:27], v[44:47], v[72:87]
    ds_read_b128 v[68:71], v21 offset:4096
    ds_read_b64_tr_b16 v[48:49], v17 offset:5120
    ds_read_b64_tr_b16 v[50:51], v17 offset:6400
    v_mfma_f32_32x32x16_bf16 v[88:103], v[28:31], v[44:47], v[88:103]
    ds_read_b64_tr_b16 v[52:53], v17 offset:5184
    ds_read_b64_tr_b16 v[54:55], v17 offset:6464
    ds_read_b64_tr_b16 v[56:57], v17 offset:5248
    v_mfma_f32_32x32x16_bf16 v[104:119], v[32:35], v[44:47], v[104:119]
    ds_read_b64_tr_b16 v[58:59], v17 offset:6528
    ds_read_b64_tr_b16 v[60:61], v17 offset:5312
    ds_read_b64_tr_b16 v[62:63], v17 offset:6592
    v_mfma_f32_32x32x16_bf16 v[120:135], v[36:39], v[44:47], v[120:135]
    ds_read_b64_tr_b16 v[64:65], v17 offset:5376
    ds_read_b64_tr_b16 v[66:67], v17 offset:6656
    v_mfma_f32_32x32x16_bf16 v[136:151], v[40:43], v[44:47], v[136:151]
    s_waitcnt vmcnt(8) lgkmcnt(0)
    s_barrier
    v_mfma_f32_32x32x16_bf16 v[72:87], v[48:51], v[68:71], v[72:87]
    ds_read_b128 v[44:47], v18 offset:0
    ds_read_b64_tr_b16 v[24:25], v14 offset:0
    ds_read_b64_tr_b16 v[26:27], v14 offset:1280
    v_mfma_f32_32x32x16_bf16 v[88:103], v[52:55], v[68:71], v[88:103]
    ds_read_b64_tr_b16 v[28:29], v14 offset:64
    ds_read_b64_tr_b16 v[30:31], v14 offset:1344
    ds_read_b64_tr_b16 v[32:33], v14 offset:128
    v_mfma_f32_32x32x16_bf16 v[104:119], v[56:59], v[68:71], v[104:119]
    ds_read_b64_tr_b16 v[34:35], v14 offset:1408
    ds_read_b64_tr_b16 v[36:37], v14 offset:192
    ds_read_b64_tr_b16 v[38:39], v14 offset:1472
    v_mfma_f32_32x32x16_bf16 v[120:135], v[60:63], v[68:71], v[120:135]
    ds_read_b64_tr_b16 v[40:41], v14 offset:256
    ds_read_b64_tr_b16 v[42:43], v14 offset:1536
    v_mfma_f32_32x32x16_bf16 v[136:151], v[64:67], v[68:71], v[136:151]
    s_add_u32 m0, s53, 110592
    s_add_u32 s54, s51, 573440
    buffer_load_dwordx4 v8, s[28:31], s54 offen sc1 lds
    s_add_u32 m0, s53, 118784
    s_add_u32 s54, s51, 573440
    buffer_load_dwordx4 v9, s[28:31], s54 offen sc1 lds
    s_cmp_lt_u32 s25, 4
    s_cbranch_scc0 oproj_kernel_d15a
    s_add_u32 m0, s53, 126976
    s_add_u32 s54, s51, 573440
    buffer_load_dwordx4 v10, s[28:31], s54 offen sc1 lds
    s_branch oproj_kernel_d15b
oproj_kernel_d15a:
    s_add_u32 m0, s53, 126976
    s_add_u32 s54, s52, 114688
    buffer_load_dwordx4 v13, s[32:35], s54 offen sc1 lds
oproj_kernel_d15b:
    s_add_u32 m0, s53, 135168
    s_add_u32 s54, s52, 114688
    buffer_load_dwordx4 v11, s[32:35], s54 offen sc1 lds
    s_cmp_lt_u32 s25, 4
    s_cbranch_scc0 oproj_kernel_d16b
    s_add_u32 m0, s53, 143360
    s_add_u32 s54, s52, 114688
    buffer_load_dwordx4 v12, s[32:35], s54 offen sc1 lds
oproj_kernel_d16b:
    s_waitcnt lgkmcnt(0)
    v_mfma_f32_32x32x16_bf16 v[72:87], v[24:27], v[44:47], v[72:87]
    ds_read_b128 v[68:71], v18 offset:4096
    ds_read_b64_tr_b16 v[48:49], v14 offset:5120
    ds_read_b64_tr_b16 v[50:51], v14 offset:6400
    v_mfma_f32_32x32x16_bf16 v[88:103], v[28:31], v[44:47], v[88:103]
    ds_read_b64_tr_b16 v[52:53], v14 offset:5184
    ds_read_b64_tr_b16 v[54:55], v14 offset:6464
    ds_read_b64_tr_b16 v[56:57], v14 offset:5248
    v_mfma_f32_32x32x16_bf16 v[104:119], v[32:35], v[44:47], v[104:119]
    ds_read_b64_tr_b16 v[58:59], v14 offset:6528
    ds_read_b64_tr_b16 v[60:61], v14 offset:5312
    ds_read_b64_tr_b16 v[62:63], v14 offset:6592
    v_mfma_f32_32x32x16_bf16 v[120:135], v[36:39], v[44:47], v[120:135]
    ds_read_b64_tr_b16 v[64:65], v14 offset:5376
    ds_read_b64_tr_b16 v[66:67], v14 offset:6656
    v_mfma_f32_32x32x16_bf16 v[136:151], v[40:43], v[44:47], v[136:151]
    s_waitcnt vmcnt(8) lgkmcnt(0)
    s_barrier
    v_mfma_f32_32x32x16_bf16 v[72:87], v[48:51], v[68:71], v[72:87]
    ds_read_b128 v[44:47], v19 offset:0
    ds_read_b64_tr_b16 v[24:25], v15 offset:0
    ds_read_b64_tr_b16 v[26:27], v15 offset:1280
    v_mfma_f32_32x32x16_bf16 v[88:103], v[52:55], v[68:71], v[88:103]
    ds_read_b64_tr_b16 v[28:29], v15 offset:64
    ds_read_b64_tr_b16 v[30:31], v15 offset:1344
    ds_read_b64_tr_b16 v[32:33], v15 offset:128
    v_mfma_f32_32x32x16_bf16 v[104:119], v[56:59], v[68:71], v[104:119]
    ds_read_b64_tr_b16 v[34:35], v15 offset:1408
    ds_read_b64_tr_b16 v[36:37], v15 offset:192
    ds_read_b64_tr_b16 v[38:39], v15 offset:1472
    v_mfma_f32_32x32x16_bf16 v[120:135], v[60:63], v[68:71], v[120:135]
    ds_read_b64_tr_b16 v[40:41], v15 offset:256
    ds_read_b64_tr_b16 v[42:43], v15 offset:1536
    v_mfma_f32_32x32x16_bf16 v[136:151], v[64:67], v[68:71], v[136:151]
    s_add_u32 m0, s53, 0
    s_add_u32 s54, s51, 655360
    buffer_load_dwordx4 v8, s[28:31], s54 offen sc1 lds
    s_add_u32 m0, s53, 8192
    s_add_u32 s54, s51, 655360
    buffer_load_dwordx4 v9, s[28:31], s54 offen sc1 lds
    s_cmp_lt_u32 s25, 4
    s_cbranch_scc0 oproj_kernel_d17a
    s_add_u32 m0, s53, 16384
    s_add_u32 s54, s51, 655360
    buffer_load_dwordx4 v10, s[28:31], s54 offen sc1 lds
    s_branch oproj_kernel_d17b
oproj_kernel_d17a:
    s_add_u32 m0, s53, 16384
    s_add_u32 s54, s52, 131072
    buffer_load_dwordx4 v13, s[32:35], s54 offen sc1 lds
oproj_kernel_d17b:
    s_add_u32 m0, s53, 24576
    s_add_u32 s54, s52, 131072
    buffer_load_dwordx4 v11, s[32:35], s54 offen sc1 lds
    s_cmp_lt_u32 s25, 4
    s_cbranch_scc0 oproj_kernel_d18b
    s_add_u32 m0, s53, 32768
    s_add_u32 s54, s52, 131072
    buffer_load_dwordx4 v12, s[32:35], s54 offen sc1 lds
oproj_kernel_d18b:
    s_waitcnt lgkmcnt(0)
    v_mfma_f32_32x32x16_bf16 v[72:87], v[24:27], v[44:47], v[72:87]
    ds_read_b128 v[68:71], v19 offset:4096
    ds_read_b64_tr_b16 v[48:49], v15 offset:5120
    ds_read_b64_tr_b16 v[50:51], v15 offset:6400
    v_mfma_f32_32x32x16_bf16 v[88:103], v[28:31], v[44:47], v[88:103]
    ds_read_b64_tr_b16 v[52:53], v15 offset:5184
    ds_read_b64_tr_b16 v[54:55], v15 offset:6464
    ds_read_b64_tr_b16 v[56:57], v15 offset:5248
    v_mfma_f32_32x32x16_bf16 v[104:119], v[32:35], v[44:47], v[104:119]
    ds_read_b64_tr_b16 v[58:59], v15 offset:6528
    ds_read_b64_tr_b16 v[60:61], v15 offset:5312
    ds_read_b64_tr_b16 v[62:63], v15 offset:6592
    v_mfma_f32_32x32x16_bf16 v[120:135], v[36:39], v[44:47], v[120:135]
    ds_read_b64_tr_b16 v[64:65], v15 offset:5376
    ds_read_b64_tr_b16 v[66:67], v15 offset:6656
    v_mfma_f32_32x32x16_bf16 v[136:151], v[40:43], v[44:47], v[136:151]
    s_waitcnt vmcnt(8) lgkmcnt(0)
    s_barrier
    v_mfma_f32_32x32x16_bf16 v[72:87], v[48:51], v[68:71], v[72:87]
    ds_read_b128 v[44:47], v20 offset:0
    ds_read_b64_tr_b16 v[24:25], v16 offset:0
    ds_read_b64_tr_b16 v[26:27], v16 offset:1280
    v_mfma_f32_32x32x16_bf16 v[88:103], v[52:55], v[68:71], v[88:103]
    ds_read_b64_tr_b16 v[28:29], v16 offset:64
    ds_read_b64_tr_b16 v[30:31], v16 offset:1344
    ds_read_b64_tr_b16 v[32:33], v16 offset:128
    v_mfma_f32_32x32x16_bf16 v[104:119], v[56:59], v[68:71], v[104:119]
    ds_read_b64_tr_b16 v[34:35], v16 offset:1408
    ds_read_b64_tr_b16 v[36:37], v16 offset:192
    ds_read_b64_tr_b16 v[38:39], v16 offset:1472
    v_mfma_f32_32x32x16_bf16 v[120:135], v[60:63], v[68:71], v[120:135]
    ds_read_b64_tr_b16 v[40:41], v16 offset:256
    ds_read_b64_tr_b16 v[42:43], v16 offset:1536
    v_mfma_f32_32x32x16_bf16 v[136:151], v[64:67], v[68:71], v[136:151]
    s_add_u32 m0, s53, 36864
    s_add_u32 s54, s51, 737280
    buffer_load_dwordx4 v8, s[28:31], s54 offen sc1 lds
    s_add_u32 m0, s53, 45056
    s_add_u32 s54, s51, 737280
    buffer_load_dwordx4 v9, s[28:31], s54 offen sc1 lds
    s_cmp_lt_u32 s25, 4
    s_cbranch_scc0 oproj_kernel_d19a
    s_add_u32 m0, s53, 53248
    s_add_u32 s54, s51, 737280
    buffer_load_dwordx4 v10, s[28:31], s54 offen sc1 lds
    s_branch oproj_kernel_d19b
oproj_kernel_d19a:
    s_add_u32 m0, s53, 53248
    s_add_u32 s54, s52, 147456
    buffer_load_dwordx4 v13, s[32:35], s54 offen sc1 lds
oproj_kernel_d19b:
    s_add_u32 m0, s53, 61440
    s_add_u32 s54, s52, 147456
    buffer_load_dwordx4 v11, s[32:35], s54 offen sc1 lds
    s_cmp_lt_u32 s25, 4
    s_cbranch_scc0 oproj_kernel_d20b
    s_add_u32 m0, s53, 69632
    s_add_u32 s54, s52, 147456
    buffer_load_dwordx4 v12, s[32:35], s54 offen sc1 lds
oproj_kernel_d20b:
    s_waitcnt lgkmcnt(0)
    v_mfma_f32_32x32x16_bf16 v[72:87], v[24:27], v[44:47], v[72:87]
    ds_read_b128 v[68:71], v20 offset:4096
    ds_read_b64_tr_b16 v[48:49], v16 offset:5120
    ds_read_b64_tr_b16 v[50:51], v16 offset:6400
    v_mfma_f32_32x32x16_bf16 v[88:103], v[28:31], v[44:47], v[88:103]
    ds_read_b64_tr_b16 v[52:53], v16 offset:5184
    ds_read_b64_tr_b16 v[54:55], v16 offset:6464
    ds_read_b64_tr_b16 v[56:57], v16 offset:5248
    v_mfma_f32_32x32x16_bf16 v[104:119], v[32:35], v[44:47], v[104:119]
    ds_read_b64_tr_b16 v[58:59], v16 offset:6528
    ds_read_b64_tr_b16 v[60:61], v16 offset:5312
    ds_read_b64_tr_b16 v[62:63], v16 offset:6592
    v_mfma_f32_32x32x16_bf16 v[120:135], v[36:39], v[44:47], v[120:135]
    ds_read_b64_tr_b16 v[64:65], v16 offset:5376
    ds_read_b64_tr_b16 v[66:67], v16 offset:6656
    v_mfma_f32_32x32x16_bf16 v[136:151], v[40:43], v[44:47], v[136:151]
    s_waitcnt vmcnt(8) lgkmcnt(0)
    s_barrier
    v_mfma_f32_32x32x16_bf16 v[72:87], v[48:51], v[68:71], v[72:87]
    ds_read_b128 v[44:47], v21 offset:0
    ds_read_b64_tr_b16 v[24:25], v17 offset:0
    ds_read_b64_tr_b16 v[26:27], v17 offset:1280
    v_mfma_f32_32x32x16_bf16 v[88:103], v[52:55], v[68:71], v[88:103]
    ds_read_b64_tr_b16 v[28:29], v17 offset:64
    ds_read_b64_tr_b16 v[30:31], v17 offset:1344
    ds_read_b64_tr_b16 v[32:33], v17 offset:128
    v_mfma_f32_32x32x16_bf16 v[104:119], v[56:59], v[68:71], v[104:119]
    ds_read_b64_tr_b16 v[34:35], v17 offset:1408
    ds_read_b64_tr_b16 v[36:37], v17 offset:192
    ds_read_b64_tr_b16 v[38:39], v17 offset:1472
    v_mfma_f32_32x32x16_bf16 v[120:135], v[60:63], v[68:71], v[120:135]
    ds_read_b64_tr_b16 v[40:41], v17 offset:256
    ds_read_b64_tr_b16 v[42:43], v17 offset:1536
    v_mfma_f32_32x32x16_bf16 v[136:151], v[64:67], v[68:71], v[136:151]
    s_add_u32 m0, s53, 73728
    s_add_u32 s54, s51, 819200
    buffer_load_dwordx4 v8, s[28:31], s54 offen sc1 lds
    s_add_u32 m0, s53, 81920
    s_add_u32 s54, s51, 819200
    buffer_load_dwordx4 v9, s[28:31], s54 offen sc1 lds
    s_cmp_lt_u32 s25, 4
    s_cbranch_scc0 oproj_kernel_d21a
    s_add_u32 m0, s53, 90112
    s_add_u32 s54, s51, 819200
    buffer_load_dwordx4 v10, s[28:31], s54 offen sc1 lds
    s_branch oproj_kernel_d21b
oproj_kernel_d21a:
    s_add_u32 m0, s53, 90112
    s_add_u32 s54, s52, 163840
    buffer_load_dwordx4 v13, s[32:35], s54 offen sc1 lds
oproj_kernel_d21b:
    s_add_u32 m0, s53, 98304
    s_add_u32 s54, s52, 163840
    buffer_load_dwordx4 v11, s[32:35], s54 offen sc1 lds
    s_cmp_lt_u32 s25, 4
    s_cbranch_scc0 oproj_kernel_d22b
    s_add_u32 m0, s53, 106496
    s_add_u32 s54, s52, 163840
    buffer_load_dwordx4 v12, s[32:35], s54 offen sc1 lds
oproj_kernel_d22b:
    s_waitcnt lgkmcnt(0)
    v_mfma_f32_32x32x16_bf16 v[72:87], v[24:27], v[44:47], v[72:87]
    ds_read_b128 v[68:71], v21 offset:4096
    ds_read_b64_tr_b16 v[48:49], v17 offset:5120
    ds_read_b64_tr_b16 v[50:51], v17 offset:6400
    v_mfma_f32_32x32x16_bf16 v[88:103], v[28:31], v[44:47], v[88:103]
    ds_read_b64_tr_b16 v[52:53], v17 offset:5184
    ds_read_b64_tr_b16 v[54:55], v17 offset:6464
    ds_read_b64_tr_b16 v[56:57], v17 offset:5248
    v_mfma_f32_32x32x16_bf16 v[104:119], v[32:35], v[44:47], v[104:119]
    ds_read_b64_tr_b16 v[58:59], v17 offset:6528
    ds_read_b64_tr_b16 v[60:61], v17 offset:5312
    ds_read_b64_tr_b16 v[62:63], v17 offset:6592
    v_mfma_f32_32x32x16_bf16 v[120:135], v[36:39], v[44:47], v[120:135]
    ds_read_b64_tr_b16 v[64:65], v17 offset:5376
    ds_read_b64_tr_b16 v[66:67], v17 offset:6656
    v_mfma_f32_32x32x16_bf16 v[136:151], v[40:43], v[44:47], v[136:151]
    s_waitcnt vmcnt(8) lgkmcnt(0)
    s_barrier
    v_mfma_f32_32x32x16_bf16 v[72:87], v[48:51], v[68:71], v[72:87]
    ds_read_b128 v[44:47], v18 offset:0
    ds_read_b64_tr_b16 v[24:25], v14 offset:0
    ds_read_b64_tr_b16 v[26:27], v14 offset:1280
    v_mfma_f32_32x32x16_bf16 v[88:103], v[52:55], v[68:71], v[88:103]
    ds_read_b64_tr_b16 v[28:29], v14 offset:64
    ds_read_b64_tr_b16 v[30:31], v14 offset:1344
    ds_read_b64_tr_b16 v[32:33], v14 offset:128
    v_mfma_f32_32x32x16_bf16 v[104:119], v[56:59], v[68:71], v[104:119]
    ds_read_b64_tr_b16 v[34:35], v14 offset:1408
    ds_read_b64_tr_b16 v[36:37], v14 offset:192
    ds_read_b64_tr_b16 v[38:39], v14 offset:1472
    v_mfma_f32_32x32x16_bf16 v[120:135], v[60:63], v[68:71], v[120:135]
    ds_read_b64_tr_b16 v[40:41], v14 offset:256
    ds_read_b64_tr_b16 v[42:43], v14 offset:1536
    v_mfma_f32_32x32x16_bf16 v[136:151], v[64:67], v[68:71], v[136:151]
    s_add_u32 m0, s53, 110592
    s_add_u32 s54, s51, 901120
    buffer_load_dwordx4 v8, s[28:31], s54 offen sc1 lds
    s_add_u32 m0, s53, 118784
    s_add_u32 s54, s51, 901120
    buffer_load_dwordx4 v9, s[28:31], s54 offen sc1 lds
    s_cmp_lt_u32 s25, 4
    s_cbranch_scc0 oproj_kernel_d23a
    s_add_u32 m0, s53, 126976
    s_add_u32 s54, s51, 901120
    buffer_load_dwordx4 v10, s[28:31], s54 offen sc1 lds
    s_branch oproj_kernel_d23b
oproj_kernel_d23a:
    s_add_u32 m0, s53, 126976
    s_add_u32 s54, s52, 180224
    buffer_load_dwordx4 v13, s[32:35], s54 offen sc1 lds
oproj_kernel_d23b:
    s_add_u32 m0, s53, 135168
    s_add_u32 s54, s52, 180224
    buffer_load_dwordx4 v11, s[32:35], s54 offen sc1 lds
    s_cmp_lt_u32 s25, 4
    s_cbranch_scc0 oproj_kernel_d24b
    s_add_u32 m0, s53, 143360
    s_add_u32 s54, s52, 180224
    buffer_load_dwordx4 v12, s[32:35], s54 offen sc1 lds
oproj_kernel_d24b:
    s_waitcnt lgkmcnt(0)
    v_mfma_f32_32x32x16_bf16 v[72:87], v[24:27], v[44:47], v[72:87]
    ds_read_b128 v[68:71], v18 offset:4096
    ds_read_b64_tr_b16 v[48:49], v14 offset:5120
    ds_read_b64_tr_b16 v[50:51], v14 offset:6400
    v_mfma_f32_32x32x16_bf16 v[88:103], v[28:31], v[44:47], v[88:103]
    ds_read_b64_tr_b16 v[52:53], v14 offset:5184
    ds_read_b64_tr_b16 v[54:55], v14 offset:6464
    ds_read_b64_tr_b16 v[56:57], v14 offset:5248
    v_mfma_f32_32x32x16_bf16 v[104:119], v[32:35], v[44:47], v[104:119]
    ds_read_b64_tr_b16 v[58:59], v14 offset:6528
    ds_read_b64_tr_b16 v[60:61], v14 offset:5312
    ds_read_b64_tr_b16 v[62:63], v14 offset:6592
    v_mfma_f32_32x32x16_bf16 v[120:135], v[36:39], v[44:47], v[120:135]
    ds_read_b64_tr_b16 v[64:65], v14 offset:5376
    ds_read_b64_tr_b16 v[66:67], v14 offset:6656
    v_mfma_f32_32x32x16_bf16 v[136:151], v[40:43], v[44:47], v[136:151]
    s_waitcnt vmcnt(8) lgkmcnt(0)
    s_barrier
    v_mfma_f32_32x32x16_bf16 v[72:87], v[48:51], v[68:71], v[72:87]
    ds_read_b128 v[44:47], v19 offset:0
    ds_read_b64_tr_b16 v[24:25], v15 offset:0
    ds_read_b64_tr_b16 v[26:27], v15 offset:1280
    v_mfma_f32_32x32x16_bf16 v[88:103], v[52:55], v[68:71], v[88:103]
    ds_read_b64_tr_b16 v[28:29], v15 offset:64
    ds_read_b64_tr_b16 v[30:31], v15 offset:1344
    ds_read_b64_tr_b16 v[32:33], v15 offset:128
    v_mfma_f32_32x32x16_bf16 v[104:119], v[56:59], v[68:71], v[104:119]
    ds_read_b64_tr_b16 v[34:35], v15 offset:1408
    ds_read_b64_tr_b16 v[36:37], v15 offset:192
    ds_read_b64_tr_b16 v[38:39], v15 offset:1472
    v_mfma_f32_32x32x16_bf16 v[120:135], v[60:63], v[68:71], v[120:135]
    ds_read_b64_tr_b16 v[40:41], v15 offset:256
    ds_read_b64_tr_b16 v[42:43], v15 offset:1536
    v_mfma_f32_32x32x16_bf16 v[136:151], v[64:67], v[68:71], v[136:151]
    s_add_u32 m0, s53, 0
    s_add_u32 s54, s51, 983040
    buffer_load_dwordx4 v8, s[28:31], s54 offen sc1 lds
    s_add_u32 m0, s53, 8192
    s_add_u32 s54, s51, 983040
    buffer_load_dwordx4 v9, s[28:31], s54 offen sc1 lds
    s_cmp_lt_u32 s25, 4
    s_cbranch_scc0 oproj_kernel_d25a
    s_add_u32 m0, s53, 16384
    s_add_u32 s54, s51, 983040
    buffer_load_dwordx4 v10, s[28:31], s54 offen sc1 lds
    s_branch oproj_kernel_d25b
oproj_kernel_d25a:
    s_add_u32 m0, s53, 16384
    s_add_u32 s54, s52, 196608
    buffer_load_dwordx4 v13, s[32:35], s54 offen sc1 lds
oproj_kernel_d25b:
    s_add_u32 m0, s53, 24576
    s_add_u32 s54, s52, 196608
    buffer_load_dwordx4 v11, s[32:35], s54 offen sc1 lds
    s_cmp_lt_u32 s25, 4
    s_cbranch_scc0 oproj_kernel_d26b
    s_add_u32 m0, s53, 32768
    s_add_u32 s54, s52, 196608
    buffer_load_dwordx4 v12, s[32:35], s54 offen sc1 lds
oproj_kernel_d26b:
    s_waitcnt lgkmcnt(0)
    v_mfma_f32_32x32x16_bf16 v[72:87], v[24:27], v[44:47], v[72:87]
    ds_read_b128 v[68:71], v19 offset:4096
    ds_read_b64_tr_b16 v[48:49], v15 offset:5120
    ds_read_b64_tr_b16 v[50:51], v15 offset:6400
    v_mfma_f32_32x32x16_bf16 v[88:103], v[28:31], v[44:47], v[88:103]
    ds_read_b64_tr_b16 v[52:53], v15 offset:5184
    ds_read_b64_tr_b16 v[54:55], v15 offset:6464
    ds_read_b64_tr_b16 v[56:57], v15 offset:5248
    v_mfma_f32_32x32x16_bf16 v[104:119], v[32:35], v[44:47], v[104:119]
    ds_read_b64_tr_b16 v[58:59], v15 offset:6528
    ds_read_b64_tr_b16 v[60:61], v15 offset:5312
    ds_read_b64_tr_b16 v[62:63], v15 offset:6592
    v_mfma_f32_32x32x16_bf16 v[120:135], v[36:39], v[44:47], v[120:135]
    ds_read_b64_tr_b16 v[64:65], v15 offset:5376
    ds_read_b64_tr_b16 v[66:67], v15 offset:6656
    v_mfma_f32_32x32x16_bf16 v[136:151], v[40:43], v[44:47], v[136:151]
    s_waitcnt vmcnt(8) lgkmcnt(0)
    s_barrier
    v_mfma_f32_32x32x16_bf16 v[72:87], v[48:51], v[68:71], v[72:87]
    ds_read_b128 v[44:47], v20 offset:0
    ds_read_b64_tr_b16 v[24:25], v16 offset:0
    ds_read_b64_tr_b16 v[26:27], v16 offset:1280
    v_mfma_f32_32x32x16_bf16 v[88:103], v[52:55], v[68:71], v[88:103]
    ds_read_b64_tr_b16 v[28:29], v16 offset:64
    ds_read_b64_tr_b16 v[30:31], v16 offset:1344
    ds_read_b64_tr_b16 v[32:33], v16 offset:128
    v_mfma_f32_32x32x16_bf16 v[104:119], v[56:59], v[68:71], v[104:119]
    ds_read_b64_tr_b16 v[34:35], v16 offset:1408
    ds_read_b64_tr_b16 v[36:37], v16 offset:192
    ds_read_b64_tr_b16 v[38:39], v16 offset:1472
    v_mfma_f32_32x32x16_bf16 v[120:135], v[60:63], v[68:71], v[120:135]
    ds_read_b64_tr_b16 v[40:41], v16 offset:256
    ds_read_b64_tr_b16 v[42:43], v16 offset:1536
    v_mfma_f32_32x32x16_bf16 v[136:151], v[64:67], v[68:71], v[136:151]
    s_add_u32 m0, s53, 36864
    s_add_u32 s54, s51, 1064960
    buffer_load_dwordx4 v8, s[28:31], s54 offen sc1 lds
    s_add_u32 m0, s53, 45056
    s_add_u32 s54, s51, 1064960
    buffer_load_dwordx4 v9, s[28:31], s54 offen sc1 lds
    s_cmp_lt_u32 s25, 4
    s_cbranch_scc0 oproj_kernel_d27a
    s_add_u32 m0, s53, 53248
    s_add_u32 s54, s51, 1064960
    buffer_load_dwordx4 v10, s[28:31], s54 offen sc1 lds
    s_branch oproj_kernel_d27b
oproj_kernel_d27a:
    s_add_u32 m0, s53, 53248
    s_add_u32 s54, s52, 212992
    buffer_load_dwordx4 v13, s[32:35], s54 offen sc1 lds
oproj_kernel_d27b:
    s_add_u32 m0, s53, 61440
    s_add_u32 s54, s52, 212992
    buffer_load_dwordx4 v11, s[32:35], s54 offen sc1 lds
    s_cmp_lt_u32 s25, 4
    s_cbranch_scc0 oproj_kernel_d28b
    s_add_u32 m0, s53, 69632
    s_add_u32 s54, s52, 212992
    buffer_load_dwordx4 v12, s[32:35], s54 offen sc1 lds
oproj_kernel_d28b:
    s_waitcnt lgkmcnt(0)
    v_mfma_f32_32x32x16_bf16 v[72:87], v[24:27], v[44:47], v[72:87]
    ds_read_b128 v[68:71], v20 offset:4096
    ds_read_b64_tr_b16 v[48:49], v16 offset:5120
    ds_read_b64_tr_b16 v[50:51], v16 offset:6400
    v_mfma_f32_32x32x16_bf16 v[88:103], v[28:31], v[44:47], v[88:103]
    ds_read_b64_tr_b16 v[52:53], v16 offset:5184
    ds_read_b64_tr_b16 v[54:55], v16 offset:6464
    ds_read_b64_tr_b16 v[56:57], v16 offset:5248
    v_mfma_f32_32x32x16_bf16 v[104:119], v[32:35], v[44:47], v[104:119]
    ds_read_b64_tr_b16 v[58:59], v16 offset:6528
    ds_read_b64_tr_b16 v[60:61], v16 offset:5312
    ds_read_b64_tr_b16 v[62:63], v16 offset:6592
    v_mfma_f32_32x32x16_bf16 v[120:135], v[36:39], v[44:47], v[120:135]
    ds_read_b64_tr_b16 v[64:65], v16 offset:5376
    ds_read_b64_tr_b16 v[66:67], v16 offset:6656
    v_mfma_f32_32x32x16_bf16 v[136:151], v[40:43], v[44:47], v[136:151]
    s_waitcnt vmcnt(8) lgkmcnt(0)
    s_barrier
    v_mfma_f32_32x32x16_bf16 v[72:87], v[48:51], v[68:71], v[72:87]
    ds_read_b128 v[44:47], v21 offset:0
    ds_read_b64_tr_b16 v[24:25], v17 offset:0
    ds_read_b64_tr_b16 v[26:27], v17 offset:1280
    v_mfma_f32_32x32x16_bf16 v[88:103], v[52:55], v[68:71], v[88:103]
    ds_read_b64_tr_b16 v[28:29], v17 offset:64
    ds_read_b64_tr_b16 v[30:31], v17 offset:1344
    ds_read_b64_tr_b16 v[32:33], v17 offset:128
    v_mfma_f32_32x32x16_bf16 v[104:119], v[56:59], v[68:71], v[104:119]
    ds_read_b64_tr_b16 v[34:35], v17 offset:1408
    ds_read_b64_tr_b16 v[36:37], v17 offset:192
    ds_read_b64_tr_b16 v[38:39], v17 offset:1472
    v_mfma_f32_32x32x16_bf16 v[120:135], v[60:63], v[68:71], v[120:135]
    ds_read_b64_tr_b16 v[40:41], v17 offset:256
    ds_read_b64_tr_b16 v[42:43], v17 offset:1536
    v_mfma_f32_32x32x16_bf16 v[136:151], v[64:67], v[68:71], v[136:151]
    s_add_u32 m0, s53, 73728
    s_add_u32 s54, s51, 1146880
    buffer_load_dwordx4 v8, s[28:31], s54 offen sc1 lds
    s_add_u32 m0, s53, 81920
    s_add_u32 s54, s51, 1146880
    buffer_load_dwordx4 v9, s[28:31], s54 offen sc1 lds
    s_cmp_lt_u32 s25, 4
    s_cbranch_scc0 oproj_kernel_d29a
    s_add_u32 m0, s53, 90112
    s_add_u32 s54, s51, 1146880
    buffer_load_dwordx4 v10, s[28:31], s54 offen sc1 lds
    s_branch oproj_kernel_d29b
oproj_kernel_d29a:
    s_add_u32 m0, s53, 90112
    s_add_u32 s54, s52, 229376
    buffer_load_dwordx4 v13, s[32:35], s54 offen sc1 lds
oproj_kernel_d29b:
    s_add_u32 m0, s53, 98304
    s_add_u32 s54, s52, 229376
    buffer_load_dwordx4 v11, s[32:35], s54 offen sc1 lds
    s_cmp_lt_u32 s25, 4
    s_cbranch_scc0 oproj_kernel_d30b
    s_add_u32 m0, s53, 106496
    s_add_u32 s54, s52, 229376
    buffer_load_dwordx4 v12, s[32:35], s54 offen sc1 lds
oproj_kernel_d30b:
    s_waitcnt lgkmcnt(0)
    v_mfma_f32_32x32x16_bf16 v[72:87], v[24:27], v[44:47], v[72:87]
    ds_read_b128 v[68:71], v21 offset:4096
    ds_read_b64_tr_b16 v[48:49], v17 offset:5120
    ds_read_b64_tr_b16 v[50:51], v17 offset:6400
    v_mfma_f32_32x32x16_bf16 v[88:103], v[28:31], v[44:47], v[88:103]
    ds_read_b64_tr_b16 v[52:53], v17 offset:5184
    ds_read_b64_tr_b16 v[54:55], v17 offset:6464
    ds_read_b64_tr_b16 v[56:57], v17 offset:5248
    v_mfma_f32_32x32x16_bf16 v[104:119], v[32:35], v[44:47], v[104:119]
    ds_read_b64_tr_b16 v[58:59], v17 offset:6528
    ds_read_b64_tr_b16 v[60:61], v17 offset:5312
    ds_read_b64_tr_b16 v[62:63], v17 offset:6592
    v_mfma_f32_32x32x16_bf16 v[120:135], v[36:39], v[44:47], v[120:135]
    ds_read_b64_tr_b16 v[64:65], v17 offset:5376
    ds_read_b64_tr_b16 v[66:67], v17 offset:6656
    v_mfma_f32_32x32x16_bf16 v[136:151], v[40:43], v[44:47], v[136:151]
    s_waitcnt vmcnt(8) lgkmcnt(0)
    s_barrier
    v_mfma_f32_32x32x16_bf16 v[72:87], v[48:51], v[68:71], v[72:87]
    ds_read_b128 v[44:47], v18 offset:0
    ds_read_b64_tr_b16 v[24:25], v14 offset:0
    ds_read_b64_tr_b16 v[26:27], v14 offset:1280
    v_mfma_f32_32x32x16_bf16 v[88:103], v[52:55], v[68:71], v[88:103]
    ds_read_b64_tr_b16 v[28:29], v14 offset:64
    ds_read_b64_tr_b16 v[30:31], v14 offset:1344
    ds_read_b64_tr_b16 v[32:33], v14 offset:128
    v_mfma_f32_32x32x16_bf16 v[104:119], v[56:59], v[68:71], v[104:119]
    ds_read_b64_tr_b16 v[34:35], v14 offset:1408
    ds_read_b64_tr_b16 v[36:37], v14 offset:192
    ds_read_b64_tr_b16 v[38:39], v14 offset:1472
    v_mfma_f32_32x32x16_bf16 v[120:135], v[60:63], v[68:71], v[120:135]
    ds_read_b64_tr_b16 v[40:41], v14 offset:256
    ds_read_b64_tr_b16 v[42:43], v14 offset:1536
    v_mfma_f32_32x32x16_bf16 v[136:151], v[64:67], v[68:71], v[136:151]
    s_add_u32 m0, s53, 110592
    s_add_u32 s54, s51, 1228800
    buffer_load_dwordx4 v8, s[28:31], s54 offen sc1 lds
    s_add_u32 m0, s53, 118784
    s_add_u32 s54, s51, 1228800
    buffer_load_dwordx4 v9, s[28:31], s54 offen sc1 lds
    s_cmp_lt_u32 s25, 4
    s_cbranch_scc0 oproj_kernel_d31a
    s_add_u32 m0, s53, 126976
    s_add_u32 s54, s51, 1228800
    buffer_load_dwordx4 v10, s[28:31], s54 offen sc1 lds
    s_branch oproj_kernel_d31b
oproj_kernel_d31a:
    s_add_u32 m0, s53, 126976
    s_add_u32 s54, s52, 245760
    buffer_load_dwordx4 v13, s[32:35], s54 offen sc1 lds
oproj_kernel_d31b:
    s_add_u32 m0, s53, 135168
    s_add_u32 s54, s52, 245760
    buffer_load_dwordx4 v11, s[32:35], s54 offen sc1 lds
    s_cmp_lt_u32 s25, 4
    s_cbranch_scc0 oproj_kernel_d32b
    s_add_u32 m0, s53, 143360
    s_add_u32 s54, s52, 245760
    buffer_load_dwordx4 v12, s[32:35], s54 offen sc1 lds
oproj_kernel_d32b:
    s_waitcnt lgkmcnt(0)
    v_mfma_f32_32x32x16_bf16 v[72:87], v[24:27], v[44:47], v[72:87]
    ds_read_b128 v[68:71], v18 offset:4096
    ds_read_b64_tr_b16 v[48:49], v14 offset:5120
    ds_read_b64_tr_b16 v[50:51], v14 offset:6400
    v_mfma_f32_32x32x16_bf16 v[88:103], v[28:31], v[44:47], v[88:103]
    ds_read_b64_tr_b16 v[52:53], v14 offset:5184
    ds_read_b64_tr_b16 v[54:55], v14 offset:6464
    ds_read_b64_tr_b16 v[56:57], v14 offset:5248
    v_mfma_f32_32x32x16_bf16 v[104:119], v[32:35], v[44:47], v[104:119]
    ds_read_b64_tr_b16 v[58:59], v14 offset:6528
    ds_read_b64_tr_b16 v[60:61], v14 offset:5312
    ds_read_b64_tr_b16 v[62:63], v14 offset:6592
    v_mfma_f32_32x32x16_bf16 v[120:135], v[36:39], v[44:47], v[120:135]
    ds_read_b64_tr_b16 v[64:65], v14 offset:5376
    ds_read_b64_tr_b16 v[66:67], v14 offset:6656
    v_mfma_f32_32x32x16_bf16 v[136:151], v[40:43], v[44:47], v[136:151]
    s_waitcnt vmcnt(8) lgkmcnt(0)
    s_barrier
    v_mfma_f32_32x32x16_bf16 v[72:87], v[48:51], v[68:71], v[72:87]
    ds_read_b128 v[44:47], v19 offset:0
    ds_read_b64_tr_b16 v[24:25], v15 offset:0
    ds_read_b64_tr_b16 v[26:27], v15 offset:1280
    v_mfma_f32_32x32x16_bf16 v[88:103], v[52:55], v[68:71], v[88:103]
    ds_read_b64_tr_b16 v[28:29], v15 offset:64
    ds_read_b64_tr_b16 v[30:31], v15 offset:1344
    ds_read_b64_tr_b16 v[32:33], v15 offset:128
    v_mfma_f32_32x32x16_bf16 v[104:119], v[56:59], v[68:71], v[104:119]
    ds_read_b64_tr_b16 v[34:35], v15 offset:1408
    ds_read_b64_tr_b16 v[36:37], v15 offset:192
    ds_read_b64_tr_b16 v[38:39], v15 offset:1472
    v_mfma_f32_32x32x16_bf16 v[120:135], v[60:63], v[68:71], v[120:135]
    ds_read_b64_tr_b16 v[40:41], v15 offset:256
    ds_read_b64_tr_b16 v[42:43], v15 offset:1536
    v_mfma_f32_32x32x16_bf16 v[136:151], v[64:67], v[68:71], v[136:151]
    s_waitcnt lgkmcnt(0)
    v_mfma_f32_32x32x16_bf16 v[72:87], v[24:27], v[44:47], v[72:87]
    ds_read_b128 v[68:71], v19 offset:4096
    ds_read_b64_tr_b16 v[48:49], v15 offset:5120
    ds_read_b64_tr_b16 v[50:51], v15 offset:6400
    v_mfma_f32_32x32x16_bf16 v[88:103], v[28:31], v[44:47], v[88:103]
    ds_read_b64_tr_b16 v[52:53], v15 offset:5184
    ds_read_b64_tr_b16 v[54:55], v15 offset:6464
    ds_read_b64_tr_b16 v[56:57], v15 offset:5248
    v_mfma_f32_32x32x16_bf16 v[104:119], v[32:35], v[44:47], v[104:119]
    ds_read_b64_tr_b16 v[58:59], v15 offset:6528
    ds_read_b64_tr_b16 v[60:61], v15 offset:5312
    ds_read_b64_tr_b16 v[62:63], v15 offset:6592
    v_mfma_f32_32x32x16_bf16 v[120:135], v[36:39], v[44:47], v[120:135]
    ds_read_b64_tr_b16 v[64:65], v15 offset:5376
    ds_read_b64_tr_b16 v[66:67], v15 offset:6656
    v_mfma_f32_32x32x16_bf16 v[136:151], v[40:43], v[44:47], v[136:151]
    s_waitcnt vmcnt(4) lgkmcnt(0)
    s_barrier
    v_mfma_f32_32x32x16_bf16 v[72:87], v[48:51], v[68:71], v[72:87]
    ds_read_b128 v[44:47], v20 offset:0
    ds_read_b64_tr_b16 v[24:25], v16 offset:0
    ds_read_b64_tr_b16 v[26:27], v16 offset:1280
    v_mfma_f32_32x32x16_bf16 v[88:103], v[52:55], v[68:71], v[88:103]
    ds_read_b64_tr_b16 v[28:29], v16 offset:64
    ds_read_b64_tr_b16 v[30:31], v16 offset:1344
    ds_read_b64_tr_b16 v[32:33], v16 offset:128
    v_mfma_f32_32x32x16_bf16 v[104:119], v[56:59], v[68:71], v[104:119]
    ds_read_b64_tr_b16 v[34:35], v16 offset:1408
    ds_read_b64_tr_b16 v[36:37], v16 offset:192
    ds_read_b64_tr_b16 v[38:39], v16 offset:1472
    v_mfma_f32_32x32x16_bf16 v[120:135], v[60:63], v[68:71], v[120:135]
    ds_read_b64_tr_b16 v[40:41], v16 offset:256
    ds_read_b64_tr_b16 v[42:43], v16 offset:1536
    v_mfma_f32_32x32x16_bf16 v[136:151], v[64:67], v[68:71], v[136:151]
    s_waitcnt lgkmcnt(0)
    v_mfma_f32_32x32x16_bf16 v[72:87], v[24:27], v[44:47], v[72:87]
    ds_read_b128 v[68:71], v20 offset:4096
    ds_read_b64_tr_b16 v[48:49], v16 offset:5120
    ds_read_b64_tr_b16 v[50:51], v16 offset:6400
    v_mfma_f32_32x32x16_bf16 v[88:103], v[28:31], v[44:47], v[88:103]
    ds_read_b64_tr_b16 v[52:53], v16 offset:5184
    ds_read_b64_tr_b16 v[54:55], v16 offset:6464
    ds_read_b64_tr_b16 v[56:57], v16 offset:5248
    v_mfma_f32_32x32x16_bf16 v[104:119], v[32:35], v[44:47], v[104:119]
    ds_read_b64_tr_b16 v[58:59], v16 offset:6528
    ds_read_b64_tr_b16 v[60:61], v16 offset:5312
    ds_read_b64_tr_b16 v[62:63], v16 offset:6592
    v_mfma_f32_32x32x16_bf16 v[120:135], v[36:39], v[44:47], v[120:135]
    ds_read_b64_tr_b16 v[64:65], v16 offset:5376
    ds_read_b64_tr_b16 v[66:67], v16 offset:6656
    v_mfma_f32_32x32x16_bf16 v[136:151], v[40:43], v[44:47], v[136:151]
    s_waitcnt vmcnt(0) lgkmcnt(0)
    s_barrier
    v_mfma_f32_32x32x16_bf16 v[72:87], v[48:51], v[68:71], v[72:87]
    ds_read_b128 v[44:47], v21 offset:0
    ds_read_b64_tr_b16 v[24:25], v17 offset:0
    ds_read_b64_tr_b16 v[26:27], v17 offset:1280
    v_mfma_f32_32x32x16_bf16 v[88:103], v[52:55], v[68:71], v[88:103]
    ds_read_b64_tr_b16 v[28:29], v17 offset:64
    ds_read_b64_tr_b16 v[30:31], v17 offset:1344
    ds_read_b64_tr_b16 v[32:33], v17 offset:128
    v_mfma_f32_32x32x16_bf16 v[104:119], v[56:59], v[68:71], v[104:119]
    ds_read_b64_tr_b16 v[34:35], v17 offset:1408
    ds_read_b64_tr_b16 v[36:37], v17 offset:192
    ds_read_b64_tr_b16 v[38:39], v17 offset:1472
    v_mfma_f32_32x32x16_bf16 v[120:135], v[60:63], v[68:71], v[120:135]
    ds_read_b64_tr_b16 v[40:41], v17 offset:256
    ds_read_b64_tr_b16 v[42:43], v17 offset:1536
    v_mfma_f32_32x32x16_bf16 v[136:151], v[64:67], v[68:71], v[136:151]
    s_waitcnt lgkmcnt(0)
    v_mfma_f32_32x32x16_bf16 v[72:87], v[24:27], v[44:47], v[72:87]
    ds_read_b128 v[68:71], v21 offset:4096
    ds_read_b64_tr_b16 v[48:49], v17 offset:5120
    ds_read_b64_tr_b16 v[50:51], v17 offset:6400
    v_mfma_f32_32x32x16_bf16 v[88:103], v[28:31], v[44:47], v[88:103]
    ds_read_b64_tr_b16 v[52:53], v17 offset:5184
    ds_read_b64_tr_b16 v[54:55], v17 offset:6464
    ds_read_b64_tr_b16 v[56:57], v17 offset:5248
    v_mfma_f32_32x32x16_bf16 v[104:119], v[32:35], v[44:47], v[104:119]
    ds_read_b64_tr_b16 v[58:59], v17 offset:6528
    ds_read_b64_tr_b16 v[60:61], v17 offset:5312
    ds_read_b64_tr_b16 v[62:63], v17 offset:6592
    v_mfma_f32_32x32x16_bf16 v[120:135], v[36:39], v[44:47], v[120:135]
    ds_read_b64_tr_b16 v[64:65], v17 offset:5376
    ds_read_b64_tr_b16 v[66:67], v17 offset:6656
    v_mfma_f32_32x32x16_bf16 v[136:151], v[40:43], v[44:47], v[136:151]
    s_waitcnt lgkmcnt(0)
    v_mfma_f32_32x32x16_bf16 v[72:87], v[48:51], v[68:71], v[72:87]
    v_mfma_f32_32x32x16_bf16 v[88:103], v[52:55], v[68:71], v[88:103]
    v_mfma_f32_32x32x16_bf16 v[104:119], v[56:59], v[68:71], v[104:119]
    v_mfma_f32_32x32x16_bf16 v[120:135], v[60:63], v[68:71], v[120:135]
    v_mfma_f32_32x32x16_bf16 v[136:151], v[64:67], v[68:71], v[136:151]
    s_barrier
    s_mul_i32 s57, s25, 10240
    s_add_u32 s58, s25, 4
    s_cmp_ge_u32 s58, 8
    s_cselect_b32 s59, 8, 0
    s_sub_u32 s58, s58, s59
    s_mul_i32 s58, s58, 10240
    v_lshlrev_b32 v4, 4, v1
    v_add_u32 v5, s58, v4
    v_add_u32 v4, s57, v4
    s_cmp_lt_u32 s25, 4
    s_cbranch_scc0 oproj_kernel_red1
    ds_write_b128 v4, v[112:115] offset:0
    ds_write_b128 v4, v[116:119] offset:1024
    ds_write_b128 v4, v[120:123] offset:2048
    ds_write_b128 v4, v[124:127] offset:3072
    ds_write_b128 v4, v[128:131] offset:4096
    ds_write_b128 v4, v[132:135] offset:5120
    ds_write_b128 v4, v[136:139] offset:6144
    ds_write_b128 v4, v[140:143] offset:7168
    ds_write_b128 v4, v[144:147] offset:8192
    ds_write_b128 v4, v[148:151] offset:9216
    s_waitcnt lgkmcnt(0)
    s_barrier
    ds_read_b128 v[112:115], v5 offset:0
    ds_read_b128 v[116:119], v5 offset:1024
    ds_read_b128 v[120:123], v5 offset:2048
    ds_read_b128 v[124:127], v5 offset:3072
    ds_read_b128 v[128:131], v5 offset:4096
    ds_read_b128 v[132:135], v5 offset:5120
    ds_read_b128 v[136:139], v5 offset:6144
    ds_read_b128 v[140:143], v5 offset:7168
    ds_read_b128 v[144:147], v5 offset:8192
    ds_read_b128 v[148:151], v5 offset:9216
    s_waitcnt lgkmcnt(0)
    v_add_f32 v72, v72, v112
    v_add_f32 v73, v73, v113
    v_add_f32 v74, v74, v114
    v_add_f32 v75, v75, v115
    v_add_f32 v76, v76, v116
    v_add_f32 v77, v77, v117
    v_add_f32 v78, v78, v118
    v_add_f32 v79, v79, v119
    v_add_f32 v80, v80, v120
    v_add_f32 v81, v81, v121
    v_add_f32 v82, v82, v122
    v_add_f32 v83, v83, v123
    v_add_f32 v84, v84, v124
    v_add_f32 v85, v85, v125
    v_add_f32 v86, v86, v126
    v_add_f32 v87, v87, v127
    v_add_f32 v88, v88, v128
    v_add_f32 v89, v89, v129
    v_add_f32 v90, v90, v130
    v_add_f32 v91, v91, v131
    v_add_f32 v92, v92, v132
    v_add_f32 v93, v93, v133
    v_add_f32 v94, v94, v134
    v_add_f32 v95, v95, v135
    v_add_f32 v96, v96, v136
    v_add_f32 v97, v97, v137
    v_add_f32 v98, v98, v138
    v_add_f32 v99, v99, v139
    v_add_f32 v100, v100, v140
    v_add_f32 v101, v101, v141
    v_add_f32 v102, v102, v142
    v_add_f32 v103, v103, v143
    v_add_f32 v104, v104, v144
    v_add_f32 v105, v105, v145
    v_add_f32 v106, v106, v146
    v_add_f32 v107, v107, v147
    v_add_f32 v108, v108, v148
    v_add_f32 v109, v109, v149
    v_add_f32 v110, v110, v150
    v_add_f32 v111, v111, v151
    s_add_u32 s36, s12, 0x3c00000
    s_addc_u32 s37, s13, 0
    s_mov_b32 s38, 0x1400000
    s_mov_b32 s39, 0x00020000
    s_lshr_b32 s57, s21, 7
    s_lshl_b32 s58, s19, 4
    s_add_u32 s57, s57, s58
    s_mul_i32 s57, s57, 160
    s_lshr_b32 s58, s20, 2
    s_add_u32 s57, s57, s58
    s_lshl_b32 s57, s57, 11
    s_lshl_b32 s58, s27, 9
    s_add_u32 s57, s57, s58
    v_lshrrev_b32 v4, 5, v1
    v_lshlrev_b32 v4, 11, v4
    v_and_b32 v5, 31, v1
    v_lshlrev_b32 v5, 4, v5
    v_add_u32 v4, v4, v5
    v_add_u32 v4, s57, v4
    s_mov_b32 s60, 0
    buffer_store_dwordx4 v[72:75], v4, s[36:39], s60 offen sc1
    s_mov_b32 s60, 4096
    buffer_store_dwordx4 v[76:79], v4, s[36:39], s60 offen sc1
    s_mov_b32 s60, 8192
    buffer_store_dwordx4 v[80:83], v4, s[36:39], s60 offen sc1
    s_mov_b32 s60, 12288
    buffer_store_dwordx4 v[84:87], v4, s[36:39], s60 offen sc1
    s_mov_b32 s60, 16384
    buffer_store_dwordx4 v[88:91], v4, s[36:39], s60 offen sc1
    s_mov_b32 s60, 20480
    buffer_store_dwordx4 v[92:95], v4, s[36:39], s60 offen sc1
    s_mov_b32 s60, 24576
    buffer_store_dwordx4 v[96:99], v4, s[36:39], s60 offen sc1
    s_mov_b32 s60, 28672
    buffer_store_dwordx4 v[100:103], v4, s[36:39], s60 offen sc1
    s_mov_b32 s60, 32768
    buffer_store_dwordx4 v[104:107], v4, s[36:39], s60 offen sc1
    s_mov_b32 s60, 36864
    buffer_store_dwordx4 v[108:111], v4, s[36:39], s60 offen sc1
    s_branch oproj_kernel_fin
oproj_kernel_red1:
    ds_write_b128 v4, v[72:75] offset:0
    ds_write_b128 v4, v[76:79] offset:1024
    ds_write_b128 v4, v[80:83] offset:2048
    ds_write_b128 v4, v[84:87] offset:3072
    ds_write_b128 v4, v[88:91] offset:4096
    ds_write_b128 v4, v[92:95] offset:5120
    ds_write_b128 v4, v[96:99] offset:6144
    ds_write_b128 v4, v[100:103] offset:7168
    ds_write_b128 v4, v[104:107] offset:8192
    ds_write_b128 v4, v[108:111] offset:9216
    s_waitcnt lgkmcnt(0)
    s_barrier
    ds_read_b128 v[72:75], v5 offset:0
    ds_read_b128 v[76:79], v5 offset:1024
    ds_read_b128 v[80:83], v5 offset:2048
    ds_read_b128 v[84:87], v5 offset:3072
    ds_read_b128 v[88:91], v5 offset:4096
    ds_read_b128 v[92:95], v5 offset:5120
    ds_read_b128 v[96:99], v5 offset:6144
    ds_read_b128 v[100:103], v5 offset:7168
    ds_read_b128 v[104:107], v5 offset:8192
    ds_read_b128 v[108:111], v5 offset:9216
    s_waitcnt lgkmcnt(0)
    v_add_f32 v112, v112, v72
    v_add_f32 v113, v113, v73
    v_add_f32 v114, v114, v74
    v_add_f32 v115, v115, v75
    v_add_f32 v116, v116, v76
    v_add_f32 v117, v117, v77
    v_add_f32 v118, v118, v78
    v_add_f32 v119, v119, v79
    v_add_f32 v120, v120, v80
    v_add_f32 v121, v121, v81
    v_add_f32 v122, v122, v82
    v_add_f32 v123, v123, v83
    v_add_f32 v124, v124, v84
    v_add_f32 v125, v125, v85
    v_add_f32 v126, v126, v86
    v_add_f32 v127, v127, v87
    v_add_f32 v128, v128, v88
    v_add_f32 v129, v129, v89
    v_add_f32 v130, v130, v90
    v_add_f32 v131, v131, v91
    v_add_f32 v132, v132, v92
    v_add_f32 v133, v133, v93
    v_add_f32 v134, v134, v94
    v_add_f32 v135, v135, v95
    v_add_f32 v136, v136, v96
    v_add_f32 v137, v137, v97
    v_add_f32 v138, v138, v98
    v_add_f32 v139, v139, v99
    v_add_f32 v140, v140, v100
    v_add_f32 v141, v141, v101
    v_add_f32 v142, v142, v102
    v_add_f32 v143, v143, v103
    v_add_f32 v144, v144, v104
    v_add_f32 v145, v145, v105
    v_add_f32 v146, v146, v106
    v_add_f32 v147, v147, v107
    v_add_f32 v148, v148, v108
    v_add_f32 v149, v149, v109
    v_add_f32 v150, v150, v110
    v_add_f32 v151, v151, v111
    s_add_u32 s36, s12, 0x3c00000
    s_addc_u32 s37, s13, 0
    s_mov_b32 s38, 0x1400000
    s_mov_b32 s39, 0x00020000
    s_lshr_b32 s57, s21, 7
    s_lshl_b32 s58, s19, 4
    s_add_u32 s57, s57, s58
    s_mul_i32 s57, s57, 160
    s_lshr_b32 s58, s20, 2
    s_add_u32 s57, s57, s58
    s_lshl_b32 s57, s57, 11
    s_lshl_b32 s58, s27, 9
    s_add_u32 s57, s57, s58
    v_lshrrev_b32 v4, 5, v1
    v_lshlrev_b32 v4, 11, v4
    v_and_b32 v5, 31, v1
    v_lshlrev_b32 v5, 4, v5
    v_add_u32 v4, v4, v5
    v_add_u32 v4, s57, v4
    s_mov_b32 s60, 40960
    buffer_store_dwordx4 v[112:115], v4, s[36:39], s60 offen sc1
    s_mov_b32 s60, 45056
    buffer_store_dwordx4 v[116:119], v4, s[36:39], s60 offen sc1
    s_mov_b32 s60, 49152
    buffer_store_dwordx4 v[120:123], v4, s[36:39], s60 offen sc1
    s_mov_b32 s60, 53248
    buffer_store_dwordx4 v[124:127], v4, s[36:39], s60 offen sc1
    s_mov_b32 s60, 57344
    buffer_store_dwordx4 v[128:131], v4, s[36:39], s60 offen sc1
    s_mov_b32 s60, 61440
    buffer_store_dwordx4 v[132:135], v4, s[36:39], s60 offen sc1
    s_mov_b32 s60, 65536
    buffer_store_dwordx4 v[136:139], v4, s[36:39], s60 offen sc1
    s_mov_b32 s60, 69632
    buffer_store_dwordx4 v[140:143], v4, s[36:39], s60 offen sc1
    s_mov_b32 s60, 73728
    buffer_store_dwordx4 v[144:147], v4, s[36:39], s60 offen sc1
    s_mov_b32 s60, 77824
    buffer_store_dwordx4 v[148:151], v4, s[36:39], s60 offen sc1
oproj_kernel_fin:
oproj_kernel_fin2:
    s_waitcnt vmcnt(0)
    s_barrier
    s_cmp_eq_u32 s25, 0
    s_cbranch_scc0 L_fz_s13
    s_lshl_b32 s88, s2, 3
    s_add_u32 s88, s88, 6144
    s_mov_b64 exec, 1
    v_mov_b32 v248, s100
    v_mov_b32 v249, s101
    v_mov_b32 v250, 0
    buffer_store_dwordx2 v[248:249], v250, s[96:99], s88 offen sc0 sc1
    s_mov_b64 exec, -1
L_fz_s13:
oproj_kernel_end:
    s_load_dwordx2 s[6:7], s[0:1], 0
    s_load_dwordx2 s[12:13], s[0:1], 104
    v_lshrrev_b32 v2, 6, v0
    v_and_b32 v1, 63, v0
    v_readfirstlane_b32 s25, v2
    s_waitcnt lgkmcnt(0)
    s_add_u32 s28, s12, 0x3c00000
    s_addc_u32 s29, s13, 0
    s_mov_b32 s30, 0x1400000
    s_mov_b32 s31, 0x00020000
    s_mov_b32 s32, s6
    s_mov_b32 s33, s7
    s_mov_b32 s34, 0x280000
    s_mov_b32 s35, 0x00020000
    s_add_u32 s36, s12, 0x5400000
    s_addc_u32 s37, s13, 0
    s_mov_b32 s38, 0x280000
    s_mov_b32 s39, 0x00020000
    s_add_u32 s40, s12, 0x5800000
    s_addc_u32 s41, s13, 0
    s_mov_b32 s42, 0x280000
    s_mov_b32 s43, 0x00020000
    s_cmp_eq_u32 s25, 0
    s_cbranch_scc0 L_fz_w14d
    v_and_b32 v121, 63, v0
    v_min_u32 v121, 15, v121
    s_lshr_b32 s88, s2, 4
    s_and_b32 s89, s88, 7
    s_lshl_b32 s89, s89, 5
    s_lshr_b32 s88, s88, 3
    s_lshl_b32 s88, s88, 2
    s_add_u32 s88, s88, s89
    s_add_u32 s88, s88, 768
    v_lshrrev_b32 v120, 2, v121
    v_lshlrev_b32 v120, 3, v120
    v_and_b32 v122, 3, v121
    v_add_u32 v120, v120, v122
    v_add_u32 v120, s88, v120
    v_lshlrev_b32 v120, 3, v120
    s_mov_b32 s88, 0
L_fz_w14:
    buffer_load_dwordx2 v[122:123], v120, s[96:99], 0 offen sc0 sc1
    s_waitcnt vmcnt(0)
    v_cmp_eq_u64 vcc, s[100:101], v[122:123]
    s_add_u32 s88, s88, 1
    s_nop 0
    s_cmp_eq_u64 vcc, exec
    s_cbranch_scc1 L_fz_w14d
    s_sleep 1
    s_cmp_lt_u32 s88, 400000
    s_cbranch_scc1 L_fz_w14
L_fz_w14d:
    s_barrier
    s_cmp_lt_u32 s25, 4
    s_cbranch_scc0 L_ln_idle
    s_lshr_b32 s20, s2, 4
    s_and_b32 s21, s2, 15
    s_lshl_b32 s21, s21, 3
    v_and_b32 v3, 7, v1
    v_lshrrev_b32 v4, 3, v1
    s_mul_i32 s22, s25, 40
    v_add_u32 v4, s22, v4
    v_add_u32 v5, s21, v3
    v_lshlrev_b32 v6, 11, v4
    v_lshlrev_b32 v7, 4, v5
    v_add_u32 v6, v6, v7
    s_mul_i32 s23, s20, 327680
    s_add_u32 s54, s23, 0
    buffer_load_dwordx4 v[16:19], v6, s[28:31], s54 offen sc1
    s_add_u32 s54, s23, 16384
    buffer_load_dwordx4 v[20:23], v6, s[28:31], s54 offen sc1
    s_add_u32 s54, s23, 32768
    buffer_load_dwordx4 v[24:27], v6, s[28:31], s54 offen sc1
    s_add_u32 s54, s23, 49152
    buffer_load_dwordx4 v[28:31], v6, s[28:31], s54 offen sc1
    s_add_u32 s54, s23, 65536
    buffer_load_dwordx4 v[32:35], v6, s[28:31], s54 offen sc1
    s_add_u32 s54, s23, 5242880
    buffer_load_dwordx4 v[36:39], v6, s[28:31], s54 offen sc1
    s_add_u32 s54, s23, 5259264
    buffer_load_dwordx4 v[40:43], v6, s[28:31], s54 offen sc1
    s_add_u32 s54, s23, 5275648
    buffer_load_dwordx4 v[44:47], v6, s[28:31], s54 offen sc1
    s_add_u32 s54, s23, 5292032
    buffer_load_dwordx4 v[48:51], v6, s[28:31], s54 offen sc1
    s_add_u32 s54, s23, 5308416
    buffer_load_dwordx4 v[52:55], v6, s[28:31], s54 offen sc1
    s_add_u32 s54, s23, 10485760
    buffer_load_dwordx4 v[56:59], v6, s[28:31], s54 offen sc1
    s_add_u32 s54, s23, 10502144
    buffer_load_dwordx4 v[60:63], v6, s[28:31], s54 offen sc1
    s_add_u32 s54, s23, 10518528
    buffer_load_dwordx4 v[64:67], v6, s[28:31], s54 offen sc1
    s_add_u32 s54, s23, 10534912
    buffer_load_dwordx4 v[68:71], v6, s[28:31], s54 offen sc1
    s_add_u32 s54, s23, 10551296
    buffer_load_dwordx4 v[72:75], v6, s[28:31], s54 offen sc1
    s_add_u32 s54, s23, 15728640
    buffer_load_dwordx4 v[76:79], v6, s[28:31], s54 offen sc1
    s_add_u32 s54, s23, 15745024
    buffer_load_dwordx4 v[80:83], v6, s[28:31], s54 offen sc1
    s_add_u32 s54, s23, 15761408
    buffer_load_dwordx4 v[84:87], v6, s[28:31], s54 offen sc1
    s_add_u32 s54, s23, 15777792
    buffer_load_dwordx4 v[88:91], v6, s[28:31], s54 offen sc1
    s_add_u32 s54, s23, 15794176
    buffer_load_dwordx4 v[92:95], v6, s[28:31], s54 offen sc1
    s_lshl_b32 s24, s2, 3
    v_add_u32 v8, s24, v3
    v_mul_u32_u24 v8, 1280, v8
    v_lshlrev_b32 v9, 3, v4
    v_add_u32 v8, v8, v9
    buffer_load_dwordx2 v[96:97], v8, s[32:35], 0 offen offset:0 sc1
    buffer_load_dwordx2 v[98:99], v8, s[32:35], 0 offen offset:64 sc1
    buffer_load_dwordx2 v[100:101], v8, s[32:35], 0 offen offset:128 sc1
    buffer_load_dwordx2 v[102:103], v8, s[32:35], 0 offen offset:192 sc1
    buffer_load_dwordx2 v[104:105], v8, s[32:35], 0 offen offset:256 sc1
    s_waitcnt vmcnt(0)
    v_add_f32 v16, v16, v36
    v_add_f32 v56, v56, v76
    v_add_f32 v16, v16, v56
    v_add_f32 v17, v17, v37
    v_add_f32 v57, v57, v77
    v_add_f32 v17, v17, v57
    v_add_f32 v18, v18, v38
    v_add_f32 v58, v58, v78
    v_add_f32 v18, v18, v58
    v_add_f32 v19, v19, v39
    v_add_f32 v59, v59, v79
    v_add_f32 v19, v19, v59
    v_add_f32 v20, v20, v40
    v_add_f32 v60, v60, v80
    v_add_f32 v20, v20, v60
    v_add_f32 v21, v21, v41
    v_add_f32 v61, v61, v81
    v_add_f32 v21, v21, v61
    v_add_f32 v22, v22, v42
    v_add_f32 v62, v62, v82
    v_add_f32 v22, v22, v62
    v_add_f32 v23, v23, v43
    v_add_f32 v63, v63, v83
    v_add_f32 v23, v23, v63
    v_add_f32 v24, v24, v44
    v_add_f32 v64, v64, v84
    v_add_f32 v24, v24, v64
    v_add_f32 v25, v25, v45
    v_add_f32 v65, v65, v85
    v_add_f32 v25, v25, v65
    v_add_f32 v26, v26, v46
    v_add_f32 v66, v66, v86
    v_add_f32 v26, v26, v66
    v_add_f32 v27, v27, v47
    v_add_f32 v67, v67, v87
    v_add_f32 v27, v27, v67
    v_add_f32 v28, v28, v48
    v_add_f32 v68, v68, v88
    v_add_f32 v28, v28, v68
    v_add_f32 v29, v29, v49
    v_add_f32 v69, v69, v89
    v_add_f32 v29, v29, v69
    v_add_f32 v30, v30, v50
    v_add_f32 v70, v70, v90
    v_add_f32 v30, v30, v70
    v_add_f32 v31, v31, v51
    v_add_f32 v71, v71, v91
    v_add_f32 v31, v31, v71
    v_add_f32 v32, v32, v52
    v_add_f32 v72, v72, v92
    v_add_f32 v32, v32, v72
    v_add_f32 v33, v33, v53
    v_add_f32 v73, v73, v93
    v_add_f32 v33, v33, v73
    v_add_f32 v34, v34, v54
    v_add_f32 v74, v74, v94
    v_add_f32 v34, v34, v74
    v_add_f32 v35, v35, v55
    v_add_f32 v75, v75, v95
    v_add_f32 v35, v35, v75
    v_cvt_pk_bf16_f32 v110, v16, v17
    v_lshlrev_b32 v111, 16, v110
    v_and_b32 v112, 0xffff0000, v110
    v_lshlrev_b32 v113, 16, v96
    v_and_b32 v114, 0xffff0000, v96
    v_add_f32 v111, v111, v113
    v_add_f32 v112, v112, v114
    v_cvt_pk_bf16_f32 v40, v111, v112
    v_lshlrev_b32 v16, 16, v40
    v_and_b32 v17, 0xffff0000, v40
    v_cvt_pk_bf16_f32 v110, v18, v19
    v_lshlrev_b32 v111, 16, v110
    v_and_b32 v112, 0xffff0000, v110
    v_lshlrev_b32 v113, 16, v97
    v_and_b32 v114, 0xffff0000, v97
    v_add_f32 v111, v111, v113
    v_add_f32 v112, v112, v114
    v_cvt_pk_bf16_f32 v41, v111, v112
    v_lshlrev_b32 v18, 16, v41
    v_and_b32 v19, 0xffff0000, v41
    v_cvt_pk_bf16_f32 v110, v20, v21
    v_lshlrev_b32 v111, 16, v110
    v_and_b32 v112, 0xffff0000, v110
    v_lshlrev_b32 v113, 16, v98
    v_and_b32 v114, 0xffff0000, v98
    v_add_f32 v111, v111, v113
    v_add_f32 v112, v112, v114
    v_cvt_pk_bf16_f32 v42, v111, v112
    v_lshlrev_b32 v20, 16, v42
    v_and_b32 v21, 0xffff0000, v42
    v_cvt_pk_bf16_f32 v110, v22, v23
    v_lshlrev_b32 v111, 16, v110
    v_and_b32 v112, 0xffff0000, v110
    v_lshlrev_b32 v113, 16, v99
    v_and_b32 v114, 0xffff0000, v99
    v_add_f32 v111, v111, v113
    v_add_f32 v112, v112, v114
    v_cvt_pk_bf16_f32 v43, v111, v112
    v_lshlrev_b32 v22, 16, v43
    v_and_b32 v23, 0xffff0000, v43
    v_cvt_pk_bf16_f32 v110, v24, v25
    v_lshlrev_b32 v111, 16, v110
    v_and_b32 v112, 0xffff0000, v110
    v_lshlrev_b32 v113, 16, v100
    v_and_b32 v114, 0xffff0000, v100
    v_add_f32 v111, v111, v113
    v_add_f32 v112, v112, v114
    v_cvt_pk_bf16_f32 v44, v111, v112
    v_lshlrev_b32 v24, 16, v44
    v_and_b32 v25, 0xffff0000, v44
    v_cvt_pk_bf16_f32 v110, v26, v27
    v_lshlrev_b32 v111, 16, v110
    v_and_b32 v112, 0xffff0000, v110
    v_lshlrev_b32 v113, 16, v101
    v_and_b32 v114, 0xffff0000, v101
    v_add_f32 v111, v111, v113
    v_add_f32 v112, v112, v114
    v_cvt_pk_bf16_f32 v45, v111, v112
    v_lshlrev_b32 v26, 16, v45
    v_and_b32 v27, 0xffff0000, v45
    v_cvt_pk_bf16_f32 v110, v28, v29
    v_lshlrev_b32 v111, 16, v110
    v_and_b32 v112, 0xffff0000, v110
    v_lshlrev_b32 v113, 16, v102
    v_and_b32 v114, 0xffff0000, v102
    v_add_f32 v111, v111, v113
    v_add_f32 v112, v112, v114
    v_cvt_pk_bf16_f32 v46, v111, v112
    v_lshlrev_b32 v28, 16, v46
    v_and_b32 v29, 0xffff0000, v46
    v_cvt_pk_bf16_f32 v110, v30, v31
    v_lshlrev_b32 v111, 16, v110
    v_and_b32 v112, 0xffff0000, v110
    v_lshlrev_b32 v113, 16, v103
    v_and_b32 v114, 0xffff0000, v103
    v_add_f32 v111, v111, v113
    v_add_f32 v112, v112, v114
    v_cvt_pk_bf16_f32 v47, v111, v112
    v_lshlrev_b32 v30, 16, v47
    v_and_b32 v31, 0xffff0000, v47
    v_cvt_pk_bf16_f32 v110, v32, v33
    v_lshlrev_b32 v111, 16, v110
    v_and_b32 v112, 0xffff0000, v110
    v_lshlrev_b32 v113, 16, v104
    v_and_b32 v114, 0xffff0000, v104
    v_add_f32 v111, v111, v113
    v_add_f32 v112, v112, v114
    v_cvt_pk_bf16_f32 v48, v111, v112
    v_lshlrev_b32 v32, 16, v48
    v_and_b32 v33, 0xffff0000, v48
    v_cvt_pk_bf16_f32 v110, v34, v35
    v_lshlrev_b32 v111, 16, v110
    v_and_b32 v112, 0xffff0000, v110
    v_lshlrev_b32 v113, 16, v105
    v_and_b32 v114, 0xffff0000, v105
    v_add_f32 v111, v111, v113
    v_add_f32 v112, v112, v114
    v_cvt_pk_bf16_f32 v49, v111, v112
    v_lshlrev_b32 v34, 16, v49
    v_and_b32 v35, 0xffff0000, v49
    v_lshrrev_b32 v9, 1, v4
    v_lshlrev_b32 v9, 11, v9
    v_and_b32 v10, 1, v4
    v_lshlrev_b32 v10, 3, v10
    v_add_u32 v9, v9, v10
    v_add_u32 v9, v9, v7
    s_mul_i32 s26, s20, 163840
    s_add_u32 s54, s26, 0
    buffer_store_dwordx2 v[40:41], v9, s[36:39], s54 offen sc1
    s_add_u32 s54, s26, 8192
    buffer_store_dwordx2 v[42:43], v9, s[36:39], s54 offen sc1
    s_add_u32 s54, s26, 16384
    buffer_store_dwordx2 v[44:45], v9, s[36:39], s54 offen sc1
    s_add_u32 s54, s26, 24576
    buffer_store_dwordx2 v[46:47], v9, s[36:39], s54 offen sc1
    s_add_u32 s54, s26, 32768
    buffer_store_dwordx2 v[48:49], v9, s[36:39], s54 offen sc1
    v_add_f32 v110, v16, v17
    v_add_f32 v110, v110, v18
    v_add_f32 v110, v110, v19
    v_add_f32 v110, v110, v20
    v_add_f32 v110, v110, v21
    v_add_f32 v110, v110, v22
    v_add_f32 v110, v110, v23
    v_add_f32 v110, v110, v24
    v_add_f32 v110, v110, v25
    v_add_f32 v110, v110, v26
    v_add_f32 v110, v110, v27
    v_add_f32 v110, v110, v28
    v_add_f32 v110, v110, v29
    v_add_f32 v110, v110, v30
    v_add_f32 v110, v110, v31
    v_add_f32 v110, v110, v32
    v_add_f32 v110, v110, v33
    v_add_f32 v110, v110, v34
    v_add_f32 v110, v110, v35
    s_nop 1
    v_add_f32_dpp v110, v110, v110 row_ror:8 row_mask:0xf bank_mask:0xf
    v_mov_b32 v111, v110
    s_nop 1
    v_permlane16_swap_b32 v110, v111
    v_add_f32 v110, v110, v111
    v_mov_b32 v111, v110
    s_nop 1
    v_permlane32_swap_b32 v110, v111
    v_add_f32 v110, v110, v111
    s_lshl_b32 s27, s25, 5
    v_lshlrev_b32 v11, 2, v3
    v_add_u32 v12, s27, v11
    ds_write_b32 v12, v110 offset:0
    s_waitcnt lgkmcnt(0)
    s_barrier
    ds_read_b32 v116, v11 offset:0
    ds_read_b32 v117, v11 offset:32
    ds_read_b32 v118, v11 offset:64
    ds_read_b32 v119, v11 offset:96
    s_waitcnt lgkmcnt(0)
    v_add_f32 v116, v116, v117
    v_add_f32 v118, v118, v119
    v_add_f32 v110, v116, v118
    v_mul_f32 v110, 0x3acccccd, v110
    v_sub_f32 v16, v16, v110
    v_sub_f32 v17, v17, v110
    v_sub_f32 v18, v18, v110
    v_sub_f32 v19, v19, v110
    v_sub_f32 v20, v20, v110
    v_sub_f32 v21, v21, v110
    v_sub_f32 v22, v22, v110
    v_sub_f32 v23, v23, v110
    v_sub_f32 v24, v24, v110
    v_sub_f32 v25, v25, v110
    v_sub_f32 v26, v26, v110
    v_sub_f32 v27, v27, v110
    v_sub_f32 v28, v28, v110
    v_sub_f32 v29, v29, v110
    v_sub_f32 v30, v30, v110
    v_sub_f32 v31, v31, v110
    v_sub_f32 v32, v32, v110
    v_sub_f32 v33, v33, v110
    v_sub_f32 v34, v34, v110
    v_sub_f32 v35, v35, v110
    v_mul_f32 v110, v16, v16
    v_fmac_f32 v110, v17, v17
    v_fmac_f32 v110, v18, v18
    v_fmac_f32 v110, v19, v19
    v_fmac_f32 v110, v20, v20
    v_fmac_f32 v110, v21, v21
    v_fmac_f32 v110, v22, v22
    v_fmac_f32 v110, v23, v23
    v_fmac_f32 v110, v24, v24
    v_fmac_f32 v110, v25, v25
    v_fmac_f32 v110, v26, v26
    v_fmac_f32 v110, v27, v27
    v_fmac_f32 v110, v28, v28
    v_fmac_f32 v110, v29, v29
    v_fmac_f32 v110, v30, v30
    v_fmac_f32 v110, v31, v31
    v_fmac_f32 v110, v32, v32
    v_fmac_f32 v110, v33, v33
    v_fmac_f32 v110, v34, v34
    v_fmac_f32 v110, v35, v35
    s_nop 1
    v_add_f32_dpp v110, v110, v110 row_ror:8 row_mask:0xf bank_mask:0xf
    v_mov_b32 v111, v110
    s_nop 1
    v_permlane16_swap_b32 v110, v111
    v_add_f32 v110, v110, v111
    v_mov_b32 v111, v110
    s_nop 1
    v_permlane32_swap_b32 v110, v111
    v_add_f32 v110, v110, v111
    s_lshl_b32 s27, s25, 5
    v_lshlrev_b32 v11, 2, v3
    v_add_u32 v12, s27, v11
    ds_write_b32 v12, v110 offset:256
    s_waitcnt lgkmcnt(0)
    s_barrier
    ds_read_b32 v116, v11 offset:256
    ds_read_b32 v117, v11 offset:288
    ds_read_b32 v118, v11 offset:320
    ds_read_b32 v119, v11 offset:352
    s_waitcnt lgkmcnt(0)
    v_add_f32 v116, v116, v117
    v_add_f32 v118, v118, v119
    v_add_f32 v110, v116, v118
    v_mov_b32 v111, 0x3727c5ac
    v_fmac_f32 v111, 0x3acccccd, v110
    v_rsq_f32 v111, v111
    s_nop 0
    v_mul_f32 v16, v16, v111
    v_mul_f32 v17, v17, v111
    v_mul_f32 v18, v18, v111
    v_mul_f32 v19, v19, v111
    v_mul_f32 v20, v20, v111
    v_mul_f32 v21, v21, v111
    v_mul_f32 v22, v22, v111
    v_mul_f32 v23, v23, v111
    v_mul_f32 v24, v24, v111
    v_mul_f32 v25, v25, v111
    v_mul_f32 v26, v26, v111
    v_mul_f32 v27, v27, v111
    v_mul_f32 v28, v28, v111
    v_mul_f32 v29, v29, v111
    v_mul_f32 v30, v30, v111
    v_mul_f32 v31, v31, v111
    v_mul_f32 v32, v32, v111
    v_mul_f32 v33, v33, v111
    v_mul_f32 v34, v34, v111
    v_mul_f32 v35, v35, v111
    v_cvt_pk_bf16_f32 v60, v16, v17
    v_cvt_pk_bf16_f32 v61, v18, v19
    s_add_u32 s54, s26, 0
    buffer_store_dwordx2 v[60:61], v9, s[40:43], s54 offen sc1
    v_cvt_pk_bf16_f32 v62, v20, v21
    v_cvt_pk_bf16_f32 v63, v22, v23
    s_add_u32 s54, s26, 8192
    buffer_store_dwordx2 v[62:63], v9, s[40:43], s54 offen sc1
    v_cvt_pk_bf16_f32 v64, v24, v25
    v_cvt_pk_bf16_f32 v65, v26, v27
    s_add_u32 s54, s26, 16384
    buffer_store_dwordx2 v[64:65], v9, s[40:43], s54 offen sc1
    v_cvt_pk_bf16_f32 v66, v28, v29
    v_cvt_pk_bf16_f32 v67, v30, v31
    s_add_u32 s54, s26, 24576
    buffer_store_dwordx2 v[66:67], v9, s[40:43], s54 offen sc1
    v_cvt_pk_bf16_f32 v68, v32, v33
    v_cvt_pk_bf16_f32 v69, v34, v35
    s_add_u32 s54, s26, 32768
    buffer_store_dwordx2 v[68:69], v9, s[40:43], s54 offen sc1
    s_branch L_ln_sig
L_ln_idle:
    s_barrier
    s_barrier
L_ln_sig:
    s_waitcnt vmcnt(0)
    s_barrier
    s_cmp_eq_u32 s25, 0
    s_cbranch_scc0 L_fz_s15
    s_lshl_b32 s88, s2, 3
    s_add_u32 s88, s88, 8192
    s_mov_b64 exec, 1
    v_mov_b32 v248, s100
    v_mov_b32 v249, s101
    v_mov_b32 v250, 0
    buffer_store_dwordx2 v[248:249], v250, s[96:99], s88 offen sc0 sc1
    s_mov_b64 exec, -1
L_fz_s15:
L_ln_end:
    s_cmp_ge_u32 s2, 216
    s_cbranch_scc1 ffn1_kernel_end
    s_load_dwordx2 s[4:5], s[0:1], 56
    s_load_dwordx2 s[12:13], s[0:1], 104
    s_load_dwordx2 s[14:15], s[0:1], 64
    v_lshrrev_b32 v2, 6, v0
    v_and_b32 v1, 63, v0
    v_readfirstlane_b32 s25, v2
    s_and_b32 s21, s2, 7
    s_lshl_b32 s21, s21, 8
    s_lshr_b32 s20, s2, 3
    s_lshl_b32 s20, s20, 6
    s_mov_b32 s22, 0
    s_waitcnt lgkmcnt(0)
    s_mov_b32 s28, s4
    s_mov_b32 s29, s5
    s_mov_b32 s30, 0x21c000
    s_mov_b32 s31, 0x00020000
    s_add_u32 s32, s12, 0x5800000
    s_addc_u32 s33, s13, 0
    s_mov_b32 s34, 0x280000
    s_mov_b32 s35, 0x00020000
    s_lshl_b32 s53, s25, 10
    v_lshlrev_b32 v3, 4, v1
    s_add_u32 s54, s25, 0
    s_lshl_b32 s54, s54, 6
    v_add_u32 v4, s54, v1
    v_lshrrev_b32 v5, 3, v4
    v_and_b32 v6, 7, v4
    v_lshrrev_b32 v7, 1, v5
    v_and_b32 v7, 1, v7
    v_lshlrev_b32 v7, 2, v7
    v_xor_b32 v6, v6, v7
    v_mul_u32_u24 v5, 3456, v5
    v_lshlrev_b32 v6, 4, v6
    v_add_u32 v8, v5, v6
    s_add_u32 s54, s25, 0
    s_lshl_b32 s54, s54, 10
    v_add_u32 v4, s54, v3
    v_lshrrev_b32 v5, 12, v4
    v_and_b32 v6, 4095, v4
    v_lshlrev_b32 v5, 11, v5
    v_lshrrev_b32 v7, 11, v6
    v_and_b32 v6, 2047, v6
    v_mul_u32_u24 v7, 163840, v7
    v_add_u32 v5, v5, v7
    v_add_u32 v9, v5, v6
    s_add_u32 s54, s25, 8
    s_lshl_b32 s54, s54, 10
    v_add_u32 v4, s54, v3
    v_lshrrev_b32 v5, 12, v4
    v_and_b32 v6, 4095, v4
    v_lshlrev_b32 v5, 11, v5
    v_lshrrev_b32 v7, 11, v6
    v_and_b32 v6, 2047, v6
    v_mul_u32_u24 v7, 163840, v7
    v_add_u32 v5, v5, v7
    v_add_u32 v10, v5, v6
    s_add_u32 s54, s25, 16
    s_lshl_b32 s54, s54, 10
    v_add_u32 v4, s54, v3
    v_lshrrev_b32 v5, 12, v4
    v_and_b32 v6, 4095, v4
    v_lshlrev_b32 v5, 11, v5
    v_lshrrev_b32 v7, 11, v6
    v_and_b32 v6, 2047, v6
    v_mul_u32_u24 v7, 163840, v7
    v_add_u32 v5, v5, v7
    v_add_u32 v11, v5, v6
    s_add_u32 s54, s25, 24
    s_lshl_b32 s54, s54, 10
    v_add_u32 v4, s54, v3
    v_lshrrev_b32 v5, 12, v4
    v_and_b32 v6, 4095, v4
    v_lshlrev_b32 v5, 11, v5
    v_lshrrev_b32 v7, 11, v6
    v_and_b32 v6, 2047, v6
    v_mul_u32_u24 v7, 163840, v7
    v_add_u32 v5, v5, v7
    v_add_u32 v12, v5, v6
    s_mul_i32 s51, s22, 3456
    s_lshl_b32 s54, s20, 1
    s_add_u32 s51, s51, s54
    s_lshr_b32 s52, s21, 7
    s_mul_i32 s52, s52, 80
    s_lshr_b32 s54, s22, 3
    s_add_u32 s52, s52, s54
    s_lshl_b32 s52, s52, 11
    s_and_b32 s54, s21, 127
    s_lshl_b32 s54, s54, 4
    s_add_u32 s52, s52, s54
    s_add_u32 m0, s53, 0
    s_add_u32 s54, s51, 0
    buffer_load_dwordx4 v8, s[28:31], s54 offen sc1 lds
    s_add_u32 m0, s53, 40960
    s_add_u32 s54, s51, 221184
    buffer_load_dwordx4 v8, s[28:31], s54 offen sc1 lds
    s_add_u32 m0, s53, 81920
    s_add_u32 s54, s51, 442368
    buffer_load_dwordx4 v8, s[28:31], s54 offen sc1 lds
    s_add_u32 m0, s53, 122880
    s_add_u32 s54, s51, 663552
    buffer_load_dwordx4 v8, s[28:31], s54 offen sc1 lds
    s_cmp_eq_u32 s25, 0
    s_cbranch_scc0 L_fz_w16d
    v_and_b32 v41, 63, v0
    v_min_u32 v41, 31, v41
    s_lshr_b32 s88, s21, 3
    s_add_u32 s88, s88, 1024
    v_add_u32 v40, s88, v41
    v_lshlrev_b32 v40, 3, v40
    s_mov_b32 s88, 0
L_fz_w16:
    buffer_load_dwordx2 v[42:43], v40, s[96:99], 0 offen sc0 sc1
    s_waitcnt vmcnt(0)
    v_cmp_eq_u64 vcc, s[100:101], v[42:43]
    s_add_u32 s88, s88, 1
    s_nop 0
    s_cmp_eq_u64 vcc, exec
    s_cbranch_scc1 L_fz_w16d
    s_sleep 1
    s_cmp_lt_u32 s88, 400000
    s_cbranch_scc1 L_fz_w16
L_fz_w16d:
    s_barrier
    s_add_u32 m0, s53, 8192
    s_add_u32 s54, s52, 0
    buffer_load_dwordx4 v9, s[32:35], s54 offen sc1 lds
    s_add_u32 m0, s53, 16384
    s_add_u32 s54, s52, 0
    buffer_load_dwordx4 v10, s[32:35], s54 offen sc1 lds
    s_add_u32 m0, s53, 24576
    s_add_u32 s54, s52, 0
    buffer_load_dwordx4 v11, s[32:35], s54 offen sc1 lds
    s_add_u32 m0, s53, 32768
    s_add_u32 s54, s52, 0
    buffer_load_dwordx4 v12, s[32:35], s54 offen sc1 lds
    s_add_u32 m0, s53, 49152
    s_add_u32 s54, s52, 16384
    buffer_load_dwordx4 v9, s[32:35], s54 offen sc1 lds
    s_add_u32 m0, s53, 57344
    s_add_u32 s54, s52, 16384
    buffer_load_dwordx4 v10, s[32:35], s54 offen sc1 lds
    s_add_u32 m0, s53, 65536
    s_add_u32 s54, s52, 16384
    buffer_load_dwordx4 v11, s[32:35], s54 offen sc1 lds
    s_add_u32 m0, s53, 73728
    s_add_u32 s54, s52, 16384
    buffer_load_dwordx4 v12, s[32:35], s54 offen sc1 lds
    s_add_u32 m0, s53, 90112
    s_add_u32 s54, s52, 32768
    buffer_load_dwordx4 v9, s[32:35], s54 offen sc1 lds
    s_add_u32 m0, s53, 98304
    s_add_u32 s54, s52, 32768
    buffer_load_dwordx4 v10, s[32:35], s54 offen sc1 lds
    s_add_u32 m0, s53, 106496
    s_add_u32 s54, s52, 32768
    buffer_load_dwordx4 v11, s[32:35], s54 offen sc1 lds
    s_add_u32 m0, s53, 114688
    s_add_u32 s54, s52, 32768
    buffer_load_dwordx4 v12, s[32:35], s54 offen sc1 lds
    s_add_u32 m0, s53, 131072
    s_add_u32 s54, s52, 49152
    buffer_load_dwordx4 v9, s[32:35], s54 offen sc1 lds
    s_add_u32 m0, s53, 139264
    s_add_u32 s54, s52, 49152
    buffer_load_dwordx4 v10, s[32:35], s54 offen sc1 lds
    s_add_u32 m0, s53, 147456
    s_add_u32 s54, s52, 49152
    buffer_load_dwordx4 v11, s[32:35], s54 offen sc1 lds
    s_add_u32 m0, s53, 155648
    s_add_u32 s54, s52, 49152
    buffer_load_dwordx4 v12, s[32:35], s54 offen sc1 lds
    s_mov_b32 s56, 0
    s_mov_b32 s26, 0
    s_mov_b32 s57, s25
    s_and_b32 s27, s57, 3
    s_lshr_b32 s24, s57, 2
    v_and_b32 v4, 3, v1
    v_and_b32 v5, 1, v4
    v_lshlrev_b32 v5, 1, v5
    v_lshrrev_b32 v6, 1, v4
    v_or_b32 v4, v5, v6
    v_lshrrev_b32 v5, 1, v4
    v_and_b32 v4, 1, v4
    v_lshlrev_b32 v4, 3, v4
    v_lshrrev_b32 v6, 4, v1
    v_and_b32 v6, 1, v6
    v_lshlrev_b32 v6, 1, v6
    v_add_u32 v5, v5, v6
    s_mul_i32 s57, s26, 8
    v_add_u32 v5, s57, v5
    v_lshrrev_b32 v6, 2, v1
    v_and_b32 v6, 3, v6
    v_lshrrev_b32 v7, 5, v1
    v_lshlrev_b32 v7, 3, v7
    v_add_u32 v7, v7, v6
    s_mul_i32 s57, s24, 32
    v_add_u32 v7, s57, v7
    v_mul_u32_u24 v7, 128, v7
    v_add_u32 v7, v7, v4
    v_lshrrev_b32 v6, 1, v6
    v_lshlrev_b32 v6, 2, v6
    v_add_u32 v4, 0, v5
    v_xor_b32 v4, v4, v6
    v_lshlrev_b32 v4, 4, v4
    v_add_u32 v14, v7, v4
    v_add_u32 v4, 4, v5
    v_xor_b32 v4, v4, v6
    v_lshlrev_b32 v4, 4, v4
    v_add_u32 v15, v7, v4
    v_add_u32 v16, 40960, v14
    v_add_u32 v17, 40960, v15
    v_add_u32 v18, 81920, v14
    v_add_u32 v19, 81920, v15
    v_add_u32 v20, 122880, v14
    v_add_u32 v21, 122880, v15
    v_lshrrev_b32 v4, 5, v1
    s_mul_i32 s57, s24, 4
    v_add_u32 v4, s57, v4
    v_mul_u32_u24 v4, 4096, v4
    v_and_b32 v5, 31, v1
    v_lshlrev_b32 v5, 4, v5
    v_add_u32 v4, v4, v5
    s_mul_i32 s57, s27, 1024
    s_add_u32 s57, s57, 8192
    v_add_u32 v22, s57, v4
    v_add_u32 v23, 40960, v22
    v_add_u32 v24, 81920, v22
    v_add_u32 v25, 122880, v22
    v_mov_b32 v60, 0
    v_mov_b32 v61, 0
    v_mov_b32 v62, 0
    v_mov_b32 v63, 0
    v_mov_b32 v64, 0
    v_mov_b32 v65, 0
    v_mov_b32 v66, 0
    v_mov_b32 v67, 0
    v_mov_b32 v68, 0
    v_mov_b32 v69, 0
    v_mov_b32 v70, 0
    v_mov_b32 v71, 0
    v_mov_b32 v72, 0
    v_mov_b32 v73, 0
    v_mov_b32 v74, 0
    v_mov_b32 v75, 0
    v_mov_b32 v76, 0
    v_mov_b32 v77, 0
    v_mov_b32 v78, 0
    v_mov_b32 v79, 0
    v_mov_b32 v80, 0
    v_mov_b32 v81, 0
    v_mov_b32 v82, 0
    v_mov_b32 v83, 0
    v_mov_b32 v84, 0
    v_mov_b32 v85, 0
    v_mov_b32 v86, 0
    v_mov_b32 v87, 0
    v_mov_b32 v88, 0
    v_mov_b32 v89, 0
    v_mov_b32 v90, 0
    v_mov_b32 v91, 0
    v_mov_b32 v92, 0
    v_mov_b32 v93, 0
    v_mov_b32 v94, 0
    v_mov_b32 v95, 0
    v_mov_b32 v96, 0
    v_mov_b32 v97, 0
    v_mov_b32 v98, 0
    v_mov_b32 v99, 0
    v_mov_b32 v100, 0
    v_mov_b32 v101, 0
    v_mov_b32 v102, 0
    v_mov_b32 v103, 0
    v_mov_b32 v104, 0
    v_mov_b32 v105, 0
    v_mov_b32 v106, 0
    v_mov_b32 v107, 0
    v_mov_b32 v108, 0
    v_mov_b32 v109, 0
    v_mov_b32 v110, 0
    v_mov_b32 v111, 0
    v_mov_b32 v112, 0
    v_mov_b32 v113, 0
    v_mov_b32 v114, 0
    v_mov_b32 v115, 0
    v_mov_b32 v116, 0
    v_mov_b32 v117, 0
    v_mov_b32 v118, 0
    v_mov_b32 v119, 0
    v_mov_b32 v120, 0
    v_mov_b32 v121, 0
    v_mov_b32 v122, 0
    v_mov_b32 v123, 0
    s_waitcnt vmcnt(12)
    s_barrier
    ds_read_b128 v[36:39], v22 offset:0
    ds_read_b128 v[40:43], v22 offset:512
    ds_read_b64_tr_b16 v[28:29], v14 offset:0
    ds_read_b64_tr_b16 v[30:31], v14 offset:512
    ds_read_b64_tr_b16 v[32:33], v15 offset:0
    ds_read_b64_tr_b16 v[34:35], v15 offset:512
    s_waitcnt lgkmcnt(0)
    v_mfma_f32_32x32x16_bf16 v[60:75], v[28:31], v[36:39], v[60:75]
    ds_read_b128 v[52:55], v22 offset:8192
    ds_read_b128 v[56:59], v22 offset:8704
    v_mfma_f32_32x32x16_bf16 v[76:91], v[28:31], v[40:43], v[76:91]
    ds_read_b64_tr_b16 v[44:45], v14 offset:2048
    ds_read_b64_tr_b16 v[46:47], v14 offset:2560
    v_mfma_f32_32x32x16_bf16 v[92:107], v[32:35], v[36:39], v[92:107]
    ds_read_b64_tr_b16 v[48:49], v15 offset:2048
    ds_read_b64_tr_b16 v[50:51], v15 offset:2560
    v_mfma_f32_32x32x16_bf16 v[108:123], v[32:35], v[40:43], v[108:123]
    s_waitcnt vmcnt(8) lgkmcnt(0)
    s_barrier
    v_mfma_f32_32x32x16_bf16 v[60:75], v[44:47], v[52:55], v[60:75]
    ds_read_b128 v[36:39], v23 offset:0
    ds_read_b128 v[40:43], v23 offset:512
    v_mfma_f32_32x32x16_bf16 v[76:91], v[44:47], v[56:59], v[76:91]
    ds_read_b64_tr_b16 v[28:29], v16 offset:0
    ds_read_b64_tr_b16 v[30:31], v16 offset:512
    v_mfma_f32_32x32x16_bf16 v[92:107], v[48:51], v[52:55], v[92:107]
    ds_read_b64_tr_b16 v[32:33], v17 offset:0
    ds_read_b64_tr_b16 v[34:35], v17 offset:512
    v_mfma_f32_32x32x16_bf16 v[108:123], v[48:51], v[56:59], v[108:123]
    s_add_u32 m0, s53, 0
    s_add_u32 s54, s51, 884736
    buffer_load_dwordx4 v8, s[28:31], s54 offen sc1 lds
    s_add_u32 m0, s53, 8192
    s_add_u32 s54, s52, 65536
    buffer_load_dwordx4 v9, s[32:35], s54 offen sc1 lds
    s_add_u32 m0, s53, 16384
    s_add_u32 s54, s52, 65536
    buffer_load_dwordx4 v10, s[32:35], s54 offen sc1 lds
    s_add_u32 m0, s53, 24576
    s_add_u32 s54, s52, 65536
    buffer_load_dwordx4 v11, s[32:35], s54 offen sc1 lds
    s_add_u32 m0, s53, 32768
    s_add_u32 s54, s52, 65536
    buffer_load_dwordx4 v12, s[32:35], s54 offen sc1 lds
    s_waitcnt lgkmcnt(0)
    v_mfma_f32_32x32x16_bf16 v[60:75], v[28:31], v[36:39], v[60:75]
    ds_read_b128 v[52:55], v23 offset:8192
    ds_read_b128 v[56:59], v23 offset:8704
    v_mfma_f32_32x32x16_bf16 v[76:91], v[28:31], v[40:43], v[76:91]
    ds_read_b64_tr_b16 v[44:45], v16 offset:2048
    ds_read_b64_tr_b16 v[46:47], v16 offset:2560
    v_mfma_f32_32x32x16_bf16 v[92:107], v[32:35], v[36:39], v[92:107]
    ds_read_b64_tr_b16 v[48:49], v17 offset:2048
    ds_read_b64_tr_b16 v[50:51], v17 offset:2560
    v_mfma_f32_32x32x16_bf16 v[108:123], v[32:35], v[40:43], v[108:123]
    s_waitcnt vmcnt(9) lgkmcnt(0)
    s_barrier
    v_mfma_f32_32x32x16_bf16 v[60:75], v[44:47], v[52:55], v[60:75]
    ds_read_b128 v[36:39], v24 offset:0
    ds_read_b128 v[40:43], v24 offset:512
    v_mfma_f32_32x32x16_bf16 v[76:91], v[44:47], v[56:59], v[76:91]
    ds_read_b64_tr_b16 v[28:29], v18 offset:0
    ds_read_b64_tr_b16 v[30:31], v18 offset:512
    v_mfma_f32_32x32x16_bf16 v[92:107], v[48:51], v[52:55], v[92:107]
    ds_read_b64_tr_b16 v[32:33], v19 offset:0
    ds_read_b64_tr_b16 v[34:35], v19 offset:512
    v_mfma_f32_32x32x16_bf16 v[108:123], v[48:51], v[56:59], v[108:123]
    s_add_u32 m0, s53, 40960
    s_add_u32 s54, s51, 1105920
    buffer_load_dwordx4 v8, s[28:31], s54 offen sc1 lds
    s_add_u32 m0, s53, 49152
    s_add_u32 s54, s52, 81920
    buffer_load_dwordx4 v9, s[32:35], s54 offen sc1 lds
    s_add_u32 m0, s53, 57344
    s_add_u32 s54, s52, 81920
    buffer_load_dwordx4 v10, s[32:35], s54 offen sc1 lds
    s_add_u32 m0, s53, 65536
    s_add_u32 s54, s52, 81920
    buffer_load_dwordx4 v11, s[32:35], s54 offen sc1 lds
    s_add_u32 m0, s53, 73728
    s_add_u32 s54, s52, 81920
    buffer_load_dwordx4 v12, s[32:35], s54 offen sc1 lds
    s_waitcnt lgkmcnt(0)
    v_mfma_f32_32x32x16_bf16 v[60:75], v[28:31], v[36:39], v[60:75]
    ds_read_b128 v[52:55], v24 offset:8192
    ds_read_b128 v[56:59], v24 offset:8704
    v_mfma_f32_32x32x16_bf16 v[76:91], v[28:31], v[40:43], v[76:91]
    ds_read_b64_tr_b16 v[44:45], v18 offset:2048
    ds_read_b64_tr_b16 v[46:47], v18 offset:2560
    v_mfma_f32_32x32x16_bf16 v[92:107], v[32:35], v[36:39], v[92:107]
    ds_read_b64_tr_b16 v[48:49], v19 offset:2048
    ds_read_b64_tr_b16 v[50:51], v19 offset:2560
    v_mfma_f32_32x32x16_bf16 v[108:123], v[32:35], v[40:43], v[108:123]
    s_waitcnt vmcnt(10) lgkmcnt(0)
    s_barrier
    v_mfma_f32_32x32x16_bf16 v[60:75], v[44:47], v[52:55], v[60:75]
    ds_read_b128 v[36:39], v25 offset:0
    ds_read_b128 v[40:43], v25 offset:512
    v_mfma_f32_32x32x16_bf16 v[76:91], v[44:47], v[56:59], v[76:91]
    ds_read_b64_tr_b16 v[28:29], v20 offset:0
    ds_read_b64_tr_b16 v[30:31], v20 offset:512
    v_mfma_f32_32x32x16_bf16 v[92:107], v[48:51], v[52:55], v[92:107]
    ds_read_b64_tr_b16 v[32:33], v21 offset:0
    ds_read_b64_tr_b16 v[34:35], v21 offset:512
    v_mfma_f32_32x32x16_bf16 v[108:123], v[48:51], v[56:59], v[108:123]
    s_add_u32 m0, s53, 81920
    s_add_u32 s54, s51, 1327104
    buffer_load_dwordx4 v8, s[28:31], s54 offen sc1 lds
    s_add_u32 m0, s53, 90112
    s_add_u32 s54, s52, 98304
    buffer_load_dwordx4 v9, s[32:35], s54 offen sc1 lds
    s_add_u32 m0, s53, 98304
    s_add_u32 s54, s52, 98304
    buffer_load_dwordx4 v10, s[32:35], s54 offen sc1 lds
    s_add_u32 m0, s53, 106496
    s_add_u32 s54, s52, 98304
    buffer_load_dwordx4 v11, s[32:35], s54 offen sc1 lds
    s_add_u32 m0, s53, 114688
    s_add_u32 s54, s52, 98304
    buffer_load_dwordx4 v12, s[32:35], s54 offen sc1 lds
    s_waitcnt lgkmcnt(0)
    v_mfma_f32_32x32x16_bf16 v[60:75], v[28:31], v[36:39], v[60:75]
    ds_read_b128 v[52:55], v25 offset:8192
    ds_read_b128 v[56:59], v25 offset:8704
    v_mfma_f32_32x32x16_bf16 v[76:91], v[28:31], v[40:43], v[76:91]
    ds_read_b64_tr_b16 v[44:45], v20 offset:2048
    ds_read_b64_tr_b16 v[46:47], v20 offset:2560
    v_mfma_f32_32x32x16_bf16 v[92:107], v[32:35], v[36:39], v[92:107]
    ds_read_b64_tr_b16 v[48:49], v21 offset:2048
    ds_read_b64_tr_b16 v[50:51], v21 offset:2560
    v_mfma_f32_32x32x16_bf16 v[108:123], v[32:35], v[40:43], v[108:123]
    s_waitcnt vmcnt(10) lgkmcnt(0)
    s_barrier
    v_mfma_f32_32x32x16_bf16 v[60:75], v[44:47], v[52:55], v[60:75]
    ds_read_b128 v[36:39], v22 offset:0
    ds_read_b128 v[40:43], v22 offset:512
    v_mfma_f32_32x32x16_bf16 v[76:91], v[44:47], v[56:59], v[76:91]
    ds_read_b64_tr_b16 v[28:29], v14 offset:0
    ds_read_b64_tr_b16 v[30:31], v14 offset:512
    v_mfma_f32_32x32x16_bf16 v[92:107], v[48:51], v[52:55], v[92:107]
    ds_read_b64_tr_b16 v[32:33], v15 offset:0
    ds_read_b64_tr_b16 v[34:35], v15 offset:512
    v_mfma_f32_32x32x16_bf16 v[108:123], v[48:51], v[56:59], v[108:123]
    s_add_u32 m0, s53, 122880
    s_add_u32 s54, s51, 1548288
    buffer_load_dwordx4 v8, s[28:31], s54 offen sc1 lds
    s_add_u32 m0, s53, 131072
    s_add_u32 s54, s52, 114688
    buffer_load_dwordx4 v9, s[32:35], s54 offen sc1 lds
    s_add_u32 m0, s53, 139264
    s_add_u32 s54, s52, 114688
    buffer_load_dwordx4 v10, s[32:35], s54 offen sc1 lds
    s_add_u32 m0, s53, 147456
    s_add_u32 s54, s52, 114688
    buffer_load_dwordx4 v11, s[32:35], s54 offen sc1 lds
    s_add_u32 m0, s53, 155648
    s_add_u32 s54, s52, 114688
    buffer_load_dwordx4 v12, s[32:35], s54 offen sc1 lds
    s_waitcnt lgkmcnt(0)
    v_mfma_f32_32x32x16_bf16 v[60:75], v[28:31], v[36:39], v[60:75]
    ds_read_b128 v[52:55], v22 offset:8192
    ds_read_b128 v[56:59], v22 offset:8704
    v_mfma_f32_32x32x16_bf16 v[76:91], v[28:31], v[40:43], v[76:91]
    ds_read_b64_tr_b16 v[44:45], v14 offset:2048
    ds_read_b64_tr_b16 v[46:47], v14 offset:2560
    v_mfma_f32_32x32x16_bf16 v[92:107], v[32:35], v[36:39], v[92:107]
    ds_read_b64_tr_b16 v[48:49], v15 offset:2048
    ds_read_b64_tr_b16 v[50:51], v15 offset:2560
    v_mfma_f32_32x32x16_bf16 v[108:123], v[32:35], v[40:43], v[108:123]
    s_waitcnt vmcnt(10) lgkmcnt(0)
    s_barrier
    v_mfma_f32_32x32x16_bf16 v[60:75], v[44:47], v[52:55], v[60:75]
    ds_read_b128 v[36:39], v23 offset:0
    ds_read_b128 v[40:43], v23 offset:512
    v_mfma_f32_32x32x16_bf16 v[76:91], v[44:47], v[56:59], v[76:91]
    ds_read_b64_tr_b16 v[28:29], v16 offset:0
    ds_read_b64_tr_b16 v[30:31], v16 offset:512
    v_mfma_f32_32x32x16_bf16 v[92:107], v[48:51], v[52:55], v[92:107]
    ds_read_b64_tr_b16 v[32:33], v17 offset:0
    ds_read_b64_tr_b16 v[34:35], v17 offset:512
    v_mfma_f32_32x32x16_bf16 v[108:123], v[48:51], v[56:59], v[108:123]
    s_add_u32 m0, s53, 0
    s_add_u32 s54, s51, 1769472
    buffer_load_dwordx4 v8, s[28:31], s54 offen sc1 lds
    s_add_u32 m0, s53, 8192
    s_add_u32 s54, s52, 131072
    buffer_load_dwordx4 v9, s[32:35], s54 offen sc1 lds
    s_add_u32 m0, s53, 16384
    s_add_u32 s54, s52, 131072
    buffer_load_dwordx4 v10, s[32:35], s54 offen sc1 lds
    s_add_u32 m0, s53, 24576
    s_add_u32 s54, s52, 131072
    buffer_load_dwordx4 v11, s[32:35], s54 offen sc1 lds
    s_add_u32 m0, s53, 32768
    s_add_u32 s54, s52, 131072
    buffer_load_dwordx4 v12, s[32:35], s54 offen sc1 lds
    s_waitcnt lgkmcnt(0)
    v_mfma_f32_32x32x16_bf16 v[60:75], v[28:31], v[36:39], v[60:75]
    ds_read_b128 v[52:55], v23 offset:8192
    ds_read_b128 v[56:59], v23 offset:8704
    v_mfma_f32_32x32x16_bf16 v[76:91], v[28:31], v[40:43], v[76:91]
    ds_read_b64_tr_b16 v[44:45], v16 offset:2048
    ds_read_b64_tr_b16 v[46:47], v16 offset:2560
    v_mfma_f32_32x32x16_bf16 v[92:107], v[32:35], v[36:39], v[92:107]
    ds_read_b64_tr_b16 v[48:49], v17 offset:2048
    ds_read_b64_tr_b16 v[50:51], v17 offset:2560
    v_mfma_f32_32x32x16_bf16 v[108:123], v[32:35], v[40:43], v[108:123]
    s_waitcnt vmcnt(10) lgkmcnt(0)
    s_barrier
    v_mfma_f32_32x32x16_bf16 v[60:75], v[44:47], v[52:55], v[60:75]
    ds_read_b128 v[36:39], v24 offset:0
    ds_read_b128 v[40:43], v24 offset:512
    v_mfma_f32_32x32x16_bf16 v[76:91], v[44:47], v[56:59], v[76:91]
    ds_read_b64_tr_b16 v[28:29], v18 offset:0
    ds_read_b64_tr_b16 v[30:31], v18 offset:512
    v_mfma_f32_32x32x16_bf16 v[92:107], v[48:51], v[52:55], v[92:107]
    ds_read_b64_tr_b16 v[32:33], v19 offset:0
    ds_read_b64_tr_b16 v[34:35], v19 offset:512
    v_mfma_f32_32x32x16_bf16 v[108:123], v[48:51], v[56:59], v[108:123]
    s_add_u32 m0, s53, 40960
    s_add_u32 s54, s51, 1990656
    buffer_load_dwordx4 v8, s[28:31], s54 offen sc1 lds
    s_add_u32 m0, s53, 49152
    s_add_u32 s54, s52, 147456
    buffer_load_dwordx4 v9, s[32:35], s54 offen sc1 lds
    s_add_u32 m0, s53, 57344
    s_add_u32 s54, s52, 147456
    buffer_load_dwordx4 v10, s[32:35], s54 offen sc1 lds
    s_add_u32 m0, s53, 65536
    s_add_u32 s54, s52, 147456
    buffer_load_dwordx4 v11, s[32:35], s54 offen sc1 lds
    s_add_u32 m0, s53, 73728
    s_add_u32 s54, s52, 147456
    buffer_load_dwordx4 v12, s[32:35], s54 offen sc1 lds
    s_waitcnt lgkmcnt(0)
    v_mfma_f32_32x32x16_bf16 v[60:75], v[28:31], v[36:39], v[60:75]
    ds_read_b128 v[52:55], v24 offset:8192
    ds_read_b128 v[56:59], v24 offset:8704
    v_mfma_f32_32x32x16_bf16 v[76:91], v[28:31], v[40:43], v[76:91]
    ds_read_b64_tr_b16 v[44:45], v18 offset:2048
    ds_read_b64_tr_b16 v[46:47], v18 offset:2560
    v_mfma_f32_32x32x16_bf16 v[92:107], v[32:35], v[36:39], v[92:107]
    ds_read_b64_tr_b16 v[48:49], v19 offset:2048
    ds_read_b64_tr_b16 v[50:51], v19 offset:2560
    v_mfma_f32_32x32x16_bf16 v[108:123], v[32:35], v[40:43], v[108:123]
    s_waitcnt vmcnt(10) lgkmcnt(0)
    s_barrier
    v_mfma_f32_32x32x16_bf16 v[60:75], v[44:47], v[52:55], v[60:75]
    ds_read_b128 v[36:39], v25 offset:0
    ds_read_b128 v[40:43], v25 offset:512
    v_mfma_f32_32x32x16_bf16 v[76:91], v[44:47], v[56:59], v[76:91]
    ds_read_b64_tr_b16 v[28:29], v20 offset:0
    ds_read_b64_tr_b16 v[30:31], v20 offset:512
    v_mfma_f32_32x32x16_bf16 v[92:107], v[48:51], v[52:55], v[92:107]
    ds_read_b64_tr_b16 v[32:33], v21 offset:0
    ds_read_b64_tr_b16 v[34:35], v21 offset:512
    v_mfma_f32_32x32x16_bf16 v[108:123], v[48:51], v[56:59], v[108:123]
    s_waitcnt lgkmcnt(0)
    v_mfma_f32_32x32x16_bf16 v[60:75], v[28:31], v[36:39], v[60:75]
    ds_read_b128 v[52:55], v25 offset:8192
    ds_read_b128 v[56:59], v25 offset:8704
    v_mfma_f32_32x32x16_bf16 v[76:91], v[28:31], v[40:43], v[76:91]
    ds_read_b64_tr_b16 v[44:45], v20 offset:2048
    ds_read_b64_tr_b16 v[46:47], v20 offset:2560
    v_mfma_f32_32x32x16_bf16 v[92:107], v[32:35], v[36:39], v[92:107]
    ds_read_b64_tr_b16 v[48:49], v21 offset:2048
    ds_read_b64_tr_b16 v[50:51], v21 offset:2560
    v_mfma_f32_32x32x16_bf16 v[108:123], v[32:35], v[40:43], v[108:123]
    s_waitcnt vmcnt(5) lgkmcnt(0)
    s_barrier
    v_mfma_f32_32x32x16_bf16 v[60:75], v[44:47], v[52:55], v[60:75]
    ds_read_b128 v[36:39], v22 offset:0
    ds_read_b128 v[40:43], v22 offset:512
    v_mfma_f32_32x32x16_bf16 v[76:91], v[44:47], v[56:59], v[76:91]
    ds_read_b64_tr_b16 v[28:29], v14 offset:0
    ds_read_b64_tr_b16 v[30:31], v14 offset:512
    v_mfma_f32_32x32x16_bf16 v[92:107], v[48:51], v[52:55], v[92:107]
    ds_read_b64_tr_b16 v[32:33], v15 offset:0
    ds_read_b64_tr_b16 v[34:35], v15 offset:512
    v_mfma_f32_32x32x16_bf16 v[108:123], v[48:51], v[56:59], v[108:123]
    s_waitcnt lgkmcnt(0)
    v_mfma_f32_32x32x16_bf16 v[60:75], v[28:31], v[36:39], v[60:75]
    ds_read_b128 v[52:55], v22 offset:8192
    ds_read_b128 v[56:59], v22 offset:8704
    v_mfma_f32_32x32x16_bf16 v[76:91], v[28:31], v[40:43], v[76:91]
    ds_read_b64_tr_b16 v[44:45], v14 offset:2048
    ds_read_b64_tr_b16 v[46:47], v14 offset:2560
    v_mfma_f32_32x32x16_bf16 v[92:107], v[32:35], v[36:39], v[92:107]
    ds_read_b64_tr_b16 v[48:49], v15 offset:2048
    ds_read_b64_tr_b16 v[50:51], v15 offset:2560
    v_mfma_f32_32x32x16_bf16 v[108:123], v[32:35], v[40:43], v[108:123]
    s_waitcnt vmcnt(0) lgkmcnt(0)
    s_barrier
    v_mfma_f32_32x32x16_bf16 v[60:75], v[44:47], v[52:55], v[60:75]
    ds_read_b128 v[36:39], v23 offset:0
    ds_read_b128 v[40:43], v23 offset:512
    v_mfma_f32_32x32x16_bf16 v[76:91], v[44:47], v[56:59], v[76:91]
    ds_read_b64_tr_b16 v[28:29], v16 offset:0
    ds_read_b64_tr_b16 v[30:31], v16 offset:512
    v_mfma_f32_32x32x16_bf16 v[92:107], v[48:51], v[52:55], v[92:107]
    ds_read_b64_tr_b16 v[32:33], v17 offset:0
    ds_read_b64_tr_b16 v[34:35], v17 offset:512
    v_mfma_f32_32x32x16_bf16 v[108:123], v[48:51], v[56:59], v[108:123]
    s_waitcnt lgkmcnt(0)
    v_mfma_f32_32x32x16_bf16 v[60:75], v[28:31], v[36:39], v[60:75]
    ds_read_b128 v[52:55], v23 offset:8192
    ds_read_b128 v[56:59], v23 offset:8704
    v_mfma_f32_32x32x16_bf16 v[76:91], v[28:31], v[40:43], v[76:91]
    ds_read_b64_tr_b16 v[44:45], v16 offset:2048
    ds_read_b64_tr_b16 v[46:47], v16 offset:2560
    v_mfma_f32_32x32x16_bf16 v[92:107], v[32:35], v[36:39], v[92:107]
    ds_read_b64_tr_b16 v[48:49], v17 offset:2048
    ds_read_b64_tr_b16 v[50:51], v17 offset:2560
    v_mfma_f32_32x32x16_bf16 v[108:123], v[32:35], v[40:43], v[108:123]
    s_waitcnt lgkmcnt(0)
    v_mfma_f32_32x32x16_bf16 v[60:75], v[44:47], v[52:55], v[60:75]
    v_mfma_f32_32x32x16_bf16 v[76:91], v[44:47], v[56:59], v[76:91]
    v_mfma_f32_32x32x16_bf16 v[92:107], v[48:51], v[52:55], v[92:107]
    v_mfma_f32_32x32x16_bf16 v[108:123], v[48:51], v[56:59], v[108:123]
    s_barrier
    s_mul_i32 s57, s25, 8192
    s_add_u32 s58, s25, 4
    s_cmp_ge_u32 s58, 8
    s_cselect_b32 s59, 8, 0
    s_sub_u32 s58, s58, s59
    s_mul_i32 s58, s58, 8192
    v_lshlrev_b32 v4, 4, v1
    v_add_u32 v5, s58, v4
    v_add_u32 v4, s57, v4
    s_cmp_lt_u32 s25, 4
    s_cbranch_scc0 ffn1_kernel_red1
    ds_write_b128 v4, v[92:95] offset:0
    ds_write_b128 v4, v[96:99] offset:1024
    ds_write_b128 v4, v[100:103] offset:2048
    ds_write_b128 v4, v[104:107] offset:3072
    ds_write_b128 v4, v[108:111] offset:4096
    ds_write_b128 v4, v[112:115] offset:5120
    ds_write_b128 v4, v[116:119] offset:6144
    ds_write_b128 v4, v[120:123] offset:7168
    s_waitcnt lgkmcnt(0)
    s_barrier
    ds_read_b128 v[92:95], v5 offset:0
    ds_read_b128 v[96:99], v5 offset:1024
    ds_read_b128 v[100:103], v5 offset:2048
    ds_read_b128 v[104:107], v5 offset:3072
    ds_read_b128 v[108:111], v5 offset:4096
    ds_read_b128 v[112:115], v5 offset:5120
    ds_read_b128 v[116:119], v5 offset:6144
    ds_read_b128 v[120:123], v5 offset:7168
    s_waitcnt lgkmcnt(0)
    v_add_f32 v60, v60, v92
    v_add_f32 v61, v61, v93
    v_add_f32 v62, v62, v94
    v_add_f32 v63, v63, v95
    v_add_f32 v64, v64, v96
    v_add_f32 v65, v65, v97
    v_add_f32 v66, v66, v98
    v_add_f32 v67, v67, v99
    v_add_f32 v68, v68, v100
    v_add_f32 v69, v69, v101
    v_add_f32 v70, v70, v102
    v_add_f32 v71, v71, v103
    v_add_f32 v72, v72, v104
    v_add_f32 v73, v73, v105
    v_add_f32 v74, v74, v106
    v_add_f32 v75, v75, v107
    v_add_f32 v76, v76, v108
    v_add_f32 v77, v77, v109
    v_add_f32 v78, v78, v110
    v_add_f32 v79, v79, v111
    v_add_f32 v80, v80, v112
    v_add_f32 v81, v81, v113
    v_add_f32 v82, v82, v114
    v_add_f32 v83, v83, v115
    v_add_f32 v84, v84, v116
    v_add_f32 v85, v85, v117
    v_add_f32 v86, v86, v118
    v_add_f32 v87, v87, v119
    v_add_f32 v88, v88, v120
    v_add_f32 v89, v89, v121
    v_add_f32 v90, v90, v122
    v_add_f32 v91, v91, v123
    s_add_u32 s36, s12, 0x5c00000
    s_addc_u32 s37, s13, 0
    s_mov_b32 s38, 0x6c0000
    s_mov_b32 s39, 0x00020000
    s_mov_b32 s40, s14
    s_mov_b32 s41, s15
    s_mov_b32 s42, 0xd80
    s_mov_b32 s43, 0x00020000
    v_mov_b32 v6, 0xbdd2d3e8
    s_mov_b32 s63, 0xc0135761
    v_lshrrev_b32 v4, 5, v1
    v_lshlrev_b32 v5, 4, v4
    s_lshl_b32 s57, s20, 1
    buffer_load_dwordx4 v[28:31], v5, s[40:43], s57 offen offset:0 sc1
    buffer_load_dwordx4 v[32:35], v5, s[40:43], s57 offen offset:32 sc1
    s_lshl_b32 s58, s27, 6
    s_add_u32 s58, s58, s21
    s_lshr_b32 s59, s58, 7
    s_mul_i32 s59, s59, 216
    s_lshr_b32 s60, s20, 3
    s_add_u32 s59, s59, s60
    s_lshl_b32 s59, s59, 11
    s_and_b32 s58, s58, 127
    s_lshl_b32 s58, s58, 4
    s_add_u32 s59, s59, s58
    v_lshlrev_b32 v4, 11, v4
    v_and_b32 v5, 31, v1
    v_lshlrev_b32 v5, 4, v5
    v_add_u32 v4, v4, v5
    v_add_u32 v4, s59, v4
    s_waitcnt vmcnt(0)
    v_lshlrev_b32 v44, 16, v28
    v_and_b32 v45, 0xffff0000, v28
    v_lshlrev_b32 v46, 16, v29
    v_and_b32 v47, 0xffff0000, v29
    v_lshlrev_b32 v48, 16, v30
    v_and_b32 v49, 0xffff0000, v30
    v_lshlrev_b32 v50, 16, v31
    v_and_b32 v51, 0xffff0000, v31
    v_add_f32 v60, v60, v44
    v_add_f32 v61, v61, v45
    v_add_f32 v62, v62, v46
    v_add_f32 v63, v63, v47
    v_add_f32 v64, v64, v48
    v_add_f32 v65, v65, v49
    v_add_f32 v66, v66, v50
    v_add_f32 v67, v67, v51
    v_mul_f32 v52, v60, v60
    v_mul_f32 v53, v61, v61
    v_mul_f32 v54, v62, v62
    v_mul_f32 v55, v63, v63
    v_fmaak_f32 v52, v6, v52, 0xc0135761
    v_fmaak_f32 v53, v6, v53, 0xc0135761
    v_fmaak_f32 v54, v6, v54, 0xc0135761
    v_fmaak_f32 v55, v6, v55, 0xc0135761
    v_mul_f32 v52, v52, v60
    v_mul_f32 v53, v53, v61
    v_mul_f32 v54, v54, v62
    v_mul_f32 v55, v55, v63
    v_exp_f32 v52, v52
    v_exp_f32 v53, v53
    v_exp_f32 v54, v54
    v_exp_f32 v55, v55
    v_add_f32 v52, 1.0, v52
    v_add_f32 v53, 1.0, v53
    v_add_f32 v54, 1.0, v54
    v_add_f32 v55, 1.0, v55
    v_rcp_f32 v52, v52
    v_rcp_f32 v53, v53
    v_rcp_f32 v54, v54
    v_rcp_f32 v55, v55
    v_mul_f32 v60, v60, v52
    v_mul_f32 v61, v61, v53
    v_mul_f32 v62, v62, v54
    v_mul_f32 v63, v63, v55
    v_mul_f32 v52, v64, v64
    v_mul_f32 v53, v65, v65
    v_mul_f32 v54, v66, v66
    v_mul_f32 v55, v67, v67
    v_fmaak_f32 v52, v6, v52, 0xc0135761
    v_fmaak_f32 v53, v6, v53, 0xc0135761
    v_fmaak_f32 v54, v6, v54, 0xc0135761
    v_fmaak_f32 v55, v6, v55, 0xc0135761
    v_mul_f32 v52, v52, v64
    v_mul_f32 v53, v53, v65
    v_mul_f32 v54, v54, v66
    v_mul_f32 v55, v55, v67
    v_exp_f32 v52, v52
    v_exp_f32 v53, v53
    v_exp_f32 v54, v54
    v_exp_f32 v55, v55
    v_add_f32 v52, 1.0, v52
    v_add_f32 v53, 1.0, v53
    v_add_f32 v54, 1.0, v54
    v_add_f32 v55, 1.0, v55
    v_rcp_f32 v52, v52
    v_rcp_f32 v53, v53
    v_rcp_f32 v54, v54
    v_rcp_f32 v55, v55
    v_mul_f32 v64, v64, v52
    v_mul_f32 v65, v65, v53
    v_mul_f32 v66, v66, v54
    v_mul_f32 v67, v67, v55
    v_cvt_pk_bf16_f32 v60, v60, v61
    v_cvt_pk_bf16_f32 v61, v62, v63
    v_cvt_pk_bf16_f32 v62, v64, v65
    v_cvt_pk_bf16_f32 v63, v66, v67
    s_mov_b32 s60, 0
    buffer_store_dwordx4 v[60:63], v4, s[36:39], s60 offen sc1
    v_add_f32 v76, v76, v44
    v_add_f32 v77, v77, v45
    v_add_f32 v78, v78, v46
    v_add_f32 v79, v79, v47
    v_add_f32 v80, v80, v48
    v_add_f32 v81, v81, v49
    v_add_f32 v82, v82, v50
    v_add_f32 v83, v83, v51
    v_mul_f32 v52, v76, v76
    v_mul_f32 v53, v77, v77
    v_mul_f32 v54, v78, v78
    v_mul_f32 v55, v79, v79
    v_fmaak_f32 v52, v6, v52, 0xc0135761
    v_fmaak_f32 v53, v6, v53, 0xc0135761
    v_fmaak_f32 v54, v6, v54, 0xc0135761
    v_fmaak_f32 v55, v6, v55, 0xc0135761
    v_mul_f32 v52, v52, v76
    v_mul_f32 v53, v53, v77
    v_mul_f32 v54, v54, v78
    v_mul_f32 v55, v55, v79
    v_exp_f32 v52, v52
    v_exp_f32 v53, v53
    v_exp_f32 v54, v54
    v_exp_f32 v55, v55
    v_add_f32 v52, 1.0, v52
    v_add_f32 v53, 1.0, v53
    v_add_f32 v54, 1.0, v54
    v_add_f32 v55, 1.0, v55
    v_rcp_f32 v52, v52
    v_rcp_f32 v53, v53
    v_rcp_f32 v54, v54
    v_rcp_f32 v55, v55
    v_mul_f32 v76, v76, v52
    v_mul_f32 v77, v77, v53
    v_mul_f32 v78, v78, v54
    v_mul_f32 v79, v79, v55
    v_mul_f32 v52, v80, v80
    v_mul_f32 v53, v81, v81
    v_mul_f32 v54, v82, v82
    v_mul_f32 v55, v83, v83
    v_fmaak_f32 v52, v6, v52, 0xc0135761
    v_fmaak_f32 v53, v6, v53, 0xc0135761
    v_fmaak_f32 v54, v6, v54, 0xc0135761
    v_fmaak_f32 v55, v6, v55, 0xc0135761
    v_mul_f32 v52, v52, v80
    v_mul_f32 v53, v53, v81
    v_mul_f32 v54, v54, v82
    v_mul_f32 v55, v55, v83
    v_exp_f32 v52, v52
    v_exp_f32 v53, v53
    v_exp_f32 v54, v54
    v_exp_f32 v55, v55
    v_add_f32 v52, 1.0, v52
    v_add_f32 v53, 1.0, v53
    v_add_f32 v54, 1.0, v54
    v_add_f32 v55, 1.0, v55
    v_rcp_f32 v52, v52
    v_rcp_f32 v53, v53
    v_rcp_f32 v54, v54
    v_rcp_f32 v55, v55
    v_mul_f32 v80, v80, v52
    v_mul_f32 v81, v81, v53
    v_mul_f32 v82, v82, v54
    v_mul_f32 v83, v83, v55
    v_cvt_pk_bf16_f32 v76, v76, v77
    v_cvt_pk_bf16_f32 v77, v78, v79
    v_cvt_pk_bf16_f32 v78, v80, v81
    v_cvt_pk_bf16_f32 v79, v82, v83
    s_mov_b32 s60, 512
    buffer_store_dwordx4 v[76:79], v4, s[36:39], s60 offen sc1
    v_lshlrev_b32 v44, 16, v32
    v_and_b32 v45, 0xffff0000, v32
    v_lshlrev_b32 v46, 16, v33
    v_and_b32 v47, 0xffff0000, v33
    v_lshlrev_b32 v48, 16, v34
    v_and_b32 v49, 0xffff0000, v34
    v_lshlrev_b32 v50, 16, v35
    v_and_b32 v51, 0xffff0000, v35
    v_add_f32 v68, v68, v44
    v_add_f32 v69, v69, v45
    v_add_f32 v70, v70, v46
    v_add_f32 v71, v71, v47
    v_add_f32 v72, v72, v48
    v_add_f32 v73, v73, v49
    v_add_f32 v74, v74, v50
    v_add_f32 v75, v75, v51
    v_mul_f32 v52, v68, v68
    v_mul_f32 v53, v69, v69
    v_mul_f32 v54, v70, v70
    v_mul_f32 v55, v71, v71
    v_fmaak_f32 v52, v6, v52, 0xc0135761
    v_fmaak_f32 v53, v6, v53, 0xc0135761
    v_fmaak_f32 v54, v6, v54, 0xc0135761
    v_fmaak_f32 v55, v6, v55, 0xc0135761
    v_mul_f32 v52, v52, v68
    v_mul_f32 v53, v53, v69
    v_mul_f32 v54, v54, v70
    v_mul_f32 v55, v55, v71
    v_exp_f32 v52, v52
    v_exp_f32 v53, v53
    v_exp_f32 v54, v54
    v_exp_f32 v55, v55
    v_add_f32 v52, 1.0, v52
    v_add_f32 v53, 1.0, v53
    v_add_f32 v54, 1.0, v54
    v_add_f32 v55, 1.0, v55
    v_rcp_f32 v52, v52
    v_rcp_f32 v53, v53
    v_rcp_f32 v54, v54
    v_rcp_f32 v55, v55
    v_mul_f32 v68, v68, v52
    v_mul_f32 v69, v69, v53
    v_mul_f32 v70, v70, v54
    v_mul_f32 v71, v71, v55
    v_mul_f32 v52, v72, v72
    v_mul_f32 v53, v73, v73
    v_mul_f32 v54, v74, v74
    v_mul_f32 v55, v75, v75
    v_fmaak_f32 v52, v6, v52, 0xc0135761
    v_fmaak_f32 v53, v6, v53, 0xc0135761
    v_fmaak_f32 v54, v6, v54, 0xc0135761
    v_fmaak_f32 v55, v6, v55, 0xc0135761
    v_mul_f32 v52, v52, v72
    v_mul_f32 v53, v53, v73
    v_mul_f32 v54, v54, v74
    v_mul_f32 v55, v55, v75
    v_exp_f32 v52, v52
    v_exp_f32 v53, v53
    v_exp_f32 v54, v54
    v_exp_f32 v55, v55
    v_add_f32 v52, 1.0, v52
    v_add_f32 v53, 1.0, v53
    v_add_f32 v54, 1.0, v54
    v_add_f32 v55, 1.0, v55
    v_rcp_f32 v52, v52
    v_rcp_f32 v53, v53
    v_rcp_f32 v54, v54
    v_rcp_f32 v55, v55
    v_mul_f32 v72, v72, v52
    v_mul_f32 v73, v73, v53
    v_mul_f32 v74, v74, v54
    v_mul_f32 v75, v75, v55
    v_cvt_pk_bf16_f32 v68, v68, v69
    v_cvt_pk_bf16_f32 v69, v70, v71
    v_cvt_pk_bf16_f32 v70, v72, v73
    v_cvt_pk_bf16_f32 v71, v74, v75
    s_mov_b32 s60, 4096
    buffer_store_dwordx4 v[68:71], v4, s[36:39], s60 offen sc1
    v_add_f32 v84, v84, v44
    v_add_f32 v85, v85, v45
    v_add_f32 v86, v86, v46
    v_add_f32 v87, v87, v47
    v_add_f32 v88, v88, v48
    v_add_f32 v89, v89, v49
    v_add_f32 v90, v90, v50
    v_add_f32 v91, v91, v51
    v_mul_f32 v52, v84, v84
    v_mul_f32 v53, v85, v85
    v_mul_f32 v54, v86, v86
    v_mul_f32 v55, v87, v87
    v_fmaak_f32 v52, v6, v52, 0xc0135761
    v_fmaak_f32 v53, v6, v53, 0xc0135761
    v_fmaak_f32 v54, v6, v54, 0xc0135761
    v_fmaak_f32 v55, v6, v55, 0xc0135761
    v_mul_f32 v52, v52, v84
    v_mul_f32 v53, v53, v85
    v_mul_f32 v54, v54, v86
    v_mul_f32 v55, v55, v87
    v_exp_f32 v52, v52
    v_exp_f32 v53, v53
    v_exp_f32 v54, v54
    v_exp_f32 v55, v55
    v_add_f32 v52, 1.0, v52
    v_add_f32 v53, 1.0, v53
    v_add_f32 v54, 1.0, v54
    v_add_f32 v55, 1.0, v55
    v_rcp_f32 v52, v52
    v_rcp_f32 v53, v53
    v_rcp_f32 v54, v54
    v_rcp_f32 v55, v55
    v_mul_f32 v84, v84, v52
    v_mul_f32 v85, v85, v53
    v_mul_f32 v86, v86, v54
    v_mul_f32 v87, v87, v55
    v_mul_f32 v52, v88, v88
    v_mul_f32 v53, v89, v89
    v_mul_f32 v54, v90, v90
    v_mul_f32 v55, v91, v91
    v_fmaak_f32 v52, v6, v52, 0xc0135761
    v_fmaak_f32 v53, v6, v53, 0xc0135761
    v_fmaak_f32 v54, v6, v54, 0xc0135761
    v_fmaak_f32 v55, v6, v55, 0xc0135761
    v_mul_f32 v52, v52, v88
    v_mul_f32 v53, v53, v89
    v_mul_f32 v54, v54, v90
    v_mul_f32 v55, v55, v91
    v_exp_f32 v52, v52
    v_exp_f32 v53, v53
    v_exp_f32 v54, v54
    v_exp_f32 v55, v55
    v_add_f32 v52, 1.0, v52
    v_add_f32 v53, 1.0, v53
    v_add_f32 v54, 1.0, v54
    v_add_f32 v55, 1.0, v55
    v_rcp_f32 v52, v52
    v_rcp_f32 v53, v53
    v_rcp_f32 v54, v54
    v_rcp_f32 v55, v55
    v_mul_f32 v88, v88, v52
    v_mul_f32 v89, v89, v53
    v_mul_f32 v90, v90, v54
    v_mul_f32 v91, v91, v55
    v_cvt_pk_bf16_f32 v84, v84, v85
    v_cvt_pk_bf16_f32 v85, v86, v87
    v_cvt_pk_bf16_f32 v86, v88, v89
    v_cvt_pk_bf16_f32 v87, v90, v91
    s_mov_b32 s60, 4608
    buffer_store_dwordx4 v[84:87], v4, s[36:39], s60 offen sc1
    s_branch ffn1_kernel_fin
ffn1_kernel_red1:
    ds_write_b128 v4, v[60:63] offset:0
    ds_write_b128 v4, v[64:67] offset:1024
    ds_write_b128 v4, v[68:71] offset:2048
    ds_write_b128 v4, v[72:75] offset:3072
    ds_write_b128 v4, v[76:79] offset:4096
    ds_write_b128 v4, v[80:83] offset:5120
    ds_write_b128 v4, v[84:87] offset:6144
    ds_write_b128 v4, v[88:91] offset:7168
    s_waitcnt lgkmcnt(0)
    s_barrier
    ds_read_b128 v[60:63], v5 offset:0
    ds_read_b128 v[64:67], v5 offset:1024
    ds_read_b128 v[68:71], v5 offset:2048
    ds_read_b128 v[72:75], v5 offset:3072
    ds_read_b128 v[76:79], v5 offset:4096
    ds_read_b128 v[80:83], v5 offset:5120
    ds_read_b128 v[84:87], v5 offset:6144
    ds_read_b128 v[88:91], v5 offset:7168
    s_waitcnt lgkmcnt(0)
    v_add_f32 v92, v92, v60
    v_add_f32 v93, v93, v61
    v_add_f32 v94, v94, v62
    v_add_f32 v95, v95, v63
    v_add_f32 v96, v96, v64
    v_add_f32 v97, v97, v65
    v_add_f32 v98, v98, v66
    v_add_f32 v99, v99, v67
    v_add_f32 v100, v100, v68
    v_add_f32 v101, v101, v69
    v_add_f32 v102, v102, v70
    v_add_f32 v103, v103, v71
    v_add_f32 v104, v104, v72
    v_add_f32 v105, v105, v73
    v_add_f32 v106, v106, v74
    v_add_f32 v107, v107, v75
    v_add_f32 v108, v108, v76
    v_add_f32 v109, v109, v77
    v_add_f32 v110, v110, v78
    v_add_f32 v111, v111, v79
    v_add_f32 v112, v112, v80
    v_add_f32 v113, v113, v81
    v_add_f32 v114, v114, v82
    v_add_f32 v115, v115, v83
    v_add_f32 v116, v116, v84
    v_add_f32 v117, v117, v85
    v_add_f32 v118, v118, v86
    v_add_f32 v119, v119, v87
    v_add_f32 v120, v120, v88
    v_add_f32 v121, v121, v89
    v_add_f32 v122, v122, v90
    v_add_f32 v123, v123, v91
    s_add_u32 s36, s12, 0x5c00000
    s_addc_u32 s37, s13, 0
    s_mov_b32 s38, 0x6c0000
    s_mov_b32 s39, 0x00020000
    s_mov_b32 s40, s14
    s_mov_b32 s41, s15
    s_mov_b32 s42, 0xd80
    s_mov_b32 s43, 0x00020000
    v_mov_b32 v6, 0xbdd2d3e8
    s_mov_b32 s63, 0xc0135761
    v_lshrrev_b32 v4, 5, v1
    v_lshlrev_b32 v5, 4, v4
    s_lshl_b32 s57, s20, 1
    buffer_load_dwordx4 v[36:39], v5, s[40:43], s57 offen offset:64 sc1
    buffer_load_dwordx4 v[40:43], v5, s[40:43], s57 offen offset:96 sc1
    s_lshl_b32 s58, s27, 6
    s_add_u32 s58, s58, s21
    s_lshr_b32 s59, s58, 7
    s_mul_i32 s59, s59, 216
    s_lshr_b32 s60, s20, 3
    s_add_u32 s59, s59, s60
    s_lshl_b32 s59, s59, 11
    s_and_b32 s58, s58, 127
    s_lshl_b32 s58, s58, 4
    s_add_u32 s59, s59, s58
    v_lshlrev_b32 v4, 11, v4
    v_and_b32 v5, 31, v1
    v_lshlrev_b32 v5, 4, v5
    v_add_u32 v4, v4, v5
    v_add_u32 v4, s59, v4
    s_waitcnt vmcnt(0)
    v_lshlrev_b32 v44, 16, v36
    v_and_b32 v45, 0xffff0000, v36
    v_lshlrev_b32 v46, 16, v37
    v_and_b32 v47, 0xffff0000, v37
    v_lshlrev_b32 v48, 16, v38
    v_and_b32 v49, 0xffff0000, v38
    v_lshlrev_b32 v50, 16, v39
    v_and_b32 v51, 0xffff0000, v39
    v_add_f32 v92, v92, v44
    v_add_f32 v93, v93, v45
    v_add_f32 v94, v94, v46
    v_add_f32 v95, v95, v47
    v_add_f32 v96, v96, v48
    v_add_f32 v97, v97, v49
    v_add_f32 v98, v98, v50
    v_add_f32 v99, v99, v51
    v_mul_f32 v52, v92, v92
    v_mul_f32 v53, v93, v93
    v_mul_f32 v54, v94, v94
    v_mul_f32 v55, v95, v95
    v_fmaak_f32 v52, v6, v52, 0xc0135761
    v_fmaak_f32 v53, v6, v53, 0xc0135761
    v_fmaak_f32 v54, v6, v54, 0xc0135761
    v_fmaak_f32 v55, v6, v55, 0xc0135761
    v_mul_f32 v52, v52, v92
    v_mul_f32 v53, v53, v93
    v_mul_f32 v54, v54, v94
    v_mul_f32 v55, v55, v95
    v_exp_f32 v52, v52
    v_exp_f32 v53, v53
    v_exp_f32 v54, v54
    v_exp_f32 v55, v55
    v_add_f32 v52, 1.0, v52
    v_add_f32 v53, 1.0, v53
    v_add_f32 v54, 1.0, v54
    v_add_f32 v55, 1.0, v55
    v_rcp_f32 v52, v52
    v_rcp_f32 v53, v53
    v_rcp_f32 v54, v54
    v_rcp_f32 v55, v55
    v_mul_f32 v92, v92, v52
    v_mul_f32 v93, v93, v53
    v_mul_f32 v94, v94, v54
    v_mul_f32 v95, v95, v55
    v_mul_f32 v52, v96, v96
    v_mul_f32 v53, v97, v97
    v_mul_f32 v54, v98, v98
    v_mul_f32 v55, v99, v99
    v_fmaak_f32 v52, v6, v52, 0xc0135761
    v_fmaak_f32 v53, v6, v53, 0xc0135761
    v_fmaak_f32 v54, v6, v54, 0xc0135761
    v_fmaak_f32 v55, v6, v55, 0xc0135761
    v_mul_f32 v52, v52, v96
    v_mul_f32 v53, v53, v97
    v_mul_f32 v54, v54, v98
    v_mul_f32 v55, v55, v99
    v_exp_f32 v52, v52
    v_exp_f32 v53, v53
    v_exp_f32 v54, v54
    v_exp_f32 v55, v55
    v_add_f32 v52, 1.0, v52
    v_add_f32 v53, 1.0, v53
    v_add_f32 v54, 1.0, v54
    v_add_f32 v55, 1.0, v55
    v_rcp_f32 v52, v52
    v_rcp_f32 v53, v53
    v_rcp_f32 v54, v54
    v_rcp_f32 v55, v55
    v_mul_f32 v96, v96, v52
    v_mul_f32 v97, v97, v53
    v_mul_f32 v98, v98, v54
    v_mul_f32 v99, v99, v55
    v_cvt_pk_bf16_f32 v92, v92, v93
    v_cvt_pk_bf16_f32 v93, v94, v95
    v_cvt_pk_bf16_f32 v94, v96, v97
    v_cvt_pk_bf16_f32 v95, v98, v99
    s_mov_b32 s60, 8192
    buffer_store_dwordx4 v[92:95], v4, s[36:39], s60 offen sc1
    v_add_f32 v108, v108, v44
    v_add_f32 v109, v109, v45
    v_add_f32 v110, v110, v46
    v_add_f32 v111, v111, v47
    v_add_f32 v112, v112, v48
    v_add_f32 v113, v113, v49
    v_add_f32 v114, v114, v50
    v_add_f32 v115, v115, v51
    v_mul_f32 v52, v108, v108
    v_mul_f32 v53, v109, v109
    v_mul_f32 v54, v110, v110
    v_mul_f32 v55, v111, v111
    v_fmaak_f32 v52, v6, v52, 0xc0135761
    v_fmaak_f32 v53, v6, v53, 0xc0135761
    v_fmaak_f32 v54, v6, v54, 0xc0135761
    v_fmaak_f32 v55, v6, v55, 0xc0135761
    v_mul_f32 v52, v52, v108
    v_mul_f32 v53, v53, v109
    v_mul_f32 v54, v54, v110
    v_mul_f32 v55, v55, v111
    v_exp_f32 v52, v52
    v_exp_f32 v53, v53
    v_exp_f32 v54, v54
    v_exp_f32 v55, v55
    v_add_f32 v52, 1.0, v52
    v_add_f32 v53, 1.0, v53
    v_add_f32 v54, 1.0, v54
    v_add_f32 v55, 1.0, v55
    v_rcp_f32 v52, v52
    v_rcp_f32 v53, v53
    v_rcp_f32 v54, v54
    v_rcp_f32 v55, v55
    v_mul_f32 v108, v108, v52
    v_mul_f32 v109, v109, v53
    v_mul_f32 v110, v110, v54
    v_mul_f32 v111, v111, v55
    v_mul_f32 v52, v112, v112
    v_mul_f32 v53, v113, v113
    v_mul_f32 v54, v114, v114
    v_mul_f32 v55, v115, v115
    v_fmaak_f32 v52, v6, v52, 0xc0135761
    v_fmaak_f32 v53, v6, v53, 0xc0135761
    v_fmaak_f32 v54, v6, v54, 0xc0135761
    v_fmaak_f32 v55, v6, v55, 0xc0135761
    v_mul_f32 v52, v52, v112
    v_mul_f32 v53, v53, v113
    v_mul_f32 v54, v54, v114
    v_mul_f32 v55, v55, v115
    v_exp_f32 v52, v52
    v_exp_f32 v53, v53
    v_exp_f32 v54, v54
    v_exp_f32 v55, v55
    v_add_f32 v52, 1.0, v52
    v_add_f32 v53, 1.0, v53
    v_add_f32 v54, 1.0, v54
    v_add_f32 v55, 1.0, v55
    v_rcp_f32 v52, v52
    v_rcp_f32 v53, v53
    v_rcp_f32 v54, v54
    v_rcp_f32 v55, v55
    v_mul_f32 v112, v112, v52
    v_mul_f32 v113, v113, v53
    v_mul_f32 v114, v114, v54
    v_mul_f32 v115, v115, v55
    v_cvt_pk_bf16_f32 v108, v108, v109
    v_cvt_pk_bf16_f32 v109, v110, v111
    v_cvt_pk_bf16_f32 v110, v112, v113
    v_cvt_pk_bf16_f32 v111, v114, v115
    s_mov_b32 s60, 8704
    buffer_store_dwordx4 v[108:111], v4, s[36:39], s60 offen sc1
    v_lshlrev_b32 v44, 16, v40
    v_and_b32 v45, 0xffff0000, v40
    v_lshlrev_b32 v46, 16, v41
    v_and_b32 v47, 0xffff0000, v41
    v_lshlrev_b32 v48, 16, v42
    v_and_b32 v49, 0xffff0000, v42
    v_lshlrev_b32 v50, 16, v43
    v_and_b32 v51, 0xffff0000, v43
    v_add_f32 v100, v100, v44
    v_add_f32 v101, v101, v45
    v_add_f32 v102, v102, v46
    v_add_f32 v103, v103, v47
    v_add_f32 v104, v104, v48
    v_add_f32 v105, v105, v49
    v_add_f32 v106, v106, v50
    v_add_f32 v107, v107, v51
    v_mul_f32 v52, v100, v100
    v_mul_f32 v53, v101, v101
    v_mul_f32 v54, v102, v102
    v_mul_f32 v55, v103, v103
    v_fmaak_f32 v52, v6, v52, 0xc0135761
    v_fmaak_f32 v53, v6, v53, 0xc0135761
    v_fmaak_f32 v54, v6, v54, 0xc0135761
    v_fmaak_f32 v55, v6, v55, 0xc0135761
    v_mul_f32 v52, v52, v100
    v_mul_f32 v53, v53, v101
    v_mul_f32 v54, v54, v102
    v_mul_f32 v55, v55, v103
    v_exp_f32 v52, v52
    v_exp_f32 v53, v53
    v_exp_f32 v54, v54
    v_exp_f32 v55, v55
    v_add_f32 v52, 1.0, v52
    v_add_f32 v53, 1.0, v53
    v_add_f32 v54, 1.0, v54
    v_add_f32 v55, 1.0, v55
    v_rcp_f32 v52, v52
    v_rcp_f32 v53, v53
    v_rcp_f32 v54, v54
    v_rcp_f32 v55, v55
    v_mul_f32 v100, v100, v52
    v_mul_f32 v101, v101, v53
    v_mul_f32 v102, v102, v54
    v_mul_f32 v103, v103, v55
    v_mul_f32 v52, v104, v104
    v_mul_f32 v53, v105, v105
    v_mul_f32 v54, v106, v106
    v_mul_f32 v55, v107, v107
    v_fmaak_f32 v52, v6, v52, 0xc0135761
    v_fmaak_f32 v53, v6, v53, 0xc0135761
    v_fmaak_f32 v54, v6, v54, 0xc0135761
    v_fmaak_f32 v55, v6, v55, 0xc0135761
    v_mul_f32 v52, v52, v104
    v_mul_f32 v53, v53, v105
    v_mul_f32 v54, v54, v106
    v_mul_f32 v55, v55, v107
    v_exp_f32 v52, v52
    v_exp_f32 v53, v53
    v_exp_f32 v54, v54
    v_exp_f32 v55, v55
    v_add_f32 v52, 1.0, v52
    v_add_f32 v53, 1.0, v53
    v_add_f32 v54, 1.0, v54
    v_add_f32 v55, 1.0, v55
    v_rcp_f32 v52, v52
    v_rcp_f32 v53, v53
    v_rcp_f32 v54, v54
    v_rcp_f32 v55, v55
    v_mul_f32 v104, v104, v52
    v_mul_f32 v105, v105, v53
    v_mul_f32 v106, v106, v54
    v_mul_f32 v107, v107, v55
    v_cvt_pk_bf16_f32 v100, v100, v101
    v_cvt_pk_bf16_f32 v101, v102, v103
    v_cvt_pk_bf16_f32 v102, v104, v105
    v_cvt_pk_bf16_f32 v103, v106, v107
    s_mov_b32 s60, 12288
    buffer_store_dwordx4 v[100:103], v4, s[36:39], s60 offen sc1
    v_add_f32 v116, v116, v44
    v_add_f32 v117, v117, v45
    v_add_f32 v118, v118, v46
    v_add_f32 v119, v119, v47
    v_add_f32 v120, v120, v48
    v_add_f32 v121, v121, v49
    v_add_f32 v122, v122, v50
    v_add_f32 v123, v123, v51
    v_mul_f32 v52, v116, v116
    v_mul_f32 v53, v117, v117
    v_mul_f32 v54, v118, v118
    v_mul_f32 v55, v119, v119
    v_fmaak_f32 v52, v6, v52, 0xc0135761
    v_fmaak_f32 v53, v6, v53, 0xc0135761
    v_fmaak_f32 v54, v6, v54, 0xc0135761
    v_fmaak_f32 v55, v6, v55, 0xc0135761
    v_mul_f32 v52, v52, v116
    v_mul_f32 v53, v53, v117
    v_mul_f32 v54, v54, v118
    v_mul_f32 v55, v55, v119
    v_exp_f32 v52, v52
    v_exp_f32 v53, v53
    v_exp_f32 v54, v54
    v_exp_f32 v55, v55
    v_add_f32 v52, 1.0, v52
    v_add_f32 v53, 1.0, v53
    v_add_f32 v54, 1.0, v54
    v_add_f32 v55, 1.0, v55
    v_rcp_f32 v52, v52
    v_rcp_f32 v53, v53
    v_rcp_f32 v54, v54
    v_rcp_f32 v55, v55
    v_mul_f32 v116, v116, v52
    v_mul_f32 v117, v117, v53
    v_mul_f32 v118, v118, v54
    v_mul_f32 v119, v119, v55
    v_mul_f32 v52, v120, v120
    v_mul_f32 v53, v121, v121
    v_mul_f32 v54, v122, v122
    v_mul_f32 v55, v123, v123
    v_fmaak_f32 v52, v6, v52, 0xc0135761
    v_fmaak_f32 v53, v6, v53, 0xc0135761
    v_fmaak_f32 v54, v6, v54, 0xc0135761
    v_fmaak_f32 v55, v6, v55, 0xc0135761
    v_mul_f32 v52, v52, v120
    v_mul_f32 v53, v53, v121
    v_mul_f32 v54, v54, v122
    v_mul_f32 v55, v55, v123
    v_exp_f32 v52, v52
    v_exp_f32 v53, v53
    v_exp_f32 v54, v54
    v_exp_f32 v55, v55
    v_add_f32 v52, 1.0, v52
    v_add_f32 v53, 1.0, v53
    v_add_f32 v54, 1.0, v54
    v_add_f32 v55, 1.0, v55
    v_rcp_f32 v52, v52
    v_rcp_f32 v53, v53
    v_rcp_f32 v54, v54
    v_rcp_f32 v55, v55
    v_mul_f32 v120, v120, v52
    v_mul_f32 v121, v121, v53
    v_mul_f32 v122, v122, v54
    v_mul_f32 v123, v123, v55
    v_cvt_pk_bf16_f32 v116, v116, v117
    v_cvt_pk_bf16_f32 v117, v118, v119
    v_cvt_pk_bf16_f32 v118, v120, v121
    v_cvt_pk_bf16_f32 v119, v122, v123
    s_mov_b32 s60, 12800
    buffer_store_dwordx4 v[116:119], v4, s[36:39], s60 offen sc1
ffn1_kernel_fin:
ffn1_kernel_fin2:
    s_waitcnt vmcnt(0)
    s_barrier
    s_cmp_eq_u32 s25, 0
    s_cbranch_scc0 L_fz_s17
    s_lshl_b32 s88, s2, 3
    s_add_u32 s88, s88, 10240
    s_mov_b64 exec, 1
    v_mov_b32 v248, s100
    v_mov_b32 v249, s101
    v_mov_b32 v250, 0
    buffer_store_dwordx2 v[248:249], v250, s[96:99], s88 offen sc0 sc1
    s_mov_b64 exec, -1
L_fz_s17:
ffn1_kernel_end:
    s_cmp_ge_u32 s2, 256
    s_cbranch_scc1 ffn2_kernel_end
    s_load_dwordx2 s[4:5], s[0:1], 72
    s_load_dwordx2 s[12:13], s[0:1], 104
    s_load_dwordx2 s[14:15], s[0:1], 80
    s_load_dwordx2 s[16:17], s[0:1], 88
    v_lshrrev_b32 v2, 6, v0
    v_and_b32 v1, 63, v0
    v_readfirstlane_b32 s25, v2
    s_and_b32 s21, s2, 7
    s_lshl_b32 s21, s21, 3
    s_lshr_b32 s20, s2, 3
    s_lshr_b32 s22, s20, 2
    s_add_u32 s21, s21, s22
    s_lshl_b32 s21, s21, 5
    s_and_b32 s20, s20, 3
    s_mul_i32 s20, s20, 160
    s_mov_b32 s22, 0
    s_waitcnt lgkmcnt(0)
    s_mov_b32 s28, s4
    s_mov_b32 s29, s5
    s_mov_b32 s30, 0x21c000
    s_mov_b32 s31, 0x00020000
    s_add_u32 s32, s12, 0x5c00000
    s_addc_u32 s33, s13, 0
    s_mov_b32 s34, 0x6c0000
    s_mov_b32 s35, 0x00020000
    s_lshl_b32 s53, s25, 10
    v_lshlrev_b32 v3, 4, v1
    s_add_u32 s54, s25, 0
    s_lshl_b32 s54, s54, 6
    v_add_u32 v4, s54, v1
    s_mov_b32 s55, 0xccccccd
    v_mul_hi_u32 v5, s55, v4
    v_mul_u32_u24 v6, 20, v5
    v_sub_u32 v6, v4, v6
    v_mul_u32_u24 v5, 1280, v5
    v_lshlrev_b32 v6, 4, v6
    v_add_u32 v8, v5, v6
    s_add_u32 s54, s25, 8
    s_lshl_b32 s54, s54, 6
    v_add_u32 v4, s54, v1
    s_mov_b32 s55, 0xccccccd
    v_mul_hi_u32 v5, s55, v4
    v_mul_u32_u24 v6, 20, v5
    v_sub_u32 v6, v4, v6
    v_mul_u32_u24 v5, 1280, v5
    v_lshlrev_b32 v6, 4, v6
    v_add_u32 v9, v5, v6
    s_add_u32 s54, s25, 16
    s_lshl_b32 s54, s54, 6
    v_add_u32 v4, s54, v1
    s_mov_b32 s55, 0xccccccd
    v_mul_hi_u32 v5, s55, v4
    v_mul_u32_u24 v6, 20, v5
    v_sub_u32 v6, v4, v6
    v_mul_u32_u24 v5, 1280, v5
    v_lshlrev_b32 v6, 4, v6
    v_add_u32 v10, v5, v6
    s_add_u32 s54, s25, -4
    s_lshl_b32 s54, s54, 10
    v_add_u32 v4, s54, v3
    v_lshrrev_b32 v5, 9, v4
    v_and_b32 v6, 511, v4
    v_lshlrev_b32 v5, 11, v5
    v_add_u32 v11, v5, v6
    s_mul_i32 s51, s22, 1280
    s_lshl_b32 s54, s20, 1
    s_add_u32 s51, s51, s54
    s_lshr_b32 s52, s21, 7
    s_mul_i32 s52, s52, 216
    s_lshr_b32 s54, s22, 3
    s_add_u32 s52, s52, s54
    s_lshl_b32 s52, s52, 11
    s_and_b32 s54, s21, 127
    s_lshl_b32 s54, s54, 4
    s_add_u32 s52, s52, s54
    s_add_u32 m0, s53, 0
    s_add_u32 s54, s51, 0
    buffer_load_dwordx4 v8, s[28:31], s54 offen sc1 lds
    s_add_u32 m0, s53, 8192
    s_add_u32 s54, s51, 0
    buffer_load_dwordx4 v9, s[28:31], s54 offen sc1 lds
    s_add_u32 m0, s53, 24576
    s_add_u32 s54, s51, 81920
    buffer_load_dwordx4 v8, s[28:31], s54 offen sc1 lds
    s_add_u32 m0, s53, 32768
    s_add_u32 s54, s51, 81920
    buffer_load_dwordx4 v9, s[28:31], s54 offen sc1 lds
    s_add_u32 m0, s53, 49152
    s_add_u32 s54, s51, 163840
    buffer_load_dwordx4 v8, s[28:31], s54 offen sc1 lds
    s_add_u32 m0, s53, 57344
    s_add_u32 s54, s51, 163840
    buffer_load_dwordx4 v9, s[28:31], s54 offen sc1 lds
    s_add_u32 m0, s53, 73728
    s_add_u32 s54, s51, 245760
    buffer_load_dwordx4 v8, s[28:31], s54 offen sc1 lds
    s_add_u32 m0, s53, 81920
    s_add_u32 s54, s51, 245760
    buffer_load_dwordx4 v9, s[28:31], s54 offen sc1 lds
    s_add_u32 m0, s53, 98304
    s_add_u32 s54, s51, 327680
    buffer_load_dwordx4 v8, s[28:31], s54 offen sc1 lds
    s_add_u32 m0, s53, 106496
    s_add_u32 s54, s51, 327680
    buffer_load_dwordx4 v9, s[28:31], s54 offen sc1 lds
    s_add_u32 m0, s53, 122880
    s_add_u32 s54, s51, 409600
    buffer_load_dwordx4 v8, s[28:31], s54 offen sc1 lds
    s_add_u32 m0, s53, 131072
    s_add_u32 s54, s51, 409600
    buffer_load_dwordx4 v9, s[28:31], s54 offen sc1 lds
    s_cmp_eq_u32 s25, 0
    s_cbranch_scc0 L_fz_w18d
    v_and_b32 v41, 63, v0
    v_min_u32 v41, 26, v41
    s_lshr_b32 s88, s21, 8
    s_add_u32 s88, s88, 1280
    v_lshlrev_b32 v40, 3, v41
    v_add_u32 v40, s88, v40
    v_lshlrev_b32 v40, 3, v40
    s_mov_b32 s88, 0
L_fz_w18:
    buffer_load_dwordx2 v[42:43], v40, s[96:99], 0 offen sc0 sc1
    s_waitcnt vmcnt(0)
    v_cmp_eq_u64 vcc, s[100:101], v[42:43]
    s_add_u32 s88, s88, 1
    s_nop 0
    s_cmp_eq_u64 vcc, exec
    s_cbranch_scc1 L_fz_w18d
    s_sleep 1
    s_cmp_lt_u32 s88, 400000
    s_cbranch_scc1 L_fz_w18
L_fz_w18d:
    s_barrier
    s_cmp_lt_u32 s25, 4
    s_cbranch_scc0 ffn2_kernel_d1a
    s_add_u32 m0, s53, 16384
    s_add_u32 s54, s51, 0
    buffer_load_dwordx4 v10, s[28:31], s54 offen sc1 lds
    s_branch ffn2_kernel_d1b
ffn2_kernel_d1a:
    s_add_u32 m0, s53, 16384
    s_add_u32 s54, s52, 0
    buffer_load_dwordx4 v11, s[32:35], s54 offen sc1 lds
ffn2_kernel_d1b:
    s_cmp_lt_u32 s25, 4
    s_cbranch_scc0 ffn2_kernel_d2a
    s_add_u32 m0, s53, 40960
    s_add_u32 s54, s51, 81920
    buffer_load_dwordx4 v10, s[28:31], s54 offen sc1 lds
    s_branch ffn2_kernel_d2b
ffn2_kernel_d2a:
    s_add_u32 m0, s53, 40960
    s_add_u32 s54, s52, 16384
    buffer_load_dwordx4 v11, s[32:35], s54 offen sc1 lds
ffn2_kernel_d2b:
    s_cmp_lt_u32 s25, 4
    s_cbranch_scc0 ffn2_kernel_d3a
    s_add_u32 m0, s53, 65536
    s_add_u32 s54, s51, 163840
    buffer_load_dwordx4 v10, s[28:31], s54 offen sc1 lds
    s_branch ffn2_kernel_d3b
ffn2_kernel_d3a:
    s_add_u32 m0, s53, 65536
    s_add_u32 s54, s52, 32768
    buffer_load_dwordx4 v11, s[32:35], s54 offen sc1 lds
ffn2_kernel_d3b:
    s_cmp_lt_u32 s25, 4
    s_cbranch_scc0 ffn2_kernel_d4a
    s_add_u32 m0, s53, 90112
    s_add_u32 s54, s51, 245760
    buffer_load_dwordx4 v10, s[28:31], s54 offen sc1 lds
    s_branch ffn2_kernel_d4b
ffn2_kernel_d4a:
    s_add_u32 m0, s53, 90112
    s_add_u32 s54, s52, 49152
    buffer_load_dwordx4 v11, s[32:35], s54 offen sc1 lds
ffn2_kernel_d4b:
    s_cmp_lt_u32 s25, 4
    s_cbranch_scc0 ffn2_kernel_d5a
    s_add_u32 m0, s53, 114688
    s_add_u32 s54, s51, 327680
    buffer_load_dwordx4 v10, s[28:31], s54 offen sc1 lds
    s_branch ffn2_kernel_d5b
ffn2_kernel_d5a:
    s_add_u32 m0, s53, 114688
    s_add_u32 s54, s52, 65536
    buffer_load_dwordx4 v11, s[32:35], s54 offen sc1 lds
ffn2_kernel_d5b:
    s_cmp_lt_u32 s25, 4
    s_cbranch_scc0 ffn2_kernel_d6a
    s_add_u32 m0, s53, 139264
    s_add_u32 s54, s51, 409600
    buffer_load_dwordx4 v10, s[28:31], s54 offen sc1 lds
    s_branch ffn2_kernel_d6b
ffn2_kernel_d6a:
    s_add_u32 m0, s53, 139264
    s_add_u32 s54, s52, 81920
    buffer_load_dwordx4 v11, s[32:35], s54 offen sc1 lds
ffn2_kernel_d6b:
    s_mov_b32 s56, 0
    s_mul_hi_u32 s57, s25, 0x33333334
    s_mul_i32 s58, s57, 5
    s_sub_u32 s26, s25, s58
    s_and_b32 s27, s57, 0
    s_lshr_b32 s24, s57, 0
    v_and_b32 v4, 3, v1
    v_and_b32 v5, 1, v4
    v_lshlrev_b32 v5, 1, v5
    v_lshrrev_b32 v6, 1, v4
    v_or_b32 v4, v5, v6
    v_lshrrev_b32 v5, 1, v4
    v_and_b32 v4, 1, v4
    v_lshlrev_b32 v4, 3, v4
    v_lshrrev_b32 v6, 4, v1
    v_and_b32 v6, 1, v6
    v_lshlrev_b32 v6, 1, v6
    v_add_u32 v5, v5, v6
    s_mul_i32 s57, s26, 4
    v_add_u32 v5, s57, v5
    v_lshrrev_b32 v6, 2, v1
    v_and_b32 v6, 3, v6
    v_lshrrev_b32 v7, 5, v1
    v_lshlrev_b32 v7, 3, v7
    v_add_u32 v7, v7, v6
    s_mul_i32 s57, s24, 64
    v_add_u32 v7, s57, v7
    v_mul_u32_u24 v7, 320, v7
    v_add_u32 v7, v7, v4
    v_lshlrev_b32 v5, 4, v5
    v_add_u32 v12, v7, v5
    v_add_u32 v13, 24576, v12
    v_add_u32 v14, 49152, v12
    v_add_u32 v15, 73728, v12
    v_add_u32 v16, 98304, v12
    v_add_u32 v17, 122880, v12
    v_lshrrev_b32 v4, 5, v1
    s_mul_i32 s57, s24, 8
    v_add_u32 v4, s57, v4
    v_mul_u32_u24 v4, 512, v4
    v_and_b32 v5, 31, v1
    v_lshlrev_b32 v5, 4, v5
    v_add_u32 v4, v4, v5
    s_mul_i32 s57, s27, 512
    s_add_u32 s57, s57, 20480
    v_add_u32 v18, s57, v4
    v_add_u32 v19, 24576, v18
    v_add_u32 v20, 49152, v18
    v_add_u32 v21, 73728, v18
    v_add_u32 v22, 98304, v18
    v_add_u32 v23, 122880, v18
    v_mov_b32 v40, 0
    v_mov_b32 v41, 0
    v_mov_b32 v42, 0
    v_mov_b32 v43, 0
    v_mov_b32 v44, 0
    v_mov_b32 v45, 0
    v_mov_b32 v46, 0
    v_mov_b32 v47, 0
    v_mov_b32 v48, 0
    v_mov_b32 v49, 0
    v_mov_b32 v50, 0
    v_mov_b32 v51, 0
    v_mov_b32 v52, 0
    v_mov_b32 v53, 0
    v_mov_b32 v54, 0
    v_mov_b32 v55, 0
    s_cmp_lt_u32 s25, 5
    s_cbranch_scc0 ffn2_kernel_dmaonly
    s_waitcnt vmcnt(5)
    s_barrier
    ds_read_b128 v[28:31], v18 offset:0
    ds_read_b64_tr_b16 v[24:25], v12 offset:0
    ds_read_b64_tr_b16 v[26:27], v12 offset:1280
    s_waitcnt lgkmcnt(0)
    v_mfma_f32_32x32x16_bf16 v[40:55], v[24:27], v[28:31], v[40:55]
    ds_read_b128 v[36:39], v18 offset:1024
    ds_read_b64_tr_b16 v[32:33], v12 offset:5120
    ds_read_b64_tr_b16 v[34:35], v12 offset:6400
    s_waitcnt lgkmcnt(0)
    v_mfma_f32_32x32x16_bf16 v[40:55], v[32:35], v[36:39], v[40:55]
    ds_read_b128 v[28:31], v18 offset:2048
    ds_read_b64_tr_b16 v[24:25], v12 offset:10240
    ds_read_b64_tr_b16 v[26:27], v12 offset:11520
    s_waitcnt lgkmcnt(0)
    v_mfma_f32_32x32x16_bf16 v[40:55], v[24:27], v[28:31], v[40:55]
    ds_read_b128 v[36:39], v18 offset:3072
    ds_read_b64_tr_b16 v[32:33], v12 offset:15360
    ds_read_b64_tr_b16 v[34:35], v12 offset:16640
    s_waitcnt vmcnt(4) lgkmcnt(0)
    s_barrier
    v_mfma_f32_32x32x16_bf16 v[40:55], v[32:35], v[36:39], v[40:55]
    ds_read_b128 v[28:31], v19 offset:0
    ds_read_b64_tr_b16 v[24:25], v13 offset:0
    ds_read_b64_tr_b16 v[26:27], v13 offset:1280
    s_add_u32 m0, s53, 0
    s_add_u32 s54, s51, 491520
    buffer_load_dwordx4 v8, s[28:31], s54 offen sc1 lds
    s_add_u32 m0, s53, 8192
    s_add_u32 s54, s51, 491520
    buffer_load_dwordx4 v9, s[28:31], s54 offen sc1 lds
    s_cmp_lt_u32 s25, 4
    s_cbranch_scc0 ffn2_kernel_d7a
    s_add_u32 m0, s53, 16384
    s_add_u32 s54, s51, 491520
    buffer_load_dwordx4 v10, s[28:31], s54 offen sc1 lds
    s_branch ffn2_kernel_d7b
ffn2_kernel_d7a:
    s_add_u32 m0, s53, 16384
    s_add_u32 s54, s52, 98304
    buffer_load_dwordx4 v11, s[32:35], s54 offen sc1 lds
ffn2_kernel_d7b:
    s_waitcnt lgkmcnt(0)
    v_mfma_f32_32x32x16_bf16 v[40:55], v[24:27], v[28:31], v[40:55]
    ds_read_b128 v[36:39], v19 offset:1024
    ds_read_b64_tr_b16 v[32:33], v13 offset:5120
    ds_read_b64_tr_b16 v[34:35], v13 offset:6400
    s_waitcnt lgkmcnt(0)
    v_mfma_f32_32x32x16_bf16 v[40:55], v[32:35], v[36:39], v[40:55]
    ds_read_b128 v[28:31], v19 offset:2048
    ds_read_b64_tr_b16 v[24:25], v13 offset:10240
    ds_read_b64_tr_b16 v[26:27], v13 offset:11520
    s_waitcnt lgkmcnt(0)
    v_mfma_f32_32x32x16_bf16 v[40:55], v[24:27], v[28:31], v[40:55]
    ds_read_b128 v[36:39], v19 offset:3072
    ds_read_b64_tr_b16 v[32:33], v13 offset:15360
    ds_read_b64_tr_b16 v[34:35], v13 offset:16640
    s_waitcnt vmcnt(6) lgkmcnt(0)
    s_barrier
    v_mfma_f32_32x32x16_bf16 v[40:55], v[32:35], v[36:39], v[40:55]
    ds_read_b128 v[28:31], v20 offset:0
    ds_read_b64_tr_b16 v[24:25], v14 offset:0
    ds_read_b64_tr_b16 v[26:27], v14 offset:1280
    s_add_u32 m0, s53, 24576
    s_add_u32 s54, s51, 573440
    buffer_load_dwordx4 v8, s[28:31], s54 offen sc1 lds
    s_add_u32 m0, s53, 32768
    s_add_u32 s54, s51, 573440
    buffer_load_dwordx4 v9, s[28:31], s54 offen sc1 lds
    s_cmp_lt_u32 s25, 4
    s_cbranch_scc0 ffn2_kernel_d8a
    s_add_u32 m0, s53, 40960
    s_add_u32 s54, s51, 573440
    buffer_load_dwordx4 v10, s[28:31], s54 offen sc1 lds
    s_branch ffn2_kernel_d8b
ffn2_kernel_d8a:
    s_add_u32 m0, s53, 40960
    s_add_u32 s54, s52, 114688
    buffer_load_dwordx4 v11, s[32:35], s54 offen sc1 lds
ffn2_kernel_d8b:
    s_waitcnt lgkmcnt(0)
    v_mfma_f32_32x32x16_bf16 v[40:55], v[24:27], v[28:31], v[40:55]
    ds_read_b128 v[36:39], v20 offset:1024
    ds_read_b64_tr_b16 v[32:33], v14 offset:5120
    ds_read_b64_tr_b16 v[34:35], v14 offset:6400
    s_waitcnt lgkmcnt(0)
    v_mfma_f32_32x32x16_bf16 v[40:55], v[32:35], v[36:39], v[40:55]
    ds_read_b128 v[28:31], v20 offset:2048
    ds_read_b64_tr_b16 v[24:25], v14 offset:10240
    ds_read_b64_tr_b16 v[26:27], v14 offset:11520
    s_waitcnt lgkmcnt(0)
    v_mfma_f32_32x32x16_bf16 v[40:55], v[24:27], v[28:31], v[40:55]
    ds_read_b128 v[36:39], v20 offset:3072
    ds_read_b64_tr_b16 v[32:33], v14 offset:15360
    ds_read_b64_tr_b16 v[34:35], v14 offset:16640
    s_waitcnt vmcnt(8) lgkmcnt(0)
    s_barrier
    v_mfma_f32_32x32x16_bf16 v[40:55], v[32:35], v[36:39], v[40:55]
    ds_read_b128 v[28:31], v21 offset:0
    ds_read_b64_tr_b16 v[24:25], v15 offset:0
    ds_read_b64_tr_b16 v[26:27], v15 offset:1280
    s_add_u32 m0, s53, 49152
    s_add_u32 s54, s51, 655360
    buffer_load_dwordx4 v8, s[28:31], s54 offen sc1 lds
    s_add_u32 m0, s53, 57344
    s_add_u32 s54, s51, 655360
    buffer_load_dwordx4 v9, s[28:31], s54 offen sc1 lds
    s_cmp_lt_u32 s25, 4
    s_cbranch_scc0 ffn2_kernel_d9a
    s_add_u32 m0, s53, 65536
    s_add_u32 s54, s51, 655360
    buffer_load_dwordx4 v10, s[28:31], s54 offen sc1 lds
    s_branch ffn2_kernel_d9b
ffn2_kernel_d9a:
    s_add_u32 m0, s53, 65536
    s_add_u32 s54, s52, 131072
    buffer_load_dwordx4 v11, s[32:35], s54 offen sc1 lds
ffn2_kernel_d9b:
    s_waitcnt lgkmcnt(0)
    v_mfma_f32_32x32x16_bf16 v[40:55], v[24:27], v[28:31], v[40:55]
    ds_read_b128 v[36:39], v21 offset:1024
    ds_read_b64_tr_b16 v[32:33], v15 offset:5120
    ds_read_b64_tr_b16 v[34:35], v15 offset:6400
    s_waitcnt lgkmcnt(0)
    v_mfma_f32_32x32x16_bf16 v[40:55], v[32:35], v[36:39], v[40:55]
    ds_read_b128 v[28:31], v21 offset:2048
    ds_read_b64_tr_b16 v[24:25], v15 offset:10240
    ds_read_b64_tr_b16 v[26:27], v15 offset:11520
    s_waitcnt lgkmcnt(0)
    v_mfma_f32_32x32x16_bf16 v[40:55], v[24:27], v[28:31], v[40:55]
    ds_read_b128 v[36:39], v21 offset:3072
    ds_read_b64_tr_b16 v[32:33], v15 offset:15360
    ds_read_b64_tr_b16 v[34:35], v15 offset:16640
    s_waitcnt vmcnt(10) lgkmcnt(0)
    s_barrier
    v_mfma_f32_32x32x16_bf16 v[40:55], v[32:35], v[36:39], v[40:55]
    ds_read_b128 v[28:31], v22 offset:0
    ds_read_b64_tr_b16 v[24:25], v16 offset:0
    ds_read_b64_tr_b16 v[26:27], v16 offset:1280
    s_add_u32 m0, s53, 73728
    s_add_u32 s54, s51, 737280
    buffer_load_dwordx4 v8, s[28:31], s54 offen sc1 lds
    s_add_u32 m0, s53, 81920
    s_add_u32 s54, s51, 737280
    buffer_load_dwordx4 v9, s[28:31], s54 offen sc1 lds
    s_cmp_lt_u32 s25, 4
    s_cbranch_scc0 ffn2_kernel_d10a
    s_add_u32 m0, s53, 90112
    s_add_u32 s54, s51, 737280
    buffer_load_dwordx4 v10, s[28:31], s54 offen sc1 lds
    s_branch ffn2_kernel_d10b
ffn2_kernel_d10a:
    s_add_u32 m0, s53, 90112
    s_add_u32 s54, s52, 147456
    buffer_load_dwordx4 v11, s[32:35], s54 offen sc1 lds
ffn2_kernel_d10b:
    s_waitcnt lgkmcnt(0)
    v_mfma_f32_32x32x16_bf16 v[40:55], v[24:27], v[28:31], v[40:55]
    ds_read_b128 v[36:39], v22 offset:1024
    ds_read_b64_tr_b16 v[32:33], v16 offset:5120
    ds_read_b64_tr_b16 v[34:35], v16 offset:6400
    s_waitcnt lgkmcnt(0)
    v_mfma_f32_32x32x16_bf16 v[40:55], v[32:35], v[36:39], v[40:55]
    ds_read_b128 v[28:31], v22 offset:2048
    ds_read_b64_tr_b16 v[24:25], v16 offset:10240
    ds_read_b64_tr_b16 v[26:27], v16 offset:11520
    s_waitcnt lgkmcnt(0)
    v_mfma_f32_32x32x16_bf16 v[40:55], v[24:27], v[28:31], v[40:55]
    ds_read_b128 v[36:39], v22 offset:3072
    ds_read_b64_tr_b16 v[32:33], v16 offset:15360
    ds_read_b64_tr_b16 v[34:35], v16 offset:16640
    s_waitcnt vmcnt(12) lgkmcnt(0)
    s_barrier
    v_mfma_f32_32x32x16_bf16 v[40:55], v[32:35], v[36:39], v[40:55]
    ds_read_b128 v[28:31], v23 offset:0
    ds_read_b64_tr_b16 v[24:25], v17 offset:0
    ds_read_b64_tr_b16 v[26:27], v17 offset:1280
    s_add_u32 m0, s53, 98304
    s_add_u32 s54, s51, 819200
    buffer_load_dwordx4 v8, s[28:31], s54 offen sc1 lds
    s_add_u32 m0, s53, 106496
    s_add_u32 s54, s51, 819200
    buffer_load_dwordx4 v9, s[28:31], s54 offen sc1 lds
    s_cmp_lt_u32 s25, 4
    s_cbranch_scc0 ffn2_kernel_d11a
    s_add_u32 m0, s53, 114688
    s_add_u32 s54, s51, 819200
    buffer_load_dwordx4 v10, s[28:31], s54 offen sc1 lds
    s_branch ffn2_kernel_d11b
ffn2_kernel_d11a:
    s_add_u32 m0, s53, 114688
    s_add_u32 s54, s52, 163840
    buffer_load_dwordx4 v11, s[32:35], s54 offen sc1 lds
ffn2_kernel_d11b:
    s_waitcnt lgkmcnt(0)
    v_mfma_f32_32x32x16_bf16 v[40:55], v[24:27], v[28:31], v[40:55]
    ds_read_b128 v[36:39], v23 offset:1024
    ds_read_b64_tr_b16 v[32:33], v17 offset:5120
    ds_read_b64_tr_b16 v[34:35], v17 offset:6400
    s_waitcnt lgkmcnt(0)
    v_mfma_f32_32x32x16_bf16 v[40:55], v[32:35], v[36:39], v[40:55]
    ds_read_b128 v[28:31], v23 offset:2048
    ds_read_b64_tr_b16 v[24:25], v17 offset:10240
    ds_read_b64_tr_b16 v[26:27], v17 offset:11520
    s_waitcnt lgkmcnt(0)
    v_mfma_f32_32x32x16_bf16 v[40:55], v[24:27], v[28:31], v[40:55]
    ds_read_b128 v[36:39], v23 offset:3072
    ds_read_b64_tr_b16 v[32:33], v17 offset:15360
    ds_read_b64_tr_b16 v[34:35], v17 offset:16640
    s_waitcnt vmcnt(12) lgkmcnt(0)
    s_barrier
    v_mfma_f32_32x32x16_bf16 v[40:55], v[32:35], v[36:39], v[40:55]
    ds_read_b128 v[28:31], v18 offset:0
    ds_read_b64_tr_b16 v[24:25], v12 offset:0
    ds_read_b64_tr_b16 v[26:27], v12 offset:1280
    s_add_u32 m0, s53, 122880
    s_add_u32 s54, s51, 901120
    buffer_load_dwordx4 v8, s[28:31], s54 offen sc1 lds
    s_add_u32 m0, s53, 131072
    s_add_u32 s54, s51, 901120
    buffer_load_dwordx4 v9, s[28:31], s54 offen sc1 lds
    s_cmp_lt_u32 s25, 4
    s_cbranch_scc0 ffn2_kernel_d12a
    s_add_u32 m0, s53, 139264
    s_add_u32 s54, s51, 901120
    buffer_load_dwordx4 v10, s[28:31], s54 offen sc1 lds
    s_branch ffn2_kernel_d12b
ffn2_kernel_d12a:
    s_add_u32 m0, s53, 139264
    s_add_u32 s54, s52, 180224
    buffer_load_dwordx4 v11, s[32:35], s54 offen sc1 lds
ffn2_kernel_d12b:
    s_waitcnt lgkmcnt(0)
    v_mfma_f32_32x32x16_bf16 v[40:55], v[24:27], v[28:31], v[40:55]
    ds_read_b128 v[36:39], v18 offset:1024
    ds_read_b64_tr_b16 v[32:33], v12 offset:5120
    ds_read_b64_tr_b16 v[34:35], v12 offset:6400
    s_waitcnt lgkmcnt(0)
    v_mfma_f32_32x32x16_bf16 v[40:55], v[32:35], v[36:39], v[40:55]
    ds_read_b128 v[28:31], v18 offset:2048
    ds_read_b64_tr_b16 v[24:25], v12 offset:10240
    ds_read_b64_tr_b16 v[26:27], v12 offset:11520
    s_waitcnt lgkmcnt(0)
    v_mfma_f32_32x32x16_bf16 v[40:55], v[24:27], v[28:31], v[40:55]
    ds_read_b128 v[36:39], v18 offset:3072
    ds_read_b64_tr_b16 v[32:33], v12 offset:15360
    ds_read_b64_tr_b16 v[34:35], v12 offset:16640
    s_waitcnt vmcnt(12) lgkmcnt(0)
    s_barrier
    v_mfma_f32_32x32x16_bf16 v[40:55], v[32:35], v[36:39], v[40:55]
    ds_read_b128 v[28:31], v19 offset:0
    ds_read_b64_tr_b16 v[24:25], v13 offset:0
    ds_read_b64_tr_b16 v[26:27], v13 offset:1280
    s_add_u32 m0, s53, 0
    s_add_u32 s54, s51, 983040
    buffer_load_dwordx4 v8, s[28:31], s54 offen sc1 lds
    s_add_u32 m0, s53, 8192
    s_add_u32 s54, s51, 983040
    buffer_load_dwordx4 v9, s[28:31], s54 offen sc1 lds
    s_cmp_lt_u32 s25, 4
    s_cbranch_scc0 ffn2_kernel_d13a
    s_add_u32 m0, s53, 16384
    s_add_u32 s54, s51, 983040
    buffer_load_dwordx4 v10, s[28:31], s54 offen sc1 lds
    s_branch ffn2_kernel_d13b
ffn2_kernel_d13a:
    s_add_u32 m0, s53, 16384
    s_add_u32 s54, s52, 196608
    buffer_load_dwordx4 v11, s[32:35], s54 offen sc1 lds
ffn2_kernel_d13b:
    s_waitcnt lgkmcnt(0)
    v_mfma_f32_32x32x16_bf16 v[40:55], v[24:27], v[28:31], v[40:55]
    ds_read_b128 v[36:39], v19 offset:1024
    ds_read_b64_tr_b16 v[32:33], v13 offset:5120
    ds_read_b64_tr_b16 v[34:35], v13 offset:6400
    s_waitcnt lgkmcnt(0)
    v_mfma_f32_32x32x16_bf16 v[40:55], v[32:35], v[36:39], v[40:55]
    ds_read_b128 v[28:31], v19 offset:2048
    ds_read_b64_tr_b16 v[24:25], v13 offset:10240
    ds_read_b64_tr_b16 v[26:27], v13 offset:11520
    s_waitcnt lgkmcnt(0)
    v_mfma_f32_32x32x16_bf16 v[40:55], v[24:27], v[28:31], v[40:55]
    ds_read_b128 v[36:39], v19 offset:3072
    ds_read_b64_tr_b16 v[32:33], v13 offset:15360
    ds_read_b64_tr_b16 v[34:35], v13 offset:16640
    s_waitcnt vmcnt(12) lgkmcnt(0)
    s_barrier
    v_mfma_f32_32x32x16_bf16 v[40:55], v[32:35], v[36:39], v[40:55]
    ds_read_b128 v[28:31], v20 offset:0
    ds_read_b64_tr_b16 v[24:25], v14 offset:0
    ds_read_b64_tr_b16 v[26:27], v14 offset:1280
    s_add_u32 m0, s53, 24576
    s_add_u32 s54, s51, 1064960
    buffer_load_dwordx4 v8, s[28:31], s54 offen sc1 lds
    s_add_u32 m0, s53, 32768
    s_add_u32 s54, s51, 1064960
    buffer_load_dwordx4 v9, s[28:31], s54 offen sc1 lds
    s_cmp_lt_u32 s25, 4
    s_cbranch_scc0 ffn2_kernel_d14a
    s_add_u32 m0, s53, 40960
    s_add_u32 s54, s51, 1064960
    buffer_load_dwordx4 v10, s[28:31], s54 offen sc1 lds
    s_branch ffn2_kernel_d14b
ffn2_kernel_d14a:
    s_add_u32 m0, s53, 40960
    s_add_u32 s54, s52, 212992
    buffer_load_dwordx4 v11, s[32:35], s54 offen sc1 lds
ffn2_kernel_d14b:
    s_waitcnt lgkmcnt(0)
    v_mfma_f32_32x32x16_bf16 v[40:55], v[24:27], v[28:31], v[40:55]
    ds_read_b128 v[36:39], v20 offset:1024
    ds_read_b64_tr_b16 v[32:33], v14 offset:5120
    ds_read_b64_tr_b16 v[34:35], v14 offset:6400
    s_waitcnt lgkmcnt(0)
    v_mfma_f32_32x32x16_bf16 v[40:55], v[32:35], v[36:39], v[40:55]
    ds_read_b128 v[28:31], v20 offset:2048
    ds_read_b64_tr_b16 v[24:25], v14 offset:10240
    ds_read_b64_tr_b16 v[26:27], v14 offset:11520
    s_waitcnt lgkmcnt(0)
    v_mfma_f32_32x32x16_bf16 v[40:55], v[24:27], v[28:31], v[40:55]
    ds_read_b128 v[36:39], v20 offset:3072
    ds_read_b64_tr_b16 v[32:33], v14 offset:15360
    ds_read_b64_tr_b16 v[34:35], v14 offset:16640
    s_waitcnt vmcnt(12) lgkmcnt(0)
    s_barrier
    v_mfma_f32_32x32x16_bf16 v[40:55], v[32:35], v[36:39], v[40:55]
    ds_read_b128 v[28:31], v21 offset:0
    ds_read_b64_tr_b16 v[24:25], v15 offset:0
    ds_read_b64_tr_b16 v[26:27], v15 offset:1280
    s_add_u32 m0, s53, 49152
    s_add_u32 s54, s51, 1146880
    buffer_load_dwordx4 v8, s[28:31], s54 offen sc1 lds
    s_add_u32 m0, s53, 57344
    s_add_u32 s54, s51, 1146880
    buffer_load_dwordx4 v9, s[28:31], s54 offen sc1 lds
    s_cmp_lt_u32 s25, 4
    s_cbranch_scc0 ffn2_kernel_d15a
    s_add_u32 m0, s53, 65536
    s_add_u32 s54, s51, 1146880
    buffer_load_dwordx4 v10, s[28:31], s54 offen sc1 lds
    s_branch ffn2_kernel_d15b
ffn2_kernel_d15a:
    s_add_u32 m0, s53, 65536
    s_add_u32 s54, s52, 229376
    buffer_load_dwordx4 v11, s[32:35], s54 offen sc1 lds
ffn2_kernel_d15b:
    s_waitcnt lgkmcnt(0)
    v_mfma_f32_32x32x16_bf16 v[40:55], v[24:27], v[28:31], v[40:55]
    ds_read_b128 v[36:39], v21 offset:1024
    ds_read_b64_tr_b16 v[32:33], v15 offset:5120
    ds_read_b64_tr_b16 v[34:35], v15 offset:6400
    s_waitcnt lgkmcnt(0)
    v_mfma_f32_32x32x16_bf16 v[40:55], v[32:35], v[36:39], v[40:55]
    ds_read_b128 v[28:31], v21 offset:2048
    ds_read_b64_tr_b16 v[24:25], v15 offset:10240
    ds_read_b64_tr_b16 v[26:27], v15 offset:11520
    s_waitcnt lgkmcnt(0)
    v_mfma_f32_32x32x16_bf16 v[40:55], v[24:27], v[28:31], v[40:55]
    ds_read_b128 v[36:39], v21 offset:3072
    ds_read_b64_tr_b16 v[32:33], v15 offset:15360
    ds_read_b64_tr_b16 v[34:35], v15 offset:16640
    s_waitcnt vmcnt(12) lgkmcnt(0)
    s_barrier
    v_mfma_f32_32x32x16_bf16 v[40:55], v[32:35], v[36:39], v[40:55]
    ds_read_b128 v[28:31], v22 offset:0
    ds_read_b64_tr_b16 v[24:25], v16 offset:0
    ds_read_b64_tr_b16 v[26:27], v16 offset:1280
    s_add_u32 m0, s53, 73728
    s_add_u32 s54, s51, 1228800
    buffer_load_dwordx4 v8, s[28:31], s54 offen sc1 lds
    s_add_u32 m0, s53, 81920
    s_add_u32 s54, s51, 1228800
    buffer_load_dwordx4 v9, s[28:31], s54 offen sc1 lds
    s_cmp_lt_u32 s25, 4
    s_cbranch_scc0 ffn2_kernel_d16a
    s_add_u32 m0, s53, 90112
    s_add_u32 s54, s51, 1228800
    buffer_load_dwordx4 v10, s[28:31], s54 offen sc1 lds
    s_branch ffn2_kernel_d16b
ffn2_kernel_d16a:
    s_add_u32 m0, s53, 90112
    s_add_u32 s54, s52, 245760
    buffer_load_dwordx4 v11, s[32:35], s54 offen sc1 lds
ffn2_kernel_d16b:
    s_waitcnt lgkmcnt(0)
    v_mfma_f32_32x32x16_bf16 v[40:55], v[24:27], v[28:31], v[40:55]
    ds_read_b128 v[36:39], v22 offset:1024
    ds_read_b64_tr_b16 v[32:33], v16 offset:5120
    ds_read_b64_tr_b16 v[34:35], v16 offset:6400
    s_waitcnt lgkmcnt(0)
    v_mfma_f32_32x32x16_bf16 v[40:55], v[32:35], v[36:39], v[40:55]
    ds_read_b128 v[28:31], v22 offset:2048
    ds_read_b64_tr_b16 v[24:25], v16 offset:10240
    ds_read_b64_tr_b16 v[26:27], v16 offset:11520
    s_waitcnt lgkmcnt(0)
    v_mfma_f32_32x32x16_bf16 v[40:55], v[24:27], v[28:31], v[40:55]
    ds_read_b128 v[36:39], v22 offset:3072
    ds_read_b64_tr_b16 v[32:33], v16 offset:15360
    ds_read_b64_tr_b16 v[34:35], v16 offset:16640
    s_waitcnt vmcnt(12) lgkmcnt(0)
    s_barrier
    v_mfma_f32_32x32x16_bf16 v[40:55], v[32:35], v[36:39], v[40:55]
    ds_read_b128 v[28:31], v23 offset:0
    ds_read_b64_tr_b16 v[24:25], v17 offset:0
    ds_read_b64_tr_b16 v[26:27], v17 offset:1280
    s_add_u32 m0, s53, 98304
    s_add_u32 s54, s51, 1310720
    buffer_load_dwordx4 v8, s[28:31], s54 offen sc1 lds
    s_add_u32 m0, s53, 106496
    s_add_u32 s54, s51, 1310720
    buffer_load_dwordx4 v9, s[28:31], s54 offen sc1 lds
    s_cmp_lt_u32 s25, 4
    s_cbranch_scc0 ffn2_kernel_d17a
    s_add_u32 m0, s53, 114688
    s_add_u32 s54, s51, 1310720
    buffer_load_dwordx4 v10, s[28:31], s54 offen sc1 lds
    s_branch ffn2_kernel_d17b
ffn2_kernel_d17a:
    s_add_u32 m0, s53, 114688
    s_add_u32 s54, s52, 262144
    buffer_load_dwordx4 v11, s[32:35], s54 offen sc1 lds
ffn2_kernel_d17b:
    s_waitcnt lgkmcnt(0)
    v_mfma_f32_32x32x16_bf16 v[40:55], v[24:27], v[28:31], v[40:55]
    ds_read_b128 v[36:39], v23 offset:1024
    ds_read_b64_tr_b16 v[32:33], v17 offset:5120
    ds_read_b64_tr_b16 v[34:35], v17 offset:6400
    s_waitcnt lgkmcnt(0)
    v_mfma_f32_32x32x16_bf16 v[40:55], v[32:35], v[36:39], v[40:55]
    ds_read_b128 v[28:31], v23 offset:2048
    ds_read_b64_tr_b16 v[24:25], v17 offset:10240
    ds_read_b64_tr_b16 v[26:27], v17 offset:11520
    s_waitcnt lgkmcnt(0)
    v_mfma_f32_32x32x16_bf16 v[40:55], v[24:27], v[28:31], v[40:55]
    ds_read_b128 v[36:39], v23 offset:3072
    ds_read_b64_tr_b16 v[32:33], v17 offset:15360
    ds_read_b64_tr_b16 v[34:35], v17 offset:16640
    s_waitcnt vmcnt(12) lgkmcnt(0)
    s_barrier
    v_mfma_f32_32x32x16_bf16 v[40:55], v[32:35], v[36:39], v[40:55]
    ds_read_b128 v[28:31], v18 offset:0
    ds_read_b64_tr_b16 v[24:25], v12 offset:0
    ds_read_b64_tr_b16 v[26:27], v12 offset:1280
    s_add_u32 m0, s53, 122880
    s_add_u32 s54, s51, 1392640
    buffer_load_dwordx4 v8, s[28:31], s54 offen sc1 lds
    s_add_u32 m0, s53, 131072
    s_add_u32 s54, s51, 1392640
    buffer_load_dwordx4 v9, s[28:31], s54 offen sc1 lds
    s_cmp_lt_u32 s25, 4
    s_cbranch_scc0 ffn2_kernel_d18a
    s_add_u32 m0, s53, 139264
    s_add_u32 s54, s51, 1392640
    buffer_load_dwordx4 v10, s[28:31], s54 offen sc1 lds
    s_branch ffn2_kernel_d18b
ffn2_kernel_d18a:
    s_add_u32 m0, s53, 139264
    s_add_u32 s54, s52, 278528
    buffer_load_dwordx4 v11, s[32:35], s54 offen sc1 lds
ffn2_kernel_d18b:
    s_waitcnt lgkmcnt(0)
    v_mfma_f32_32x32x16_bf16 v[40:55], v[24:27], v[28:31], v[40:55]
    ds_read_b128 v[36:39], v18 offset:1024
    ds_read_b64_tr_b16 v[32:33], v12 offset:5120
    ds_read_b64_tr_b16 v[34:35], v12 offset:6400
    s_waitcnt lgkmcnt(0)
    v_mfma_f32_32x32x16_bf16 v[40:55], v[32:35], v[36:39], v[40:55]
    ds_read_b128 v[28:31], v18 offset:2048
    ds_read_b64_tr_b16 v[24:25], v12 offset:10240
    ds_read_b64_tr_b16 v[26:27], v12 offset:11520
    s_waitcnt lgkmcnt(0)
    v_mfma_f32_32x32x16_bf16 v[40:55], v[24:27], v[28:31], v[40:55]
    ds_read_b128 v[36:39], v18 offset:3072
    ds_read_b64_tr_b16 v[32:33], v12 offset:15360
    ds_read_b64_tr_b16 v[34:35], v12 offset:16640
    s_waitcnt vmcnt(12) lgkmcnt(0)
    s_barrier
    v_mfma_f32_32x32x16_bf16 v[40:55], v[32:35], v[36:39], v[40:55]
    ds_read_b128 v[28:31], v19 offset:0
    ds_read_b64_tr_b16 v[24:25], v13 offset:0
    ds_read_b64_tr_b16 v[26:27], v13 offset:1280
    s_add_u32 m0, s53, 0
    s_add_u32 s54, s51, 1474560
    buffer_load_dwordx4 v8, s[28:31], s54 offen sc1 lds
    s_add_u32 m0, s53, 8192
    s_add_u32 s54, s51, 1474560
    buffer_load_dwordx4 v9, s[28:31], s54 offen sc1 lds
    s_cmp_lt_u32 s25, 4
    s_cbranch_scc0 ffn2_kernel_d19a
    s_add_u32 m0, s53, 16384
    s_add_u32 s54, s51, 1474560
    buffer_load_dwordx4 v10, s[28:31], s54 offen sc1 lds
    s_branch ffn2_kernel_d19b
ffn2_kernel_d19a:
    s_add_u32 m0, s53, 16384
    s_add_u32 s54, s52, 294912
    buffer_load_dwordx4 v11, s[32:35], s54 offen sc1 lds
ffn2_kernel_d19b:
    s_waitcnt lgkmcnt(0)
    v_mfma_f32_32x32x16_bf16 v[40:55], v[24:27], v[28:31], v[40:55]
    ds_read_b128 v[36:39], v19 offset:1024
    ds_read_b64_tr_b16 v[32:33], v13 offset:5120
    ds_read_b64_tr_b16 v[34:35], v13 offset:6400
    s_waitcnt lgkmcnt(0)
    v_mfma_f32_32x32x16_bf16 v[40:55], v[32:35], v[36:39], v[40:55]
    ds_read_b128 v[28:31], v19 offset:2048
    ds_read_b64_tr_b16 v[24:25], v13 offset:10240
    ds_read_b64_tr_b16 v[26:27], v13 offset:11520
    s_waitcnt lgkmcnt(0)
    v_mfma_f32_32x32x16_bf16 v[40:55], v[24:27], v[28:31], v[40:55]
    ds_read_b128 v[36:39], v19 offset:3072
    ds_read_b64_tr_b16 v[32:33], v13 offset:15360
    ds_read_b64_tr_b16 v[34:35], v13 offset:16640
    s_waitcnt vmcnt(12) lgkmcnt(0)
    s_barrier
    v_mfma_f32_32x32x16_bf16 v[40:55], v[32:35], v[36:39], v[40:55]
    ds_read_b128 v[28:31], v20 offset:0
    ds_read_b64_tr_b16 v[24:25], v14 offset:0
    ds_read_b64_tr_b16 v[26:27], v14 offset:1280
    s_add_u32 m0, s53, 24576
    s_add_u32 s54, s51, 1556480
    buffer_load_dwordx4 v8, s[28:31], s54 offen sc1 lds
    s_add_u32 m0, s53, 32768
    s_add_u32 s54, s51, 1556480
    buffer_load_dwordx4 v9, s[28:31], s54 offen sc1 lds
    s_cmp_lt_u32 s25, 4
    s_cbranch_scc0 ffn2_kernel_d20a
    s_add_u32 m0, s53, 40960
    s_add_u32 s54, s51, 1556480
    buffer_load_dwordx4 v10, s[28:31], s54 offen sc1 lds
    s_branch ffn2_kernel_d20b
ffn2_kernel_d20a:
    s_add_u32 m0, s53, 40960
    s_add_u32 s54, s52, 311296
    buffer_load_dwordx4 v11, s[32:35], s54 offen sc1 lds
ffn2_kernel_d20b:
    s_waitcnt lgkmcnt(0)
    v_mfma_f32_32x32x16_bf16 v[40:55], v[24:27], v[28:31], v[40:55]
    ds_read_b128 v[36:39], v20 offset:1024
    ds_read_b64_tr_b16 v[32:33], v14 offset:5120
    ds_read_b64_tr_b16 v[34:35], v14 offset:6400
    s_waitcnt lgkmcnt(0)
    v_mfma_f32_32x32x16_bf16 v[40:55], v[32:35], v[36:39], v[40:55]
    ds_read_b128 v[28:31], v20 offset:2048
    ds_read_b64_tr_b16 v[24:25], v14 offset:10240
    ds_read_b64_tr_b16 v[26:27], v14 offset:11520
    s_waitcnt lgkmcnt(0)
    v_mfma_f32_32x32x16_bf16 v[40:55], v[24:27], v[28:31], v[40:55]
    ds_read_b128 v[36:39], v20 offset:3072
    ds_read_b64_tr_b16 v[32:33], v14 offset:15360
    ds_read_b64_tr_b16 v[34:35], v14 offset:16640
    s_waitcnt vmcnt(12) lgkmcnt(0)
    s_barrier
    v_mfma_f32_32x32x16_bf16 v[40:55], v[32:35], v[36:39], v[40:55]
    ds_read_b128 v[28:31], v21 offset:0
    ds_read_b64_tr_b16 v[24:25], v15 offset:0
    ds_read_b64_tr_b16 v[26:27], v15 offset:1280
    s_add_u32 m0, s53, 49152
    s_add_u32 s54, s51, 1638400
    buffer_load_dwordx4 v8, s[28:31], s54 offen sc1 lds
    s_add_u32 m0, s53, 57344
    s_add_u32 s54, s51, 1638400
    buffer_load_dwordx4 v9, s[28:31], s54 offen sc1 lds
    s_cmp_lt_u32 s25, 4
    s_cbranch_scc0 ffn2_kernel_d21a
    s_add_u32 m0, s53, 65536
    s_add_u32 s54, s51, 1638400
    buffer_load_dwordx4 v10, s[28:31], s54 offen sc1 lds
    s_branch ffn2_kernel_d21b
ffn2_kernel_d21a:
    s_add_u32 m0, s53, 65536
    s_add_u32 s54, s52, 327680
    buffer_load_dwordx4 v11, s[32:35], s54 offen sc1 lds
ffn2_kernel_d21b:
    s_waitcnt lgkmcnt(0)
    v_mfma_f32_32x32x16_bf16 v[40:55], v[24:27], v[28:31], v[40:55]
    ds_read_b128 v[36:39], v21 offset:1024
    ds_read_b64_tr_b16 v[32:33], v15 offset:5120
    ds_read_b64_tr_b16 v[34:35], v15 offset:6400
    s_waitcnt lgkmcnt(0)
    v_mfma_f32_32x32x16_bf16 v[40:55], v[32:35], v[36:39], v[40:55]
    ds_read_b128 v[28:31], v21 offset:2048
    ds_read_b64_tr_b16 v[24:25], v15 offset:10240
    ds_read_b64_tr_b16 v[26:27], v15 offset:11520
    s_waitcnt lgkmcnt(0)
    v_mfma_f32_32x32x16_bf16 v[40:55], v[24:27], v[28:31], v[40:55]
    ds_read_b128 v[36:39], v21 offset:3072
    ds_read_b64_tr_b16 v[32:33], v15 offset:15360
    ds_read_b64_tr_b16 v[34:35], v15 offset:16640
    s_waitcnt vmcnt(12) lgkmcnt(0)
    s_barrier
    v_mfma_f32_32x32x16_bf16 v[40:55], v[32:35], v[36:39], v[40:55]
    ds_read_b128 v[28:31], v22 offset:0
    ds_read_b64_tr_b16 v[24:25], v16 offset:0
    ds_read_b64_tr_b16 v[26:27], v16 offset:1280
    s_add_u32 m0, s53, 73728
    s_add_u32 s54, s51, 1720320
    buffer_load_dwordx4 v8, s[28:31], s54 offen sc1 lds
    s_add_u32 m0, s53, 81920
    s_add_u32 s54, s51, 1720320
    buffer_load_dwordx4 v9, s[28:31], s54 offen sc1 lds
    s_cmp_lt_u32 s25, 4
    s_cbranch_scc0 ffn2_kernel_d22a
    s_add_u32 m0, s53, 90112
    s_add_u32 s54, s51, 1720320
    buffer_load_dwordx4 v10, s[28:31], s54 offen sc1 lds
    s_branch ffn2_kernel_d22b
ffn2_kernel_d22a:
    s_add_u32 m0, s53, 90112
    s_add_u32 s54, s52, 344064
    buffer_load_dwordx4 v11, s[32:35], s54 offen sc1 lds
ffn2_kernel_d22b:
    s_waitcnt lgkmcnt(0)
    v_mfma_f32_32x32x16_bf16 v[40:55], v[24:27], v[28:31], v[40:55]
    ds_read_b128 v[36:39], v22 offset:1024
    ds_read_b64_tr_b16 v[32:33], v16 offset:5120
    ds_read_b64_tr_b16 v[34:35], v16 offset:6400
    s_waitcnt lgkmcnt(0)
    v_mfma_f32_32x32x16_bf16 v[40:55], v[32:35], v[36:39], v[40:55]
    ds_read_b128 v[28:31], v22 offset:2048
    ds_read_b64_tr_b16 v[24:25], v16 offset:10240
    ds_read_b64_tr_b16 v[26:27], v16 offset:11520
    s_waitcnt lgkmcnt(0)
    v_mfma_f32_32x32x16_bf16 v[40:55], v[24:27], v[28:31], v[40:55]
    ds_read_b128 v[36:39], v22 offset:3072
    ds_read_b64_tr_b16 v[32:33], v16 offset:15360
    ds_read_b64_tr_b16 v[34:35], v16 offset:16640
    s_waitcnt vmcnt(12) lgkmcnt(0)
    s_barrier
    v_mfma_f32_32x32x16_bf16 v[40:55], v[32:35], v[36:39], v[40:55]
    ds_read_b128 v[28:31], v23 offset:0
    ds_read_b64_tr_b16 v[24:25], v17 offset:0
    ds_read_b64_tr_b16 v[26:27], v17 offset:1280
    s_add_u32 m0, s53, 98304
    s_add_u32 s54, s51, 1802240
    buffer_load_dwordx4 v8, s[28:31], s54 offen sc1 lds
    s_add_u32 m0, s53, 106496
    s_add_u32 s54, s51, 1802240
    buffer_load_dwordx4 v9, s[28:31], s54 offen sc1 lds
    s_cmp_lt_u32 s25, 4
    s_cbranch_scc0 ffn2_kernel_d23a
    s_add_u32 m0, s53, 114688
    s_add_u32 s54, s51, 1802240
    buffer_load_dwordx4 v10, s[28:31], s54 offen sc1 lds
    s_branch ffn2_kernel_d23b
ffn2_kernel_d23a:
    s_add_u32 m0, s53, 114688
    s_add_u32 s54, s52, 360448
    buffer_load_dwordx4 v11, s[32:35], s54 offen sc1 lds
ffn2_kernel_d23b:
    s_waitcnt lgkmcnt(0)
    v_mfma_f32_32x32x16_bf16 v[40:55], v[24:27], v[28:31], v[40:55]
    ds_read_b128 v[36:39], v23 offset:1024
    ds_read_b64_tr_b16 v[32:33], v17 offset:5120
    ds_read_b64_tr_b16 v[34:35], v17 offset:6400
    s_waitcnt lgkmcnt(0)
    v_mfma_f32_32x32x16_bf16 v[40:55], v[32:35], v[36:39], v[40:55]
    ds_read_b128 v[28:31], v23 offset:2048
    ds_read_b64_tr_b16 v[24:25], v17 offset:10240
    ds_read_b64_tr_b16 v[26:27], v17 offset:11520
    s_waitcnt lgkmcnt(0)
    v_mfma_f32_32x32x16_bf16 v[40:55], v[24:27], v[28:31], v[40:55]
    ds_read_b128 v[36:39], v23 offset:3072
    ds_read_b64_tr_b16 v[32:33], v17 offset:15360
    ds_read_b64_tr_b16 v[34:35], v17 offset:16640
    s_waitcnt vmcnt(12) lgkmcnt(0)
    s_barrier
    v_mfma_f32_32x32x16_bf16 v[40:55], v[32:35], v[36:39], v[40:55]
    ds_read_b128 v[28:31], v18 offset:0
    ds_read_b64_tr_b16 v[24:25], v12 offset:0
    ds_read_b64_tr_b16 v[26:27], v12 offset:1280
    s_add_u32 m0, s53, 122880
    s_add_u32 s54, s51, 1884160
    buffer_load_dwordx4 v8, s[28:31], s54 offen sc1 lds
    s_add_u32 m0, s53, 131072
    s_add_u32 s54, s51, 1884160
    buffer_load_dwordx4 v9, s[28:31], s54 offen sc1 lds
    s_cmp_lt_u32 s25, 4
    s_cbranch_scc0 ffn2_kernel_d24a
    s_add_u32 m0, s53, 139264
    s_add_u32 s54, s51, 1884160
    buffer_load_dwordx4 v10, s[28:31], s54 offen sc1 lds
    s_branch ffn2_kernel_d24b
ffn2_kernel_d24a:
    s_add_u32 m0, s53, 139264
    s_add_u32 s54, s52, 376832
    buffer_load_dwordx4 v11, s[32:35], s54 offen sc1 lds
ffn2_kernel_d24b:
    s_waitcnt lgkmcnt(0)
    v_mfma_f32_32x32x16_bf16 v[40:55], v[24:27], v[28:31], v[40:55]
    ds_read_b128 v[36:39], v18 offset:1024
    ds_read_b64_tr_b16 v[32:33], v12 offset:5120
    ds_read_b64_tr_b16 v[34:35], v12 offset:6400
    s_waitcnt lgkmcnt(0)
    v_mfma_f32_32x32x16_bf16 v[40:55], v[32:35], v[36:39], v[40:55]
    ds_read_b128 v[28:31], v18 offset:2048
    ds_read_b64_tr_b16 v[24:25], v12 offset:10240
    ds_read_b64_tr_b16 v[26:27], v12 offset:11520
    s_waitcnt lgkmcnt(0)
    v_mfma_f32_32x32x16_bf16 v[40:55], v[24:27], v[28:31], v[40:55]
    ds_read_b128 v[36:39], v18 offset:3072
    ds_read_b64_tr_b16 v[32:33], v12 offset:15360
    ds_read_b64_tr_b16 v[34:35], v12 offset:16640
    s_waitcnt vmcnt(12) lgkmcnt(0)
    s_barrier
    v_mfma_f32_32x32x16_bf16 v[40:55], v[32:35], v[36:39], v[40:55]
    ds_read_b128 v[28:31], v19 offset:0
    ds_read_b64_tr_b16 v[24:25], v13 offset:0
    ds_read_b64_tr_b16 v[26:27], v13 offset:1280
    s_add_u32 m0, s53, 0
    s_add_u32 s54, s51, 1966080
    buffer_load_dwordx4 v8, s[28:31], s54 offen sc1 lds
    s_add_u32 m0, s53, 8192
    s_add_u32 s54, s51, 1966080
    buffer_load_dwordx4 v9, s[28:31], s54 offen sc1 lds
    s_cmp_lt_u32 s25, 4
    s_cbranch_scc0 ffn2_kernel_d25a
    s_add_u32 m0, s53, 16384
    s_add_u32 s54, s51, 1966080
    buffer_load_dwordx4 v10, s[28:31], s54 offen sc1 lds
    s_branch ffn2_kernel_d25b
ffn2_kernel_d25a:
    s_add_u32 m0, s53, 16384
    s_add_u32 s54, s52, 393216
    buffer_load_dwordx4 v11, s[32:35], s54 offen sc1 lds
ffn2_kernel_d25b:
    s_waitcnt lgkmcnt(0)
    v_mfma_f32_32x32x16_bf16 v[40:55], v[24:27], v[28:31], v[40:55]
    ds_read_b128 v[36:39], v19 offset:1024
    ds_read_b64_tr_b16 v[32:33], v13 offset:5120
    ds_read_b64_tr_b16 v[34:35], v13 offset:6400
    s_waitcnt lgkmcnt(0)
    v_mfma_f32_32x32x16_bf16 v[40:55], v[32:35], v[36:39], v[40:55]
    ds_read_b128 v[28:31], v19 offset:2048
    ds_read_b64_tr_b16 v[24:25], v13 offset:10240
    ds_read_b64_tr_b16 v[26:27], v13 offset:11520
    s_waitcnt lgkmcnt(0)
    v_mfma_f32_32x32x16_bf16 v[40:55], v[24:27], v[28:31], v[40:55]
    ds_read_b128 v[36:39], v19 offset:3072
    ds_read_b64_tr_b16 v[32:33], v13 offset:15360
    ds_read_b64_tr_b16 v[34:35], v13 offset:16640
    s_waitcnt vmcnt(12) lgkmcnt(0)
    s_barrier
    v_mfma_f32_32x32x16_bf16 v[40:55], v[32:35], v[36:39], v[40:55]
    ds_read_b128 v[28:31], v20 offset:0
    ds_read_b64_tr_b16 v[24:25], v14 offset:0
    ds_read_b64_tr_b16 v[26:27], v14 offset:1280
    s_add_u32 m0, s53, 24576
    s_add_u32 s54, s51, 2048000
    buffer_load_dwordx4 v8, s[28:31], s54 offen sc1 lds
    s_add_u32 m0, s53, 32768
    s_add_u32 s54, s51, 2048000
    buffer_load_dwordx4 v9, s[28:31], s54 offen sc1 lds
    s_cmp_lt_u32 s25, 4
    s_cbranch_scc0 ffn2_kernel_d26a
    s_add_u32 m0, s53, 40960
    s_add_u32 s54, s51, 2048000
    buffer_load_dwordx4 v10, s[28:31], s54 offen sc1 lds
    s_branch ffn2_kernel_d26b
ffn2_kernel_d26a:
    s_add_u32 m0, s53, 40960
    s_add_u32 s54, s52, 409600
    buffer_load_dwordx4 v11, s[32:35], s54 offen sc1 lds
ffn2_kernel_d26b:
    s_waitcnt lgkmcnt(0)
    v_mfma_f32_32x32x16_bf16 v[40:55], v[24:27], v[28:31], v[40:55]
    ds_read_b128 v[36:39], v20 offset:1024
    ds_read_b64_tr_b16 v[32:33], v14 offset:5120
    ds_read_b64_tr_b16 v[34:35], v14 offset:6400
    s_waitcnt lgkmcnt(0)
    v_mfma_f32_32x32x16_bf16 v[40:55], v[32:35], v[36:39], v[40:55]
    ds_read_b128 v[28:31], v20 offset:2048
    ds_read_b64_tr_b16 v[24:25], v14 offset:10240
    ds_read_b64_tr_b16 v[26:27], v14 offset:11520
    s_waitcnt lgkmcnt(0)
    v_mfma_f32_32x32x16_bf16 v[40:55], v[24:27], v[28:31], v[40:55]
    ds_read_b128 v[36:39], v20 offset:3072
    ds_read_b64_tr_b16 v[32:33], v14 offset:15360
    ds_read_b64_tr_b16 v[34:35], v14 offset:16640
    s_waitcnt vmcnt(12) lgkmcnt(0)
    s_barrier
    v_mfma_f32_32x32x16_bf16 v[40:55], v[32:35], v[36:39], v[40:55]
    ds_read_b128 v[28:31], v21 offset:0
    ds_read_b64_tr_b16 v[24:25], v15 offset:0
    ds_read_b64_tr_b16 v[26:27], v15 offset:1280
    s_add_u32 m0, s53, 49152
    s_add_u32 s54, s51, 2129920
    buffer_load_dwordx4 v8, s[28:31], s54 offen sc1 lds
    s_add_u32 m0, s53, 57344
    s_add_u32 s54, s51, 2129920
    buffer_load_dwordx4 v9, s[28:31], s54 offen sc1 lds
    s_cmp_lt_u32 s25, 4
    s_cbranch_scc0 ffn2_kernel_d27a
    s_add_u32 m0, s53, 65536
    s_add_u32 s54, s51, 2129920
    buffer_load_dwordx4 v10, s[28:31], s54 offen sc1 lds
    s_branch ffn2_kernel_d27b
ffn2_kernel_d27a:
    s_add_u32 m0, s53, 65536
    s_add_u32 s54, s52, 425984
    buffer_load_dwordx4 v11, s[32:35], s54 offen sc1 lds
ffn2_kernel_d27b:
    s_waitcnt lgkmcnt(0)
    v_mfma_f32_32x32x16_bf16 v[40:55], v[24:27], v[28:31], v[40:55]
    ds_read_b128 v[36:39], v21 offset:1024
    ds_read_b64_tr_b16 v[32:33], v15 offset:5120
    ds_read_b64_tr_b16 v[34:35], v15 offset:6400
    s_waitcnt lgkmcnt(0)
    v_mfma_f32_32x32x16_bf16 v[40:55], v[32:35], v[36:39], v[40:55]
    ds_read_b128 v[28:31], v21 offset:2048
    ds_read_b64_tr_b16 v[24:25], v15 offset:10240
    ds_read_b64_tr_b16 v[26:27], v15 offset:11520
    s_waitcnt lgkmcnt(0)
    v_mfma_f32_32x32x16_bf16 v[40:55], v[24:27], v[28:31], v[40:55]
    ds_read_b128 v[36:39], v21 offset:3072
    ds_read_b64_tr_b16 v[32:33], v15 offset:15360
    ds_read_b64_tr_b16 v[34:35], v15 offset:16640
    s_waitcnt vmcnt(12) lgkmcnt(0)
    s_barrier
    v_mfma_f32_32x32x16_bf16 v[40:55], v[32:35], v[36:39], v[40:55]
    ds_read_b128 v[28:31], v22 offset:0
    ds_read_b64_tr_b16 v[24:25], v16 offset:0
    ds_read_b64_tr_b16 v[26:27], v16 offset:1280
    s_waitcnt lgkmcnt(0)
    v_mfma_f32_32x32x16_bf16 v[40:55], v[24:27], v[28:31], v[40:55]
    ds_read_b128 v[36:39], v22 offset:1024
    ds_read_b64_tr_b16 v[32:33], v16 offset:5120
    ds_read_b64_tr_b16 v[34:35], v16 offset:6400
    s_waitcnt lgkmcnt(0)
    v_mfma_f32_32x32x16_bf16 v[40:55], v[32:35], v[36:39], v[40:55]
    ds_read_b128 v[28:31], v22 offset:2048
    ds_read_b64_tr_b16 v[24:25], v16 offset:10240
    ds_read_b64_tr_b16 v[26:27], v16 offset:11520
    s_waitcnt lgkmcnt(0)
    v_mfma_f32_32x32x16_bf16 v[40:55], v[24:27], v[28:31], v[40:55]
    ds_read_b128 v[36:39], v22 offset:3072
    ds_read_b64_tr_b16 v[32:33], v16 offset:15360
    ds_read_b64_tr_b16 v[34:35], v16 offset:16640
    s_waitcnt vmcnt(9) lgkmcnt(0)
    s_barrier
    v_mfma_f32_32x32x16_bf16 v[40:55], v[32:35], v[36:39], v[40:55]
    ds_read_b128 v[28:31], v23 offset:0
    ds_read_b64_tr_b16 v[24:25], v17 offset:0
    ds_read_b64_tr_b16 v[26:27], v17 offset:1280
    s_waitcnt lgkmcnt(0)
    v_mfma_f32_32x32x16_bf16 v[40:55], v[24:27], v[28:31], v[40:55]
    ds_read_b128 v[36:39], v23 offset:1024
    ds_read_b64_tr_b16 v[32:33], v17 offset:5120
    ds_read_b64_tr_b16 v[34:35], v17 offset:6400
    s_waitcnt lgkmcnt(0)
    v_mfma_f32_32x32x16_bf16 v[40:55], v[32:35], v[36:39], v[40:55]
    ds_read_b128 v[28:31], v23 offset:2048
    ds_read_b64_tr_b16 v[24:25], v17 offset:10240
    ds_read_b64_tr_b16 v[26:27], v17 offset:11520
    s_waitcnt lgkmcnt(0)
    v_mfma_f32_32x32x16_bf16 v[40:55], v[24:27], v[28:31], v[40:55]
    ds_read_b128 v[36:39], v23 offset:3072
    ds_read_b64_tr_b16 v[32:33], v17 offset:15360
    ds_read_b64_tr_b16 v[34:35], v17 offset:16640
    s_waitcnt vmcnt(6) lgkmcnt(0)
    s_barrier
    v_mfma_f32_32x32x16_bf16 v[40:55], v[32:35], v[36:39], v[40:55]
    ds_read_b128 v[28:31], v18 offset:0
    ds_read_b64_tr_b16 v[24:25], v12 offset:0
    ds_read_b64_tr_b16 v[26:27], v12 offset:1280
    s_waitcnt lgkmcnt(0)
    v_mfma_f32_32x32x16_bf16 v[40:55], v[24:27], v[28:31], v[40:55]
    ds_read_b128 v[36:39], v18 offset:1024
    ds_read_b64_tr_b16 v[32:33], v12 offset:5120
    ds_read_b64_tr_b16 v[34:35], v12 offset:6400
    s_waitcnt lgkmcnt(0)
    v_mfma_f32_32x32x16_bf16 v[40:55], v[32:35], v[36:39], v[40:55]
    ds_read_b128 v[28:31], v18 offset:2048
    ds_read_b64_tr_b16 v[24:25], v12 offset:10240
    ds_read_b64_tr_b16 v[26:27], v12 offset:11520
    s_waitcnt lgkmcnt(0)
    v_mfma_f32_32x32x16_bf16 v[40:55], v[24:27], v[28:31], v[40:55]
    ds_read_b128 v[36:39], v18 offset:3072
    ds_read_b64_tr_b16 v[32:33], v12 offset:15360
    ds_read_b64_tr_b16 v[34:35], v12 offset:16640
    s_waitcnt vmcnt(3) lgkmcnt(0)
    s_barrier
    v_mfma_f32_32x32x16_bf16 v[40:55], v[32:35], v[36:39], v[40:55]
    ds_read_b128 v[28:31], v19 offset:0
    ds_read_b64_tr_b16 v[24:25], v13 offset:0
    ds_read_b64_tr_b16 v[26:27], v13 offset:1280
    s_waitcnt lgkmcnt(0)
    v_mfma_f32_32x32x16_bf16 v[40:55], v[24:27], v[28:31], v[40:55]
    ds_read_b128 v[36:39], v19 offset:1024
    ds_read_b64_tr_b16 v[32:33], v13 offset:5120
    ds_read_b64_tr_b16 v[34:35], v13 offset:6400
    s_waitcnt lgkmcnt(0)
    v_mfma_f32_32x32x16_bf16 v[40:55], v[32:35], v[36:39], v[40:55]
    ds_read_b128 v[28:31], v19 offset:2048
    ds_read_b64_tr_b16 v[24:25], v13 offset:10240
    ds_read_b64_tr_b16 v[26:27], v13 offset:11520
    s_waitcnt lgkmcnt(0)
    v_mfma_f32_32x32x16_bf16 v[40:55], v[24:27], v[28:31], v[40:55]
    ds_read_b128 v[36:39], v19 offset:3072
    ds_read_b64_tr_b16 v[32:33], v13 offset:15360
    ds_read_b64_tr_b16 v[34:35], v13 offset:16640
    s_waitcnt vmcnt(0) lgkmcnt(0)
    s_barrier
    v_mfma_f32_32x32x16_bf16 v[40:55], v[32:35], v[36:39], v[40:55]
    ds_read_b128 v[28:31], v20 offset:0
    ds_read_b64_tr_b16 v[24:25], v14 offset:0
    ds_read_b64_tr_b16 v[26:27], v14 offset:1280
    s_waitcnt lgkmcnt(0)
    v_mfma_f32_32x32x16_bf16 v[40:55], v[24:27], v[28:31], v[40:55]
    ds_read_b128 v[36:39], v20 offset:1024
    ds_read_b64_tr_b16 v[32:33], v14 offset:5120
    ds_read_b64_tr_b16 v[34:35], v14 offset:6400
    s_waitcnt lgkmcnt(0)
    v_mfma_f32_32x32x16_bf16 v[40:55], v[32:35], v[36:39], v[40:55]
    ds_read_b128 v[28:31], v20 offset:2048
    ds_read_b64_tr_b16 v[24:25], v14 offset:10240
    ds_read_b64_tr_b16 v[26:27], v14 offset:11520
    s_waitcnt lgkmcnt(0)
    v_mfma_f32_32x32x16_bf16 v[40:55], v[24:27], v[28:31], v[40:55]
    ds_read_b128 v[36:39], v20 offset:3072
    ds_read_b64_tr_b16 v[32:33], v14 offset:15360
    ds_read_b64_tr_b16 v[34:35], v14 offset:16640
    s_waitcnt lgkmcnt(0)
    v_mfma_f32_32x32x16_bf16 v[40:55], v[32:35], v[36:39], v[40:55]
    s_branch ffn2_kernel_comp_done
ffn2_kernel_dmaonly:
    s_waitcnt vmcnt(5)
    s_barrier
    s_waitcnt vmcnt(4) lgkmcnt(0)
    s_barrier
    s_add_u32 m0, s53, 0
    s_add_u32 s54, s51, 491520
    buffer_load_dwordx4 v8, s[28:31], s54 offen sc1 lds
    s_add_u32 m0, s53, 8192
    s_add_u32 s54, s51, 491520
    buffer_load_dwordx4 v9, s[28:31], s54 offen sc1 lds
    s_cmp_lt_u32 s25, 4
    s_cbranch_scc0 ffn2_kernel_d28a
    s_add_u32 m0, s53, 16384
    s_add_u32 s54, s51, 491520
    buffer_load_dwordx4 v10, s[28:31], s54 offen sc1 lds
    s_branch ffn2_kernel_d28b
ffn2_kernel_d28a:
    s_add_u32 m0, s53, 16384
    s_add_u32 s54, s52, 98304
    buffer_load_dwordx4 v11, s[32:35], s54 offen sc1 lds
ffn2_kernel_d28b:
    s_waitcnt vmcnt(6) lgkmcnt(0)
    s_barrier
    s_add_u32 m0, s53, 24576
    s_add_u32 s54, s51, 573440
    buffer_load_dwordx4 v8, s[28:31], s54 offen sc1 lds
    s_add_u32 m0, s53, 32768
    s_add_u32 s54, s51, 573440
    buffer_load_dwordx4 v9, s[28:31], s54 offen sc1 lds
    s_cmp_lt_u32 s25, 4
    s_cbranch_scc0 ffn2_kernel_d29a
    s_add_u32 m0, s53, 40960
    s_add_u32 s54, s51, 573440
    buffer_load_dwordx4 v10, s[28:31], s54 offen sc1 lds
    s_branch ffn2_kernel_d29b
ffn2_kernel_d29a:
    s_add_u32 m0, s53, 40960
    s_add_u32 s54, s52, 114688
    buffer_load_dwordx4 v11, s[32:35], s54 offen sc1 lds
ffn2_kernel_d29b:
    s_waitcnt vmcnt(8) lgkmcnt(0)
    s_barrier
    s_add_u32 m0, s53, 49152
    s_add_u32 s54, s51, 655360
    buffer_load_dwordx4 v8, s[28:31], s54 offen sc1 lds
    s_add_u32 m0, s53, 57344
    s_add_u32 s54, s51, 655360
    buffer_load_dwordx4 v9, s[28:31], s54 offen sc1 lds
    s_cmp_lt_u32 s25, 4
    s_cbranch_scc0 ffn2_kernel_d30a
    s_add_u32 m0, s53, 65536
    s_add_u32 s54, s51, 655360
    buffer_load_dwordx4 v10, s[28:31], s54 offen sc1 lds
    s_branch ffn2_kernel_d30b
ffn2_kernel_d30a:
    s_add_u32 m0, s53, 65536
    s_add_u32 s54, s52, 131072
    buffer_load_dwordx4 v11, s[32:35], s54 offen sc1 lds
ffn2_kernel_d30b:
    s_waitcnt vmcnt(10) lgkmcnt(0)
    s_barrier
    s_add_u32 m0, s53, 73728
    s_add_u32 s54, s51, 737280
    buffer_load_dwordx4 v8, s[28:31], s54 offen sc1 lds
    s_add_u32 m0, s53, 81920
    s_add_u32 s54, s51, 737280
    buffer_load_dwordx4 v9, s[28:31], s54 offen sc1 lds
    s_cmp_lt_u32 s25, 4
    s_cbranch_scc0 ffn2_kernel_d31a
    s_add_u32 m0, s53, 90112
    s_add_u32 s54, s51, 737280
    buffer_load_dwordx4 v10, s[28:31], s54 offen sc1 lds
    s_branch ffn2_kernel_d31b
ffn2_kernel_d31a:
    s_add_u32 m0, s53, 90112
    s_add_u32 s54, s52, 147456
    buffer_load_dwordx4 v11, s[32:35], s54 offen sc1 lds
ffn2_kernel_d31b:
    s_waitcnt vmcnt(12) lgkmcnt(0)
    s_barrier
    s_add_u32 m0, s53, 98304
    s_add_u32 s54, s51, 819200
    buffer_load_dwordx4 v8, s[28:31], s54 offen sc1 lds
    s_add_u32 m0, s53, 106496
    s_add_u32 s54, s51, 819200
    buffer_load_dwordx4 v9, s[28:31], s54 offen sc1 lds
    s_cmp_lt_u32 s25, 4
    s_cbranch_scc0 ffn2_kernel_d32a
    s_add_u32 m0, s53, 114688
    s_add_u32 s54, s51, 819200
    buffer_load_dwordx4 v10, s[28:31], s54 offen sc1 lds
    s_branch ffn2_kernel_d32b
ffn2_kernel_d32a:
    s_add_u32 m0, s53, 114688
    s_add_u32 s54, s52, 163840
    buffer_load_dwordx4 v11, s[32:35], s54 offen sc1 lds
ffn2_kernel_d32b:
    s_waitcnt vmcnt(12) lgkmcnt(0)
    s_barrier
    s_add_u32 m0, s53, 122880
    s_add_u32 s54, s51, 901120
    buffer_load_dwordx4 v8, s[28:31], s54 offen sc1 lds
    s_add_u32 m0, s53, 131072
    s_add_u32 s54, s51, 901120
    buffer_load_dwordx4 v9, s[28:31], s54 offen sc1 lds
    s_cmp_lt_u32 s25, 4
    s_cbranch_scc0 ffn2_kernel_d33a
    s_add_u32 m0, s53, 139264
    s_add_u32 s54, s51, 901120
    buffer_load_dwordx4 v10, s[28:31], s54 offen sc1 lds
    s_branch ffn2_kernel_d33b
ffn2_kernel_d33a:
    s_add_u32 m0, s53, 139264
    s_add_u32 s54, s52, 180224
    buffer_load_dwordx4 v11, s[32:35], s54 offen sc1 lds
ffn2_kernel_d33b:
    s_waitcnt vmcnt(12) lgkmcnt(0)
    s_barrier
    s_add_u32 m0, s53, 0
    s_add_u32 s54, s51, 983040
    buffer_load_dwordx4 v8, s[28:31], s54 offen sc1 lds
    s_add_u32 m0, s53, 8192
    s_add_u32 s54, s51, 983040
    buffer_load_dwordx4 v9, s[28:31], s54 offen sc1 lds
    s_cmp_lt_u32 s25, 4
    s_cbranch_scc0 ffn2_kernel_d34a
    s_add_u32 m0, s53, 16384
    s_add_u32 s54, s51, 983040
    buffer_load_dwordx4 v10, s[28:31], s54 offen sc1 lds
    s_branch ffn2_kernel_d34b
ffn2_kernel_d34a:
    s_add_u32 m0, s53, 16384
    s_add_u32 s54, s52, 196608
    buffer_load_dwordx4 v11, s[32:35], s54 offen sc1 lds
ffn2_kernel_d34b:
    s_waitcnt vmcnt(12) lgkmcnt(0)
    s_barrier
    s_add_u32 m0, s53, 24576
    s_add_u32 s54, s51, 1064960
    buffer_load_dwordx4 v8, s[28:31], s54 offen sc1 lds
    s_add_u32 m0, s53, 32768
    s_add_u32 s54, s51, 1064960
    buffer_load_dwordx4 v9, s[28:31], s54 offen sc1 lds
    s_cmp_lt_u32 s25, 4
    s_cbranch_scc0 ffn2_kernel_d35a
    s_add_u32 m0, s53, 40960
    s_add_u32 s54, s51, 1064960
    buffer_load_dwordx4 v10, s[28:31], s54 offen sc1 lds
    s_branch ffn2_kernel_d35b
ffn2_kernel_d35a:
    s_add_u32 m0, s53, 40960
    s_add_u32 s54, s52, 212992
    buffer_load_dwordx4 v11, s[32:35], s54 offen sc1 lds
ffn2_kernel_d35b:
    s_waitcnt vmcnt(12) lgkmcnt(0)
    s_barrier
    s_add_u32 m0, s53, 49152
    s_add_u32 s54, s51, 1146880
    buffer_load_dwordx4 v8, s[28:31], s54 offen sc1 lds
    s_add_u32 m0, s53, 57344
    s_add_u32 s54, s51, 1146880
    buffer_load_dwordx4 v9, s[28:31], s54 offen sc1 lds
    s_cmp_lt_u32 s25, 4
    s_cbranch_scc0 ffn2_kernel_d36a
    s_add_u32 m0, s53, 65536
    s_add_u32 s54, s51, 1146880
    buffer_load_dwordx4 v10, s[28:31], s54 offen sc1 lds
    s_branch ffn2_kernel_d36b
ffn2_kernel_d36a:
    s_add_u32 m0, s53, 65536
    s_add_u32 s54, s52, 229376
    buffer_load_dwordx4 v11, s[32:35], s54 offen sc1 lds
ffn2_kernel_d36b:
    s_waitcnt vmcnt(12) lgkmcnt(0)
    s_barrier
    s_add_u32 m0, s53, 73728
    s_add_u32 s54, s51, 1228800
    buffer_load_dwordx4 v8, s[28:31], s54 offen sc1 lds
    s_add_u32 m0, s53, 81920
    s_add_u32 s54, s51, 1228800
    buffer_load_dwordx4 v9, s[28:31], s54 offen sc1 lds
    s_cmp_lt_u32 s25, 4
    s_cbranch_scc0 ffn2_kernel_d37a
    s_add_u32 m0, s53, 90112
    s_add_u32 s54, s51, 1228800
    buffer_load_dwordx4 v10, s[28:31], s54 offen sc1 lds
    s_branch ffn2_kernel_d37b
ffn2_kernel_d37a:
    s_add_u32 m0, s53, 90112
    s_add_u32 s54, s52, 245760
    buffer_load_dwordx4 v11, s[32:35], s54 offen sc1 lds
ffn2_kernel_d37b:
    s_waitcnt vmcnt(12) lgkmcnt(0)
    s_barrier
    s_add_u32 m0, s53, 98304
    s_add_u32 s54, s51, 1310720
    buffer_load_dwordx4 v8, s[28:31], s54 offen sc1 lds
    s_add_u32 m0, s53, 106496
    s_add_u32 s54, s51, 1310720
    buffer_load_dwordx4 v9, s[28:31], s54 offen sc1 lds
    s_cmp_lt_u32 s25, 4
    s_cbranch_scc0 ffn2_kernel_d38a
    s_add_u32 m0, s53, 114688
    s_add_u32 s54, s51, 1310720
    buffer_load_dwordx4 v10, s[28:31], s54 offen sc1 lds
    s_branch ffn2_kernel_d38b
ffn2_kernel_d38a:
    s_add_u32 m0, s53, 114688
    s_add_u32 s54, s52, 262144
    buffer_load_dwordx4 v11, s[32:35], s54 offen sc1 lds
ffn2_kernel_d38b:
    s_waitcnt vmcnt(12) lgkmcnt(0)
    s_barrier
    s_add_u32 m0, s53, 122880
    s_add_u32 s54, s51, 1392640
    buffer_load_dwordx4 v8, s[28:31], s54 offen sc1 lds
    s_add_u32 m0, s53, 131072
    s_add_u32 s54, s51, 1392640
    buffer_load_dwordx4 v9, s[28:31], s54 offen sc1 lds
    s_cmp_lt_u32 s25, 4
    s_cbranch_scc0 ffn2_kernel_d39a
    s_add_u32 m0, s53, 139264
    s_add_u32 s54, s51, 1392640
    buffer_load_dwordx4 v10, s[28:31], s54 offen sc1 lds
    s_branch ffn2_kernel_d39b
ffn2_kernel_d39a:
    s_add_u32 m0, s53, 139264
    s_add_u32 s54, s52, 278528
    buffer_load_dwordx4 v11, s[32:35], s54 offen sc1 lds
ffn2_kernel_d39b:
    s_waitcnt vmcnt(12) lgkmcnt(0)
    s_barrier
    s_add_u32 m0, s53, 0
    s_add_u32 s54, s51, 1474560
    buffer_load_dwordx4 v8, s[28:31], s54 offen sc1 lds
    s_add_u32 m0, s53, 8192
    s_add_u32 s54, s51, 1474560
    buffer_load_dwordx4 v9, s[28:31], s54 offen sc1 lds
    s_cmp_lt_u32 s25, 4
    s_cbranch_scc0 ffn2_kernel_d40a
    s_add_u32 m0, s53, 16384
    s_add_u32 s54, s51, 1474560
    buffer_load_dwordx4 v10, s[28:31], s54 offen sc1 lds
    s_branch ffn2_kernel_d40b
ffn2_kernel_d40a:
    s_add_u32 m0, s53, 16384
    s_add_u32 s54, s52, 294912
    buffer_load_dwordx4 v11, s[32:35], s54 offen sc1 lds
ffn2_kernel_d40b:
    s_waitcnt vmcnt(12) lgkmcnt(0)
    s_barrier
    s_add_u32 m0, s53, 24576
    s_add_u32 s54, s51, 1556480
    buffer_load_dwordx4 v8, s[28:31], s54 offen sc1 lds
    s_add_u32 m0, s53, 32768
    s_add_u32 s54, s51, 1556480
    buffer_load_dwordx4 v9, s[28:31], s54 offen sc1 lds
    s_cmp_lt_u32 s25, 4
    s_cbranch_scc0 ffn2_kernel_d41a
    s_add_u32 m0, s53, 40960
    s_add_u32 s54, s51, 1556480
    buffer_load_dwordx4 v10, s[28:31], s54 offen sc1 lds
    s_branch ffn2_kernel_d41b
ffn2_kernel_d41a:
    s_add_u32 m0, s53, 40960
    s_add_u32 s54, s52, 311296
    buffer_load_dwordx4 v11, s[32:35], s54 offen sc1 lds
ffn2_kernel_d41b:
    s_waitcnt vmcnt(12) lgkmcnt(0)
    s_barrier
    s_add_u32 m0, s53, 49152
    s_add_u32 s54, s51, 1638400
    buffer_load_dwordx4 v8, s[28:31], s54 offen sc1 lds
    s_add_u32 m0, s53, 57344
    s_add_u32 s54, s51, 1638400
    buffer_load_dwordx4 v9, s[28:31], s54 offen sc1 lds
    s_cmp_lt_u32 s25, 4
    s_cbranch_scc0 ffn2_kernel_d42a
    s_add_u32 m0, s53, 65536
    s_add_u32 s54, s51, 1638400
    buffer_load_dwordx4 v10, s[28:31], s54 offen sc1 lds
    s_branch ffn2_kernel_d42b
ffn2_kernel_d42a:
    s_add_u32 m0, s53, 65536
    s_add_u32 s54, s52, 327680
    buffer_load_dwordx4 v11, s[32:35], s54 offen sc1 lds
ffn2_kernel_d42b:
    s_waitcnt vmcnt(12) lgkmcnt(0)
    s_barrier
    s_add_u32 m0, s53, 73728
    s_add_u32 s54, s51, 1720320
    buffer_load_dwordx4 v8, s[28:31], s54 offen sc1 lds
    s_add_u32 m0, s53, 81920
    s_add_u32 s54, s51, 1720320
    buffer_load_dwordx4 v9, s[28:31], s54 offen sc1 lds
    s_cmp_lt_u32 s25, 4
    s_cbranch_scc0 ffn2_kernel_d43a
    s_add_u32 m0, s53, 90112
    s_add_u32 s54, s51, 1720320
    buffer_load_dwordx4 v10, s[28:31], s54 offen sc1 lds
    s_branch ffn2_kernel_d43b
ffn2_kernel_d43a:
    s_add_u32 m0, s53, 90112
    s_add_u32 s54, s52, 344064
    buffer_load_dwordx4 v11, s[32:35], s54 offen sc1 lds
ffn2_kernel_d43b:
    s_waitcnt vmcnt(12) lgkmcnt(0)
    s_barrier
    s_add_u32 m0, s53, 98304
    s_add_u32 s54, s51, 1802240
    buffer_load_dwordx4 v8, s[28:31], s54 offen sc1 lds
    s_add_u32 m0, s53, 106496
    s_add_u32 s54, s51, 1802240
    buffer_load_dwordx4 v9, s[28:31], s54 offen sc1 lds
    s_cmp_lt_u32 s25, 4
    s_cbranch_scc0 ffn2_kernel_d44a
    s_add_u32 m0, s53, 114688
    s_add_u32 s54, s51, 1802240
    buffer_load_dwordx4 v10, s[28:31], s54 offen sc1 lds
    s_branch ffn2_kernel_d44b
ffn2_kernel_d44a:
    s_add_u32 m0, s53, 114688
    s_add_u32 s54, s52, 360448
    buffer_load_dwordx4 v11, s[32:35], s54 offen sc1 lds
ffn2_kernel_d44b:
    s_waitcnt vmcnt(12) lgkmcnt(0)
    s_barrier
    s_add_u32 m0, s53, 122880
    s_add_u32 s54, s51, 1884160
    buffer_load_dwordx4 v8, s[28:31], s54 offen sc1 lds
    s_add_u32 m0, s53, 131072
    s_add_u32 s54, s51, 1884160
    buffer_load_dwordx4 v9, s[28:31], s54 offen sc1 lds
    s_cmp_lt_u32 s25, 4
    s_cbranch_scc0 ffn2_kernel_d45a
    s_add_u32 m0, s53, 139264
    s_add_u32 s54, s51, 1884160
    buffer_load_dwordx4 v10, s[28:31], s54 offen sc1 lds
    s_branch ffn2_kernel_d45b
ffn2_kernel_d45a:
    s_add_u32 m0, s53, 139264
    s_add_u32 s54, s52, 376832
    buffer_load_dwordx4 v11, s[32:35], s54 offen sc1 lds
ffn2_kernel_d45b:
    s_waitcnt vmcnt(12) lgkmcnt(0)
    s_barrier
    s_add_u32 m0, s53, 0
    s_add_u32 s54, s51, 1966080
    buffer_load_dwordx4 v8, s[28:31], s54 offen sc1 lds
    s_add_u32 m0, s53, 8192
    s_add_u32 s54, s51, 1966080
    buffer_load_dwordx4 v9, s[28:31], s54 offen sc1 lds
    s_cmp_lt_u32 s25, 4
    s_cbranch_scc0 ffn2_kernel_d46a
    s_add_u32 m0, s53, 16384
    s_add_u32 s54, s51, 1966080
    buffer_load_dwordx4 v10, s[28:31], s54 offen sc1 lds
    s_branch ffn2_kernel_d46b
ffn2_kernel_d46a:
    s_add_u32 m0, s53, 16384
    s_add_u32 s54, s52, 393216
    buffer_load_dwordx4 v11, s[32:35], s54 offen sc1 lds
ffn2_kernel_d46b:
    s_waitcnt vmcnt(12) lgkmcnt(0)
    s_barrier
    s_add_u32 m0, s53, 24576
    s_add_u32 s54, s51, 2048000
    buffer_load_dwordx4 v8, s[28:31], s54 offen sc1 lds
    s_add_u32 m0, s53, 32768
    s_add_u32 s54, s51, 2048000
    buffer_load_dwordx4 v9, s[28:31], s54 offen sc1 lds
    s_cmp_lt_u32 s25, 4
    s_cbranch_scc0 ffn2_kernel_d47a
    s_add_u32 m0, s53, 40960
    s_add_u32 s54, s51, 2048000
    buffer_load_dwordx4 v10, s[28:31], s54 offen sc1 lds
    s_branch ffn2_kernel_d47b
ffn2_kernel_d47a:
    s_add_u32 m0, s53, 40960
    s_add_u32 s54, s52, 409600
    buffer_load_dwordx4 v11, s[32:35], s54 offen sc1 lds
ffn2_kernel_d47b:
    s_waitcnt vmcnt(12) lgkmcnt(0)
    s_barrier
    s_add_u32 m0, s53, 49152
    s_add_u32 s54, s51, 2129920
    buffer_load_dwordx4 v8, s[28:31], s54 offen sc1 lds
    s_add_u32 m0, s53, 57344
    s_add_u32 s54, s51, 2129920
    buffer_load_dwordx4 v9, s[28:31], s54 offen sc1 lds
    s_cmp_lt_u32 s25, 4
    s_cbranch_scc0 ffn2_kernel_d48a
    s_add_u32 m0, s53, 65536
    s_add_u32 s54, s51, 2129920
    buffer_load_dwordx4 v10, s[28:31], s54 offen sc1 lds
    s_branch ffn2_kernel_d48b
ffn2_kernel_d48a:
    s_add_u32 m0, s53, 65536
    s_add_u32 s54, s52, 425984
    buffer_load_dwordx4 v11, s[32:35], s54 offen sc1 lds
ffn2_kernel_d48b:
    s_waitcnt vmcnt(12) lgkmcnt(0)
    s_barrier
    s_waitcnt vmcnt(9) lgkmcnt(0)
    s_barrier
    s_waitcnt vmcnt(6) lgkmcnt(0)
    s_barrier
    s_waitcnt vmcnt(3) lgkmcnt(0)
    s_barrier
    s_waitcnt vmcnt(0) lgkmcnt(0)
    s_barrier
    s_branch ffn2_kernel_fin2
ffn2_kernel_comp_done:
    s_mov_b32 s36, s16
    s_mov_b32 s37, s17
    s_mov_b32 s38, 0x280000
    s_mov_b32 s39, 0x00020000
    s_mov_b32 s40, s14
    s_mov_b32 s41, s15
    s_mov_b32 s42, 0x500
    s_mov_b32 s43, 0x00020000
    s_add_u32 s44, s12, 0x5400000
    s_addc_u32 s45, s13, 0
    s_mov_b32 s46, 0x280000
    s_mov_b32 s47, 0x00020000
    s_lshl_b32 s57, s26, 5
    s_add_u32 s57, s57, s20
    v_lshrrev_b32 v4, 5, v1
    v_lshlrev_b32 v5, 4, v4
    s_lshl_b32 s58, s57, 1
    buffer_load_dwordx4 v[24:27], v5, s[40:43], s58 offen offset:0 sc1
    buffer_load_dwordx4 v[28:31], v5, s[40:43], s58 offen offset:32 sc1
    s_lshr_b32 s59, s21, 7
    s_mul_i32 s59, s59, 80
    s_lshr_b32 s60, s57, 3
    s_add_u32 s59, s59, s60
    s_lshl_b32 s59, s59, 11
    s_and_b32 s60, s21, 127
    s_lshl_b32 s60, s60, 4
    s_add_u32 s59, s59, s60
    v_lshlrev_b32 v6, 11, v4
    v_and_b32 v7, 31, v1
    v_lshlrev_b32 v5, 4, v7
    v_add_u32 v6, v6, v5
    s_add_u32 s60, s59, 0
    buffer_load_dwordx4 v[32:35], v6, s[44:47], s60 offen sc1
    s_add_u32 s60, s59, 4096
    buffer_load_dwordx4 v[36:39], v6, s[44:47], s60 offen sc1
    v_add_u32 v7, s21, v7
    v_mul_u32_u24 v7, 1280, v7
    v_lshlrev_b32 v4, 4, v4
    v_add_u32 v7, v7, v4
    s_waitcnt vmcnt(0)
    v_lshlrev_b32 v96, 16, v24
    v_and_b32 v97, 0xffff0000, v24
    v_add_f32 v40, v40, v96
    v_add_f32 v41, v41, v97
    v_lshlrev_b32 v96, 16, v25
    v_and_b32 v97, 0xffff0000, v25
    v_add_f32 v42, v42, v96
    v_add_f32 v43, v43, v97
    v_lshlrev_b32 v96, 16, v26
    v_and_b32 v97, 0xffff0000, v26
    v_add_f32 v44, v44, v96
    v_add_f32 v45, v45, v97
    v_lshlrev_b32 v96, 16, v27
    v_and_b32 v97, 0xffff0000, v27
    v_add_f32 v46, v46, v96
    v_add_f32 v47, v47, v97
    v_cvt_pk_bf16_f32 v100, v40, v41
    v_cvt_pk_bf16_f32 v101, v42, v43
    v_cvt_pk_bf16_f32 v102, v44, v45
    v_cvt_pk_bf16_f32 v103, v46, v47
    v_lshlrev_b32 v96, 16, v100
    v_and_b32 v97, 0xffff0000, v100
    v_lshlrev_b32 v98, 16, v32
    v_and_b32 v99, 0xffff0000, v32
    v_add_f32 v96, v96, v98
    v_add_f32 v97, v97, v99
    v_cvt_pk_bf16_f32 v104, v96, v97
    v_lshlrev_b32 v96, 16, v101
    v_and_b32 v97, 0xffff0000, v101
    v_lshlrev_b32 v98, 16, v33
    v_and_b32 v99, 0xffff0000, v33
    v_add_f32 v96, v96, v98
    v_add_f32 v97, v97, v99
    v_cvt_pk_bf16_f32 v105, v96, v97
    v_lshlrev_b32 v96, 16, v102
    v_and_b32 v97, 0xffff0000, v102
    v_lshlrev_b32 v98, 16, v34
    v_and_b32 v99, 0xffff0000, v34
    v_add_f32 v96, v96, v98
    v_add_f32 v97, v97, v99
    v_cvt_pk_bf16_f32 v106, v96, v97
    v_lshlrev_b32 v96, 16, v103
    v_and_b32 v97, 0xffff0000, v103
    v_lshlrev_b32 v98, 16, v35
    v_and_b32 v99, 0xffff0000, v35
    v_add_f32 v96, v96, v98
    v_add_f32 v97, v97, v99
    v_cvt_pk_bf16_f32 v107, v96, v97
    buffer_store_dwordx4 v[104:107], v7, s[36:39], s58 offen offset:0 sc1
    v_lshlrev_b32 v96, 16, v28
    v_and_b32 v97, 0xffff0000, v28
    v_add_f32 v48, v48, v96
    v_add_f32 v49, v49, v97
    v_lshlrev_b32 v96, 16, v29
    v_and_b32 v97, 0xffff0000, v29
    v_add_f32 v50, v50, v96
    v_add_f32 v51, v51, v97
    v_lshlrev_b32 v96, 16, v30
    v_and_b32 v97, 0xffff0000, v30
    v_add_f32 v52, v52, v96
    v_add_f32 v53, v53, v97
    v_lshlrev_b32 v96, 16, v31
    v_and_b32 v97, 0xffff0000, v31
    v_add_f32 v54, v54, v96
    v_add_f32 v55, v55, v97
    v_cvt_pk_bf16_f32 v100, v48, v49
    v_cvt_pk_bf16_f32 v101, v50, v51
    v_cvt_pk_bf16_f32 v102, v52, v53
    v_cvt_pk_bf16_f32 v103, v54, v55
    v_lshlrev_b32 v96, 16, v100
    v_and_b32 v97, 0xffff0000, v100
    v_lshlrev_b32 v98, 16, v36
    v_and_b32 v99, 0xffff0000, v36
    v_add_f32 v96, v96, v98
    v_add_f32 v97, v97, v99
    v_cvt_pk_bf16_f32 v108, v96, v97
    v_lshlrev_b32 v96, 16, v101
    v_and_b32 v97, 0xffff0000, v101
    v_lshlrev_b32 v98, 16, v37
    v_and_b32 v99, 0xffff0000, v37
    v_add_f32 v96, v96, v98
    v_add_f32 v97, v97, v99
    v_cvt_pk_bf16_f32 v109, v96, v97
    v_lshlrev_b32 v96, 16, v102
    v_and_b32 v97, 0xffff0000, v102
    v_lshlrev_b32 v98, 16, v38
    v_and_b32 v99, 0xffff0000, v38
    v_add_f32 v96, v96, v98
    v_add_f32 v97, v97, v99
    v_cvt_pk_bf16_f32 v110, v96, v97
    v_lshlrev_b32 v96, 16, v103
    v_and_b32 v97, 0xffff0000, v103
    v_lshlrev_b32 v98, 16, v39
    v_and_b32 v99, 0xffff0000, v39
    v_add_f32 v96, v96, v98
    v_add_f32 v97, v97, v99
    v_cvt_pk_bf16_f32 v111, v96, v97
    buffer_store_dwordx4 v[108:111], v7, s[36:39], s58 offen offset:32 sc1
ffn2_kernel_fin2:
ffn2_kernel_end:
L_fz_end:
    s_endpgm
.section .rodata,"a"
.p2align 6
.amdhsa_kernel sequential_preLN__compressed_kv_cla__dense_activation_gelu__prompt_kernel
  .amdhsa_next_free_vgpr 256
  .amdhsa_next_free_sgpr 102
  .amdhsa_accum_offset 256
  .amdhsa_group_segment_fixed_size 0
  .amdhsa_kernarg_size 112
  .amdhsa_user_sgpr_count 2
  .amdhsa_user_sgpr_kernarg_segment_ptr 1
  .amdhsa_system_sgpr_workgroup_id_x 1
.end_amdhsa_kernel
```
